```python
import torch

def _softmax(x, axis=-1):
    return torch.softmax(x, dim=axis)
def _gelu(x):
    return torch.nn.functional.gelu(x, approximate="tanh")
def _silu(x):
    return torch.nn.functional.silu(x)
def _sigmoid(x):
    return torch.sigmoid(x)
def _layernorm(x, axis=-1, eps=1e-5):
    m = x.mean(dim=axis, keepdim=True)
    v = x.var(dim=axis, keepdim=True, unbiased=False)
    return (x - m) / torch.sqrt(v + eps)
def _scatter_add(tgt, idx, src, axis=0):
    return tgt.clone().index_add_(axis, idx, src)
def _segment_sum(src, seg, n):
    out = torch.zeros((n,) + src.shape[1:], dtype=src.dtype)
    return out.index_add_(0, seg, src)
def _pad(x, pw):
    flat = tuple(v for pair in reversed(pw) for v in pair)
    return torch.nn.functional.pad(x, flat)

kernel_name = 'recurrent_scan__spectral_gfnet__mixer_channel_mlp__prompt'

def setup_inputs():

    _w = (lambda a: (lambda t: t.to(torch.bfloat16) if t.is_floating_point() else t)(torch.as_tensor(a)))
    def _A_setup():
        B, S, D = 1, 2048, 576
        Df = D // 2 + 1
        return {
            "x": _w((lambda *s: torch.randn(*s, dtype=torch.bfloat16) * 0.05)(B, S, D)),
            "w_r": _w((lambda *s: torch.randn(*s, dtype=torch.bfloat16) * 0.8)(S, Df) * 0.02),
            "w_i": _w((lambda *s: torch.randn(*s, dtype=torch.bfloat16) * 0.8)(S, Df) * 0.02),
        }
    _A_in = _A_setup()

    def _B_setup():
        B, S, D, F = 1, 2048, 576, 4608
        return {
            "x": _w((lambda *s: torch.randn(*s, dtype=torch.bfloat16) * 0.05)(B, S, D)),
            "w1": _w((lambda *s: torch.randn(*s, dtype=torch.bfloat16) * 0.8)(D, F) * (D ** -0.5)),
            "b1": _w((lambda *s: torch.randn(*s, dtype=torch.bfloat16) * 0.8)(F)),
            "w2": _w((lambda *s: torch.randn(*s, dtype=torch.bfloat16) * 0.8)(F, D) * (F ** -0.5)),
            "b2": _w((lambda *s: torch.randn(*s, dtype=torch.bfloat16) * 0.2)(D)),
        }
    _B_in = _B_setup()

    return {
        "A_x": _A_in["x"],
        "A_w_r": _A_in["w_r"],
        "A_w_i": _A_in["w_i"],
        "B_x": _B_in["x"],
        "B_w1": _B_in["w1"],
        "B_b1": _B_in["b1"],
        "B_w2": _B_in["w2"],
        "B_b2": _B_in["b2"],
    }

def reference(A_x, A_w_r, A_w_i, B_x, B_w1, B_b1, B_w2, B_b2):
    def _A_ref(x, w_r, w_i):
        B, S, D = x.shape
        X = (lambda x, axes=(-2,-1): torch.fft.rfft2(x.float(), dim=axes))(x, axes=(-2, -1))
        W = w_r + 1j * w_i
        X = X * W
        y = (lambda x, s, axes=(-2,-1): torch.fft.irfft2(x, s=s, dim=axes).to(torch.bfloat16))(X, (S, D), axes=(-2, -1))
        return y

    def _B_ref(x, w1, b1, w2, b2):
        y = _layernorm(x, axis=-1)
        h = _gelu(torch.einsum("bsd,df->bsf", y, w1) + b1)
        return torch.einsum("bsf,fd->bsd", h, w2) + b2

    x = A_x
    xn = _layernorm(x, axis=-1)
    s = _A_ref(xn, A_w_r, A_w_i)
    g = _silu(_B_ref(xn, B_w1, B_b1, B_w2, B_b2))
    return x + s * g
```

```asm
; @launch kernel=mega_kernel grid=(256,1,1) block=(512,1,1) lds=163840
.amdgcn_target "amdgcn-amd-amdhsa--gfx950"
.text
.globl mega_kernel
.p2align 8
.type mega_kernel,@function
mega_kernel:
    s_cmp_ge_u32 s2, 256
    s_cbranch_scc1 .Lmega_end
    s_load_dwordx4 s[16:19], s[0:1], 72
    s_load_dwordx4 s[20:23], s[0:1], 0
    s_load_dwordx2 s[24:25], s[0:1], 16
    s_load_dwordx4 s[28:31], s[0:1], 32
    s_getpc_b64 s[96:97]
.Lpc_m:
    s_add_u32 s96, s96, const_tab-.Lpc_m
    s_addc_u32 s97, s97, 0
    s_mov_b32 s98, 0xbc00
    s_mov_b32 s99, 0x20000
    v_lshrrev_b32 v1, 6, v0
    v_and_b32 v0, 63, v0
    v_readfirstlane_b32 s88, v1
    s_and_b32 s84, s2, 7
    s_lshr_b32 s85, s2, 3
    v_lshlrev_b32 v6, 4, v0
    s_mov_b32 s89, 0
    s_cmp_lg_u32 s88, 0
    s_cbranch_scc1 .Lnocpf
    s_getpc_b64 s[100:101]
    s_mov_b32 s48, s100
    s_mov_b32 s49, s101
    s_mov_b32 s50, const_tab-mega_kernel-1024+48128
    s_mov_b32 s51, 0x20000
    s_lshl_b32 s86, s85, 12
    v_and_b32 v1, 31, v0
    v_lshlrev_b32 v1, 7, v1
    buffer_load_dword v255, v1, s[48:51], s86 offen
.Lnocpf:
    s_lshl_b32 s76, s84, 5
    s_add_u32 s76, s76, s85
    s_lshl_b32 s71, s88, 10
    s_lshl_b32 s74, s88, 6
    v_add_u32 v7, s74, v0
    v_lshrrev_b32 v1, 4, v0
    v_and_b32 v2, 15, v0
    v_lshlrev_b32 v8, 8, v1
    v_lshl_add_u32 v60, v2, 1, v8
    v_lshlrev_b32 v8, 5, v1
    v_lshl_add_u32 v61, v2, 1, v8
    s_lshl_b32 s74, s88, 8
    s_add_u32 s74, s74, s76
    s_mul_i32 s74, s74, 1152
    s_waitcnt lgkmcnt(0)
    s_mov_b32 s32, s20
    s_mov_b32 s33, s21
    s_mov_b32 s34, 0x240000
    s_mov_b32 s35, 0x20000
    buffer_load_ushort v40, v60, s[32:35], s74 offen offset:0
    buffer_load_ushort v41, v60, s[32:35], s74 offen offset:32
    buffer_load_ushort v42, v60, s[32:35], s74 offen offset:64
    buffer_load_ushort v43, v60, s[32:35], s74 offen offset:96
    buffer_load_ushort v44, v60, s[32:35], s74 offen offset:128
    buffer_load_ushort v45, v60, s[32:35], s74 offen offset:160
    buffer_load_ushort v46, v60, s[32:35], s74 offen offset:192
    buffer_load_ushort v47, v60, s[32:35], s74 offen offset:224
    buffer_load_ushort v48, v61, s[32:35], s74 offen offset:1024
    s_mov_b32 s92, s18
    s_mov_b32 s93, s19
    s_mov_b32 s94, 0x3400000
    s_mov_b32 s95, 0x20000
    s_mov_b32 s44, s16
    s_mov_b32 s45, s17
    s_mov_b32 s46, 0x100
    s_mov_b32 s47, 0x20000
    s_mov_b32 s36, s22
    s_mov_b32 s37, s23
    s_mov_b32 s38, 0x121000
    s_mov_b32 s39, 0x20000
    s_mov_b32 s40, s24
    s_mov_b32 s41, s25
    s_mov_b32 s42, 0x121000
    s_mov_b32 s43, 0x20000
    s_mov_b32 s20, s30
    s_mov_b32 s21, s31
    s_mov_b32 s22, 0x2400
    s_mov_b32 s23, 0x20000
    s_mov_b32 s16, s28
    s_mov_b32 s17, s29
    s_mov_b32 s18, 0x510000
    s_mov_b32 s19, 0x20000
    s_or_b32 s86, s2, s88
    s_cmp_lg_u32 s86, 0
    s_cbranch_scc1 .Lno_nonce
    s_memrealtime s[100:101]
    s_waitcnt lgkmcnt(0)
    s_or_b32 s100, s100, 1
    v_mov_b32 v12, s100
    v_mov_b32 v13, s101
    v_mov_b32 v1, 0
    s_mov_b64 exec, 1
    buffer_store_dwordx2 v[12:13], v1, s[44:47], 0 offen sc1
    s_mov_b64 exec, -1
.Lno_nonce:
    s_add_u32 m0, s71, 0x1e000
    s_nop 0
    buffer_load_dwordx4 v6, s[96:99], s71 offen lds
    s_add_u32 s74, s71, 8192
    s_add_u32 m0, s71, 0x20000
    s_nop 0
    buffer_load_dwordx4 v6, s[96:99], s74 offen lds
    s_lshl_b32 s74, s76, 6
    s_add_u32 s74, s74, 0x7c00
    s_add_u32 s78, s96, s74
    s_addc_u32 s79, s97, 0
    s_load_dwordx16 s[48:63], s[78:79], 0
    s_and_b32 s26, s84, 1
    s_lshl_b32 s26, s26, 2
    s_and_b32 s27, s85, 3
    s_add_u32 s26, s26, s27
    s_lshr_b32 s27, s84, 1
    s_lshl_b32 s27, s27, 3
    s_lshr_b32 s64, s85, 2
    s_add_u32 s27, s27, s64
    s_mul_i32 s66, s27, 288
    s_and_b32 s67, s27, 1
    s_lshl_b32 s70, s67, 5
    s_add_u32 s70, s70, s66
    s_lshl_b32 s64, s88, 6
    s_mov_b32 s65, 0x15556
    v_add_u32 v3, s64, v0
    v_mul_u32_u24 v1, s65, v3
    v_lshrrev_b32 v1, 20, v1
    v_mul_u32_u24 v2, 12, v1
    v_sub_u32 v3, v3, v2
    v_bfe_u32 v2, v1, 2, 1
    v_lshlrev_b32 v2, 1, v2
    v_xor_b32 v3, v3, v2
    v_lshlrev_b32 v3, 4, v3
    v_mul_u32_u24 v1, 9216, v1
    v_add_u32 v3, v3, v1
    v_add_u32 v4, s64, v0
    v_add_u32 v4, 512, v4
    v_mul_u32_u24 v1, s65, v4
    v_lshrrev_b32 v1, 20, v1
    v_mul_u32_u24 v2, 12, v1
    v_sub_u32 v4, v4, v2
    v_bfe_u32 v2, v1, 2, 1
    v_lshlrev_b32 v2, 1, v2
    v_xor_b32 v4, v4, v2
    v_lshlrev_b32 v4, 4, v4
    v_mul_u32_u24 v1, 9216, v1
    v_add_u32 v4, v4, v1
    v_add_u32 v5, s64, v0
    v_add_u32 v5, 1024, v5
    v_mul_u32_u24 v1, s65, v5
    v_lshrrev_b32 v1, 20, v1
    v_mul_u32_u24 v2, 12, v1
    v_sub_u32 v5, v5, v2
    v_bfe_u32 v2, v1, 2, 1
    v_lshlrev_b32 v2, 1, v2
    v_xor_b32 v5, v5, v2
    v_lshlrev_b32 v5, 4, v5
    v_mul_u32_u24 v1, 9216, v1
    v_add_u32 v5, v5, v1
    s_add_u32 s80, s70, 0x0
    s_add_u32 m0, s71, 0x0
    s_nop 0
    buffer_load_dwordx4 v3, s[16:19], s80 offen lds
    s_add_u32 s81, s70, 0x0
    s_add_u32 m0, s71, 0x2000
    s_nop 0
    buffer_load_dwordx4 v4, s[16:19], s81 offen lds
    s_add_u32 s80, s70, 0x0
    s_add_u32 m0, s71, 0x4000
    s_nop 0
    buffer_load_dwordx4 v5, s[16:19], s80 offen lds
    s_add_u32 s81, s70, 0x120000
    s_add_u32 m0, s71, 0x6000
    s_nop 0
    buffer_load_dwordx4 v3, s[16:19], s81 offen lds
    s_add_u32 s80, s70, 0x120000
    s_add_u32 m0, s71, 0x8000
    s_nop 0
    buffer_load_dwordx4 v4, s[16:19], s80 offen lds
    s_add_u32 s81, s70, 0x120000
    s_add_u32 m0, s71, 0xa000
    s_nop 0
    buffer_load_dwordx4 v5, s[16:19], s81 offen lds
    v_mov_b32 v1, 0
    v_mov_b32 v2, 0x26d00
    ds_write_b32 v2, v1
    s_lshl_b32 s64, s67, 4
    v_add_u32 v1, s64, v7
    v_subrev_u32 v2, 144, v1
    v_cmp_gt_u32 vcc, 144, v1
    s_nop 1
    v_cndmask_b32 v1, v2, v1, vcc
    v_lshlrev_b32 v1, 1, v1
    buffer_load_ushort v11, v1, s[20:23], s66 offen
    s_waitcnt vmcnt(17)
    v_lshlrev_b32 v40, 16, v40
    s_waitcnt vmcnt(16)
    v_lshlrev_b32 v41, 16, v41
    s_waitcnt vmcnt(15)
    v_lshlrev_b32 v42, 16, v42
    s_waitcnt vmcnt(14)
    v_lshlrev_b32 v43, 16, v43
    s_waitcnt vmcnt(13)
    v_lshlrev_b32 v44, 16, v44
    s_waitcnt vmcnt(12)
    v_lshlrev_b32 v45, 16, v45
    s_waitcnt vmcnt(11)
    v_lshlrev_b32 v46, 16, v46
    s_waitcnt vmcnt(10)
    v_lshlrev_b32 v47, 16, v47
    s_waitcnt vmcnt(9)
    v_lshlrev_b32 v48, 16, v48
    v_add_f32 v58, v40, v41
    v_add_f32 v59, v42, v43
    v_add_f32 v62, v44, v45
    v_add_f32 v63, v46, v47
    v_add_f32 v58, v58, v59
    v_add_f32 v62, v62, v63
    v_add_f32 v58, v58, v48
    v_add_f32 v58, v58, v62
    s_nop 1
    v_add_f32_dpp v58, v58, v58 row_ror:8 row_mask:0xf bank_mask:0xf
    s_nop 1
    v_add_f32_dpp v58, v58, v58 row_ror:4 row_mask:0xf bank_mask:0xf
    s_nop 1
    v_add_f32_dpp v58, v58, v58 row_ror:2 row_mask:0xf bank_mask:0xf
    s_nop 1
    v_add_f32_dpp v58, v58, v58 row_ror:1 row_mask:0xf bank_mask:0xf
    v_mov_b32 v59, v58
    s_nop 1
    v_permlane16_swap_b32 v58, v59
    v_add_f32 v58, v58, v59
    v_mov_b32 v59, v58
    s_nop 1
    v_permlane32_swap_b32 v58, v59
    v_add_f32 v58, v58, v59
    v_mul_f32 v58, 0x3ae38e39, v58
    v_sub_f32 v49, v40, v58
    v_sub_f32 v50, v41, v58
    v_sub_f32 v51, v42, v58
    v_sub_f32 v52, v43, v58
    v_sub_f32 v53, v44, v58
    v_sub_f32 v54, v45, v58
    v_sub_f32 v55, v46, v58
    v_sub_f32 v56, v47, v58
    v_sub_f32 v57, v48, v58
    v_mul_f32 v59, v49, v49
    v_mul_f32 v62, v50, v50
    v_fmac_f32 v59, v51, v51
    v_fmac_f32 v62, v52, v52
    v_fmac_f32 v59, v53, v53
    v_fmac_f32 v62, v54, v54
    v_fmac_f32 v59, v55, v55
    v_fmac_f32 v62, v56, v56
    v_fmac_f32 v59, v57, v57
    v_add_f32 v59, v59, v62
    s_nop 1
    v_add_f32_dpp v59, v59, v59 row_ror:8 row_mask:0xf bank_mask:0xf
    s_nop 1
    v_add_f32_dpp v59, v59, v59 row_ror:4 row_mask:0xf bank_mask:0xf
    s_nop 1
    v_add_f32_dpp v59, v59, v59 row_ror:2 row_mask:0xf bank_mask:0xf
    s_nop 1
    v_add_f32_dpp v59, v59, v59 row_ror:1 row_mask:0xf bank_mask:0xf
    v_mov_b32 v62, v59
    s_nop 1
    v_permlane16_swap_b32 v59, v62
    v_add_f32 v59, v59, v62
    v_mov_b32 v62, v59
    s_nop 1
    v_permlane32_swap_b32 v59, v62
    v_add_f32 v59, v59, v62
    v_mul_f32 v59, 0x3ae38e39, v59
    v_cvt_pk_bf16_f32 v58, v58, v59
    v_and_b32 v59, 0xffff0000, v58
    v_lshlrev_b32 v58, 16, v58
    v_add_f32 v59, 0x3727c5ac, v59
    v_cvt_pk_bf16_f32 v59, v59, v59
    v_lshlrev_b32 v59, 16, v59
    v_sqrt_f32 v59, v59
    s_nop 0
    v_cvt_pk_bf16_f32 v59, v59, v59
    v_lshlrev_b32 v59, 16, v59
    v_rcp_f32 v59, v59
    v_sub_f32 v40, v40, v58
    v_sub_f32 v41, v41, v58
    v_sub_f32 v42, v42, v58
    v_sub_f32 v43, v43, v58
    v_sub_f32 v44, v44, v58
    v_sub_f32 v45, v45, v58
    v_sub_f32 v46, v46, v58
    v_sub_f32 v47, v47, v58
    v_sub_f32 v48, v48, v58
    v_cvt_pk_bf16_f32 v49, v40, v41
    v_cvt_pk_bf16_f32 v50, v42, v43
    v_cvt_pk_bf16_f32 v51, v44, v45
    v_cvt_pk_bf16_f32 v52, v46, v47
    v_cvt_pk_bf16_f32 v53, v48, v48
    v_lshlrev_b32 v40, 16, v49
    v_and_b32 v41, 0xffff0000, v49
    v_lshlrev_b32 v42, 16, v50
    v_and_b32 v43, 0xffff0000, v50
    v_lshlrev_b32 v44, 16, v51
    v_and_b32 v45, 0xffff0000, v51
    v_lshlrev_b32 v46, 16, v52
    v_and_b32 v47, 0xffff0000, v52
    v_lshlrev_b32 v48, 16, v53
    v_mul_f32 v40, v40, v59
    v_mul_f32 v41, v41, v59
    v_mul_f32 v42, v42, v59
    v_mul_f32 v43, v43, v59
    v_mul_f32 v44, v44, v59
    v_mul_f32 v45, v45, v59
    v_mul_f32 v46, v46, v59
    v_mul_f32 v47, v47, v59
    v_mul_f32 v48, v48, v59
    v_cvt_pk_bf16_f32 v49, v40, v41
    v_cvt_pk_bf16_f32 v50, v42, v43
    v_cvt_pk_bf16_f32 v51, v44, v45
    v_cvt_pk_bf16_f32 v52, v46, v47
    v_cvt_pk_bf16_f32 v53, v48, v48
    v_lshlrev_b32 v40, 16, v49
    v_and_b32 v41, 0xffff0000, v49
    v_lshlrev_b32 v42, 16, v50
    v_and_b32 v43, 0xffff0000, v50
    v_lshlrev_b32 v44, 16, v51
    v_and_b32 v45, 0xffff0000, v51
    v_lshlrev_b32 v46, 16, v52
    v_and_b32 v47, 0xffff0000, v52
    v_lshlrev_b32 v48, 16, v53
    v_mov_b32 v69, 0
    v_mov_b32 v70, 0
    v_cvt_pk_f16_f32 v64, v40, v41
    v_cvt_pk_f16_f32 v65, v42, v43
    v_cvt_pk_f16_f32 v66, v44, v45
    v_cvt_pk_f16_f32 v67, v46, v47
    v_cvt_pk_f16_f32 v68, v48, v69
    v_cvt_pk_f16_f32 v71, v48, v69
    v_add_f32 v58, v40, v41
    v_add_f32 v59, v42, v43
    v_add_f32 v62, v44, v45
    v_add_f32 v63, v46, v47
    v_add_f32 v58, v58, v59
    v_add_f32 v62, v62, v63
    v_add_f32 v58, v58, v48
    v_add_f32 v58, v58, v62
    s_nop 1
    v_add_f32_dpp v58, v58, v58 row_ror:8 row_mask:0xf bank_mask:0xf
    s_nop 1
    v_add_f32_dpp v58, v58, v58 row_ror:4 row_mask:0xf bank_mask:0xf
    s_nop 1
    v_add_f32_dpp v58, v58, v58 row_ror:2 row_mask:0xf bank_mask:0xf
    s_nop 1
    v_add_f32_dpp v58, v58, v58 row_ror:1 row_mask:0xf bank_mask:0xf
    v_mov_b32 v59, v58
    s_nop 1
    v_permlane16_swap_b32 v58, v59
    v_add_f32 v58, v58, v59
    v_mov_b32 v59, v58
    s_nop 1
    v_permlane32_swap_b32 v58, v59
    v_add_f32 v58, v58, v59
    v_mul_f32 v58, 0x3ae38e39, v58
    v_sub_f32 v49, v40, v58
    v_sub_f32 v50, v41, v58
    v_sub_f32 v51, v42, v58
    v_sub_f32 v52, v43, v58
    v_sub_f32 v53, v44, v58
    v_sub_f32 v54, v45, v58
    v_sub_f32 v55, v46, v58
    v_sub_f32 v56, v47, v58
    v_sub_f32 v57, v48, v58
    v_mul_f32 v59, v49, v49
    v_mul_f32 v62, v50, v50
    v_fmac_f32 v59, v51, v51
    v_fmac_f32 v62, v52, v52
    v_fmac_f32 v59, v53, v53
    v_fmac_f32 v62, v54, v54
    v_fmac_f32 v59, v55, v55
    v_fmac_f32 v62, v56, v56
    v_fmac_f32 v59, v57, v57
    v_add_f32 v59, v59, v62
    s_nop 1
    v_add_f32_dpp v59, v59, v59 row_ror:8 row_mask:0xf bank_mask:0xf
    s_nop 1
    v_add_f32_dpp v59, v59, v59 row_ror:4 row_mask:0xf bank_mask:0xf
    s_nop 1
    v_add_f32_dpp v59, v59, v59 row_ror:2 row_mask:0xf bank_mask:0xf
    s_nop 1
    v_add_f32_dpp v59, v59, v59 row_ror:1 row_mask:0xf bank_mask:0xf
    v_mov_b32 v62, v59
    s_nop 1
    v_permlane16_swap_b32 v59, v62
    v_add_f32 v59, v59, v62
    v_mov_b32 v62, v59
    s_nop 1
    v_permlane32_swap_b32 v59, v62
    v_add_f32 v59, v59, v62
    v_mul_f32 v59, 0x3ae38e39, v59
    v_cvt_pk_bf16_f32 v58, v58, v59
    v_and_b32 v59, 0xffff0000, v58
    v_lshlrev_b32 v58, 16, v58
    v_add_f32 v59, 0x3727c5ac, v59
    v_cvt_pk_bf16_f32 v59, v59, v59
    v_lshlrev_b32 v59, 16, v59
    v_sqrt_f32 v59, v59
    s_nop 0
    v_cvt_pk_bf16_f32 v59, v59, v59
    v_lshlrev_b32 v59, 16, v59
    v_rcp_f32 v59, v59
    v_sub_f32 v40, v40, v58
    v_sub_f32 v41, v41, v58
    v_sub_f32 v42, v42, v58
    v_sub_f32 v43, v43, v58
    v_sub_f32 v44, v44, v58
    v_sub_f32 v45, v45, v58
    v_sub_f32 v46, v46, v58
    v_sub_f32 v47, v47, v58
    v_sub_f32 v48, v48, v58
    v_cvt_pk_bf16_f32 v49, v40, v41
    v_cvt_pk_bf16_f32 v50, v42, v43
    v_cvt_pk_bf16_f32 v51, v44, v45
    v_cvt_pk_bf16_f32 v52, v46, v47
    v_cvt_pk_bf16_f32 v53, v48, v48
    v_lshlrev_b32 v40, 16, v49
    v_and_b32 v41, 0xffff0000, v49
    v_lshlrev_b32 v42, 16, v50
    v_and_b32 v43, 0xffff0000, v50
    v_lshlrev_b32 v44, 16, v51
    v_and_b32 v45, 0xffff0000, v51
    v_lshlrev_b32 v46, 16, v52
    v_and_b32 v47, 0xffff0000, v52
    v_lshlrev_b32 v48, 16, v53
    v_mul_f32 v40, v40, v59
    v_mul_f32 v41, v41, v59
    v_mul_f32 v42, v42, v59
    v_mul_f32 v43, v43, v59
    v_mul_f32 v44, v44, v59
    v_mul_f32 v45, v45, v59
    v_mul_f32 v46, v46, v59
    v_mul_f32 v47, v47, v59
    v_mul_f32 v48, v48, v59
    v_cvt_pk_bf16_f32 v49, v40, v41
    v_cvt_pk_bf16_f32 v50, v42, v43
    v_cvt_pk_bf16_f32 v51, v44, v45
    v_cvt_pk_bf16_f32 v52, v46, v47
    v_cvt_pk_bf16_f32 v53, v48, v48
    v_lshlrev_b32 v40, 16, v49
    v_and_b32 v41, 0xffff0000, v49
    v_lshlrev_b32 v42, 16, v50
    v_and_b32 v43, 0xffff0000, v50
    v_lshlrev_b32 v44, 16, v51
    v_and_b32 v45, 0xffff0000, v51
    v_lshlrev_b32 v46, 16, v52
    v_and_b32 v47, 0xffff0000, v52
    v_lshlrev_b32 v48, 16, v53
    s_mul_i32 s74, s88, 1168
    s_add_u32 s74, s74, 0x24480
    v_add_u32 v60, s74, v60
    v_add_u32 v61, s74, v61
    ds_write_b16_d16_hi v60, v40 offset:0
    ds_write_b16_d16_hi v60, v41 offset:32
    ds_write_b16_d16_hi v60, v42 offset:64
    ds_write_b16_d16_hi v60, v43 offset:96
    ds_write_b16_d16_hi v60, v44 offset:128
    ds_write_b16_d16_hi v60, v45 offset:160
    ds_write_b16_d16_hi v60, v46 offset:192
    ds_write_b16_d16_hi v60, v47 offset:224
    ds_write_b16_d16_hi v61, v48 offset:1024
    v_and_b32 v1, 7, v7
    v_mul_u32_u24 v32, 1168, v1
    v_lshrrev_b32 v2, 5, v7
    v_lshl_add_u32 v32, v2, 6, v32
    v_bfe_u32 v2, v7, 3, 2
    v_lshl_add_u32 v32, v2, 3, v32
    v_add_u32 v32, 0x24480, v32
    v_lshrrev_b32 v33, 3, v7
    v_lshlrev_b32 v33, 8, v33
    v_lshl_add_u32 v33, v1, 4, v33
    s_lshr_b32 s74, s76, 1
    s_mul_i32 s74, s74, 18432
    s_and_b32 s75, s76, 1
    s_lshl_b32 s75, s75, 7
    s_add_u32 s74, s74, s75
    s_add_u32 s74, s74, 0x3000000
    s_waitcnt lgkmcnt(0)
    s_waitcnt vmcnt(7)
    s_barrier
    ds_read_b64 v[36:37], v32
    ds_read_b64 v[38:39], v32 offset:32
    ds_read_b64 v[12:13], v32 offset:1024
    ds_read_b64 v[14:15], v32 offset:1056
    s_waitcnt lgkmcnt(2)
    buffer_store_dwordx4 v[36:39], v33, s[92:95], s74 offen sc1
    s_cmp_lg_u32 s88, 0
    s_cbranch_scc1 .Lp0_now0
    s_add_u32 s74, s74, 16384
    s_waitcnt lgkmcnt(0)
    buffer_store_dwordx4 v[12:15], v33, s[92:95], s74 offen sc1
.Lp0_now0:
    s_cmp_lg_u32 s88, 7
    s_cbranch_scc1 .Lp0_nonn
    v_mov_b32 v1, 0
    s_mov_b32 s87, 0
.Lnonce_loop:
    buffer_load_dwordx2 v[34:35], v1, s[44:47], 0 offen sc1
    s_waitcnt vmcnt(0)
    v_readfirstlane_b32 s90, v34
    v_readfirstlane_b32 s91, v35
    s_nop 1
    s_cmp_lg_u32 s90, 0
    s_cbranch_scc1 .Lnonce_ok
    s_sleep 1
    s_add_u32 s87, s87, 1
    s_cmp_lt_u32 s87, 0x40000
    s_cbranch_scc1 .Lnonce_loop
.Lnonce_ok:
    s_getreg_b32 s86, hwreg(HW_REG_XCC_ID)
    s_and_b32 s86, s86, 15
    s_lshl_b32 s91, s91, 4
    s_or_b32 s91, s91, s86
.Lp0_nonn:
    v_add_u32 v63, 0x1e000, v6
    ds_read_b128 v[72:75], v63 offset:0
    ds_read_b128 v[76:79], v63 offset:1024
    ds_read_b128 v[80:83], v63 offset:2048
    ds_read_b128 v[84:87], v63 offset:3072
    ds_read_b128 v[88:91], v63 offset:4096
    ds_read_b128 v[96:99], v63 offset:11264
    ds_read_b128 v[100:103], v63 offset:12288
    s_waitcnt lgkmcnt(6)
    v_mfma_f32_16x16x32_f16 v[40:43], v[64:67], v[72:75], 0
    s_waitcnt lgkmcnt(5)
    v_mfma_f32_16x16x32_f16 v[44:47], v[64:67], v[76:79], 0
    s_waitcnt lgkmcnt(4)
    v_mfma_f32_16x16x32_f16 v[48:51], v[64:67], v[80:83], 0
    s_waitcnt lgkmcnt(3)
    v_mfma_f32_16x16x32_f16 v[52:55], v[64:67], v[84:87], 0
    s_waitcnt lgkmcnt(2)
    v_mfma_f32_16x16x16_f16 v[40:43], v[68:69], v[88:89], v[40:43]
    v_mfma_f32_16x16x16_f16 v[44:47], v[70:71], v[88:89], v[44:47]
    s_nop 0
    v_mfma_f32_16x16x16_f16 v[48:51], v[68:69], v[90:91], v[48:51]
    s_nop 0
    v_mfma_f32_16x16x16_f16 v[52:55], v[70:71], v[90:91], v[52:55]
    ds_read_b128 v[72:75], v63 offset:5120
    ds_read_b128 v[76:79], v63 offset:6144
    ds_read_b128 v[80:83], v63 offset:7168
    ds_read_b128 v[84:87], v63 offset:8192
    ds_read_b128 v[88:91], v63 offset:9216
    ds_read_b128 v[92:95], v63 offset:10240
    s_waitcnt vmcnt(0)
    s_barrier
    s_cmp_lg_u32 s88, 7
    s_cbranch_scc1 .Lpub1
    s_lshl_b32 s86, s76, 3
    s_add_u32 s86, s86, 0x3300000
    v_mov_b32 v12, s90
    v_mov_b32 v13, s91
    v_mov_b32 v14, 0
    s_mov_b64 exec, 1
    buffer_store_dwordx2 v[12:13], v14, s[92:95], s86 offen sc1
    s_mov_b64 exec, -1
.Lpub1:
    s_mul_i32 s74, s88, 1160
    s_add_u32 s74, s74, 0x22000
    s_waitcnt lgkmcnt(7)
    v_add_u32 v96, s74, v96
    v_cmp_gt_u32 vcc, 289, v7
    v_add_u32 v97, s74, v97
    v_add_u32 v98, s74, v98
    v_mov_b32 v9, 0x7ffffff0
    v_add_u32 v99, s74, v99
    s_waitcnt lgkmcnt(6)
    v_add_u32 v100, s74, v100
    v_lshlrev_b32 v8, 1, v7
    v_add_u32 v101, s74, v101
    v_add_u32 v102, s74, v102
    v_cndmask_b32 v8, v9, v8, vcc
    v_add_u32 v103, s74, v103
    s_waitcnt lgkmcnt(5)
    v_mul_f32 v56, v40, v72
    v_lshrrev_b32 v10, 2, v7
    s_waitcnt lgkmcnt(4)
    v_mul_f32 v40, v40, v76
    v_mul_f32 v57, v41, v73
    v_lshlrev_b32 v10, 15, v10
    v_mul_f32 v41, v41, v77
    v_mul_f32 v58, v42, v74
    v_and_b32 v1, 3, v7
    v_mul_f32 v42, v42, v78
    v_mul_f32 v59, v43, v75
    v_lshl_add_u32 v10, v1, 5, v10
    v_mul_f32 v43, v43, v79
    v_fma_f32 v56, -v44, v76, v56
    v_fmac_f32 v40, v44, v72
    v_cndmask_b32 v10, v9, v10, vcc
    v_fma_f32 v57, -v45, v77, v57
    v_fmac_f32 v41, v45, v73
    s_lshl_b32 s77, s76, 7
    s_and_b32 s78, s76, 127
    s_lshr_b32 s79, s76, 7
    s_lshl_b32 s79, s79, 10
    s_add_u32 s78, s78, s79
    s_mul_i32 s78, s78, 578
    buffer_load_ushort v16, v8, s[36:39], s78 offen
    v_fma_f32 v58, -v46, v78, v58
    v_fmac_f32 v42, v46, v74
    buffer_load_ushort v24, v8, s[40:43], s78 offen
    v_fma_f32 v59, -v47, v79, v59
    v_fmac_f32 v43, v47, v75
    s_add_u32 s78, s78, 73984
    buffer_load_ushort v17, v8, s[36:39], s78 offen
    v_cvt_pk_f16_f32 v64, v56, v40
    v_cvt_pk_f16_f32 v65, v57, v41
    buffer_load_ushort v25, v8, s[40:43], s78 offen
    v_cvt_pk_f16_f32 v66, v58, v42
    v_cvt_pk_f16_f32 v67, v59, v43
    s_add_u32 s78, s78, 73984
    buffer_load_ushort v18, v8, s[36:39], s78 offen
    s_waitcnt lgkmcnt(3)
    v_mul_f32 v56, v48, v80
    s_waitcnt lgkmcnt(2)
    v_mul_f32 v48, v48, v84
    buffer_load_ushort v26, v8, s[40:43], s78 offen
    v_mul_f32 v57, v49, v81
    v_mul_f32 v49, v49, v85
    s_add_u32 s78, s78, 73984
    buffer_load_ushort v19, v8, s[36:39], s78 offen
    v_mul_f32 v58, v50, v82
    v_mul_f32 v50, v50, v86
    v_mul_f32 v59, v51, v83
    buffer_load_ushort v27, v8, s[40:43], s78 offen
    v_mul_f32 v51, v51, v87
    v_fma_f32 v56, -v52, v84, v56
    s_add_u32 s78, s78, 73984
    buffer_load_ushort v20, v8, s[36:39], s78 offen
    v_fmac_f32 v48, v52, v80
    v_fma_f32 v57, -v53, v85, v57
    buffer_load_ushort v28, v8, s[40:43], s78 offen
    v_fmac_f32 v49, v53, v81
    v_fma_f32 v58, -v54, v86, v58
    s_add_u32 s78, s78, 73984
    buffer_load_ushort v21, v8, s[36:39], s78 offen
    v_fmac_f32 v50, v54, v82
    v_fma_f32 v59, -v55, v87, v59
    buffer_load_ushort v29, v8, s[40:43], s78 offen
    v_fmac_f32 v51, v55, v83
    v_cvt_pk_f16_f32 v68, v56, v48
    s_add_u32 s78, s78, 73984
    buffer_load_ushort v22, v8, s[36:39], s78 offen
    v_cvt_pk_f16_f32 v69, v57, v49
    v_cvt_pk_f16_f32 v70, v58, v50
    buffer_load_ushort v30, v8, s[40:43], s78 offen
    v_cvt_pk_f16_f32 v71, v59, v51
    s_waitcnt lgkmcnt(1)
    v_mfma_f32_16x16x32_f16 v[40:43], v[88:91], v[64:67], 0
    s_add_u32 s78, s78, 73984
    buffer_load_ushort v23, v8, s[36:39], s78 offen
    s_waitcnt lgkmcnt(0)
    v_mfma_f32_16x16x32_f16 v[44:47], v[92:95], v[64:67], 0
    v_mfma_f32_16x16x32_f16 v[48:51], v[88:91], v[68:71], 0
    v_mfma_f32_16x16x32_f16 v[52:55], v[92:95], v[68:71], 0
    buffer_load_ushort v31, v8, s[40:43], s78 offen
    s_nop 4
    v_cvt_pk_f16_f32 v40, v40, v44
    ds_write_b32 v96, v40
    s_add_u32 s80, s70, 0x240000
    s_add_u32 m0, s71, 0xc000
    s_nop 0
    buffer_load_dwordx4 v3, s[16:19], s80 offen lds
    v_cvt_pk_f16_f32 v41, v41, v45
    ds_write_b32 v97, v41
    s_add_u32 s81, s70, 0x240000
    s_add_u32 m0, s71, 0xe000
    s_nop 0
    buffer_load_dwordx4 v4, s[16:19], s81 offen lds
    v_cvt_pk_f16_f32 v42, v42, v46
    ds_write_b32 v98, v42
    s_add_u32 s80, s70, 0x240000
    s_add_u32 m0, s71, 0x10000
    s_nop 0
    buffer_load_dwordx4 v5, s[16:19], s80 offen lds
    v_cvt_pk_f16_f32 v43, v43, v47
    ds_write_b32 v99, v43
    s_add_u32 s81, s70, 0x360000
    s_add_u32 m0, s71, 0x12000
    s_nop 0
    buffer_load_dwordx4 v3, s[16:19], s81 offen lds
    v_cvt_pk_f16_f32 v48, v48, v52
    ds_write_b32 v100, v48
    s_add_u32 s80, s70, 0x360000
    s_add_u32 m0, s71, 0x14000
    s_nop 0
    buffer_load_dwordx4 v4, s[16:19], s80 offen lds
    v_cvt_pk_f16_f32 v49, v49, v53
    ds_write_b32 v101, v49
    s_add_u32 s81, s70, 0x360000
    s_add_u32 m0, s71, 0x16000
    s_nop 0
    buffer_load_dwordx4 v5, s[16:19], s81 offen lds
    v_cvt_pk_f16_f32 v50, v50, v54
    ds_write_b32 v102, v50
    s_add_u32 s80, s70, 0x480000
    s_add_u32 m0, s71, 0x18000
    s_nop 0
    buffer_load_dwordx4 v3, s[16:19], s80 offen lds
    v_cvt_pk_f16_f32 v51, v51, v55
    ds_write_b32 v103, v51
    s_cmp_ge_u32 s88, 4
    s_cbranch_scc1 .Lk1_dma13
    s_add_u32 s81, s70, 0x480000
    s_add_u32 m0, s71, 0x1a000
    s_nop 0
    buffer_load_dwordx4 v4, s[16:19], s81 offen lds
.Lk1_dma13:
    v_lshlrev_b32 v11, 16, v11
    v_lshlrev_b32 v1, 2, v7
    v_add_u32 v1, 0x1b000, v1
    ds_write_b32 v1, v11
    s_waitcnt lgkmcnt(0)
    s_barrier
    s_lshl_b32 s64, s26, 4
    s_lshl_b32 s65, s88, 1
    s_add_u32 s64, s64, s65
    s_mul_i32 s72, s64, 18432
    s_add_u32 s72, s72, 0x3000000
    s_add_u32 s73, s72, 18432
    s_mul_i32 s69, s64, 147456
    s_cmp_ge_u32 s88, 5
    s_cbranch_scc1 .Lp0_nor8
    v_lshlrev_b32 v1, 2, v7
    v_add_u32 v1, 0x22000, v1
    ds_read_b32 v56, v1 offset:0
    ds_read_b32 v57, v1 offset:1160
    ds_read_b32 v58, v1 offset:2320
    ds_read_b32 v59, v1 offset:3480
    ds_read_b32 v60, v1 offset:4640
    ds_read_b32 v61, v1 offset:5800
    ds_read_b32 v62, v1 offset:6960
    ds_read_b32 v63, v1 offset:8120
    s_waitcnt lgkmcnt(7)
    v_cvt_f32_f16 v40, v56
    v_cvt_f32_f16_sdwa v41, v56 dst_sel:DWORD dst_unused:UNUSED_PAD src0_sel:WORD_1
    s_waitcnt lgkmcnt(6)
    v_cvt_f32_f16 v42, v57
    v_cvt_f32_f16_sdwa v43, v57 dst_sel:DWORD dst_unused:UNUSED_PAD src0_sel:WORD_1
    s_waitcnt lgkmcnt(5)
    v_cvt_f32_f16 v44, v58
    v_cvt_f32_f16_sdwa v45, v58 dst_sel:DWORD dst_unused:UNUSED_PAD src0_sel:WORD_1
    s_waitcnt lgkmcnt(4)
    v_cvt_f32_f16 v46, v59
    v_cvt_f32_f16_sdwa v47, v59 dst_sel:DWORD dst_unused:UNUSED_PAD src0_sel:WORD_1
    s_waitcnt lgkmcnt(3)
    v_cvt_f32_f16 v48, v60
    v_cvt_f32_f16_sdwa v49, v60 dst_sel:DWORD dst_unused:UNUSED_PAD src0_sel:WORD_1
    s_waitcnt lgkmcnt(2)
    v_cvt_f32_f16 v50, v61
    v_cvt_f32_f16_sdwa v51, v61 dst_sel:DWORD dst_unused:UNUSED_PAD src0_sel:WORD_1
    s_waitcnt lgkmcnt(1)
    v_cvt_f32_f16 v52, v62
    v_cvt_f32_f16_sdwa v53, v62 dst_sel:DWORD dst_unused:UNUSED_PAD src0_sel:WORD_1
    s_waitcnt lgkmcnt(0)
    v_cvt_f32_f16 v54, v63
    v_cvt_f32_f16_sdwa v55, v63 dst_sel:DWORD dst_unused:UNUSED_PAD src0_sel:WORD_1
    v_add_f32 v56, v40, v48
    v_add_f32 v57, v41, v49
    v_sub_f32 v64, v40, v48
    v_sub_f32 v65, v41, v49
    v_add_f32 v58, v42, v50
    v_add_f32 v59, v43, v51
    v_sub_f32 v66, v42, v50
    v_sub_f32 v67, v43, v51
    v_add_f32 v60, v44, v52
    v_add_f32 v61, v45, v53
    v_sub_f32 v68, v44, v52
    v_sub_f32 v69, v45, v53
    v_add_f32 v62, v46, v54
    v_add_f32 v63, v47, v55
    v_sub_f32 v70, v46, v54
    v_sub_f32 v71, v47, v55
    v_add_f32 v48, v66, v67
    v_sub_f32 v49, v67, v66
    v_sub_f32 v50, v70, v71
    v_add_f32 v51, v71, v70
    v_mul_f32 v66, 0x3f3504f3, v48
    v_mul_f32 v67, 0x3f3504f3, v49
    v_mul_f32 v70, 0xbf3504f3, v50
    v_mul_f32 v71, 0xbf3504f3, v51
    v_add_f32 v40, v56, v60
    v_add_f32 v41, v57, v61
    v_sub_f32 v42, v56, v60
    v_sub_f32 v43, v57, v61
    v_add_f32 v44, v58, v62
    v_add_f32 v45, v59, v63
    v_sub_f32 v46, v58, v62
    v_sub_f32 v47, v59, v63
    v_add_f32 v56, v40, v44
    v_add_f32 v57, v41, v45
    v_sub_f32 v60, v40, v44
    v_sub_f32 v61, v41, v45
    v_add_f32 v58, v42, v47
    v_sub_f32 v59, v43, v46
    v_sub_f32 v62, v42, v47
    v_add_f32 v63, v43, v46
    v_add_f32 v48, v64, v69
    v_sub_f32 v49, v65, v68
    v_sub_f32 v50, v64, v69
    v_add_f32 v51, v65, v68
    v_add_f32 v52, v66, v70
    v_add_f32 v53, v67, v71
    v_sub_f32 v54, v66, v70
    v_sub_f32 v55, v67, v71
    v_add_f32 v64, v48, v52
    v_add_f32 v65, v49, v53
    v_sub_f32 v68, v48, v52
    v_sub_f32 v69, v49, v53
    v_add_f32 v66, v50, v55
    v_sub_f32 v67, v51, v54
    v_sub_f32 v70, v50, v55
    v_add_f32 v71, v51, v54
    v_mul_f32 v40, s48, v56
    v_mul_f32 v41, s49, v56
    v_mul_f32 v56, s49, v57
    v_mul_f32 v57, s48, v57
    v_sub_f32 v40, v40, v56
    v_add_f32 v41, v41, v57
    v_cvt_pk_f16_f32 v96, v40, v41
    v_mul_f32 v42, s50, v64
    v_mul_f32 v43, s51, v64
    v_mul_f32 v64, s51, v65
    v_mul_f32 v65, s50, v65
    v_sub_f32 v42, v42, v64
    v_add_f32 v43, v43, v65
    v_cvt_pk_f16_f32 v97, v42, v43
    v_mul_f32 v44, s52, v58
    v_mul_f32 v45, s53, v58
    v_mul_f32 v58, s53, v59
    v_mul_f32 v59, s52, v59
    v_sub_f32 v44, v44, v58
    v_add_f32 v45, v45, v59
    v_cvt_pk_f16_f32 v98, v44, v45
    v_mul_f32 v46, s54, v66
    v_mul_f32 v47, s55, v66
    v_mul_f32 v66, s55, v67
    v_mul_f32 v67, s54, v67
    v_sub_f32 v46, v46, v66
    v_add_f32 v47, v47, v67
    v_cvt_pk_f16_f32 v99, v46, v47
    v_mul_f32 v48, s56, v60
    v_mul_f32 v49, s57, v60
    v_mul_f32 v60, s57, v61
    v_mul_f32 v61, s56, v61
    v_sub_f32 v48, v48, v60
    v_add_f32 v49, v49, v61
    v_cvt_pk_f16_f32 v100, v48, v49
    v_mul_f32 v50, s58, v68
    v_mul_f32 v51, s59, v68
    v_mul_f32 v68, s59, v69
    v_mul_f32 v69, s58, v69
    v_sub_f32 v50, v50, v68
    v_add_f32 v51, v51, v69
    v_cvt_pk_f16_f32 v101, v50, v51
    v_mul_f32 v52, s60, v62
    v_mul_f32 v53, s61, v62
    v_mul_f32 v62, s61, v63
    v_mul_f32 v63, s60, v63
    v_sub_f32 v52, v52, v62
    v_add_f32 v53, v53, v63
    v_cvt_pk_f16_f32 v102, v52, v53
    v_mul_f32 v54, s62, v70
    v_mul_f32 v55, s63, v70
    v_mul_f32 v70, s63, v71
    v_mul_f32 v71, s62, v71
    v_sub_f32 v54, v54, v70
    v_add_f32 v55, v55, v71
    v_cvt_pk_f16_f32 v103, v54, v55
    s_waitcnt vmcnt(21)
    v_lshl_or_b32 v104, v24, 16, v16
    s_waitcnt vmcnt(19)
    v_lshl_or_b32 v105, v25, 16, v17
    s_waitcnt vmcnt(17)
    v_lshl_or_b32 v106, v26, 16, v18
    s_waitcnt vmcnt(15)
    v_lshl_or_b32 v107, v27, 16, v19
    s_waitcnt vmcnt(13)
    v_lshl_or_b32 v108, v28, 16, v20
    s_waitcnt vmcnt(11)
    v_lshl_or_b32 v109, v29, 16, v21
    s_waitcnt vmcnt(9)
    v_lshl_or_b32 v110, v30, 16, v22
    s_waitcnt vmcnt(7)
    v_lshl_or_b32 v111, v31, 16, v23
    v_and_b32 v24, 0x7fff7fff, v104
    v_and_b32 v25, 0x7fff7fff, v105
    v_and_b32 v26, 0x7fff7fff, v106
    v_and_b32 v27, 0x7fff7fff, v107
    v_and_b32 v28, 0x7fff7fff, v108
    v_and_b32 v29, 0x7fff7fff, v109
    v_and_b32 v30, 0x7fff7fff, v110
    v_and_b32 v31, 0x7fff7fff, v111
    v_pk_max_u16 v24, v24, v28
    v_pk_max_u16 v25, v25, v29
    v_pk_max_u16 v26, v26, v30
    v_pk_max_u16 v27, v27, v31
    v_pk_max_u16 v24, v24, v26
    v_pk_max_u16 v25, v25, v27
    v_pk_max_u16 v24, v24, v25
    v_lshrrev_b32 v25, 16, v24
    v_and_b32 v24, 0xffff, v24
    v_max_u32 v24, v24, v25
    s_nop 1
    v_max_u32_dpp v24, v24, v24 row_ror:8 row_mask:0xf bank_mask:0xf
    s_nop 1
    v_max_u32_dpp v24, v24, v24 row_ror:4 row_mask:0xf bank_mask:0xf
    s_nop 1
    v_max_u32_dpp v24, v24, v24 row_ror:2 row_mask:0xf bank_mask:0xf
    s_nop 1
    v_max_u32_dpp v24, v24, v24 row_ror:1 row_mask:0xf bank_mask:0xf
    v_mov_b32 v25, v24
    s_nop 1
    v_permlane16_swap_b32 v24, v25
    v_max_u32 v24, v24, v25
    v_mov_b32 v25, v24
    s_nop 1
    v_permlane32_swap_b32 v24, v25
    v_max_u32 v24, v24, v25
    v_mov_b32 v25, 0x26d00
    s_mov_b64 exec, 1
    ds_max_u32 v25, v24
    s_mov_b64 exec, -1
    s_lshl_b32 s74, s88, 11
    v_lshlrev_b32 v1, 5, v0
    v_add_u32 v1, s74, v1
    v_add_u32 v1, 0x1e000, v1
    v_add_u32 v2, s74, v6
    v_add_u32 v2, 0x1e000, v2
    ds_write_b128 v1, v[96:99]
    ds_write_b128 v1, v[100:103] offset:16
    ds_write_b128 v1, v[104:107] offset:25728
    ds_write_b128 v1, v[108:111] offset:25744
    s_waitcnt lgkmcnt(0)
    ds_read_b128 v[96:99], v2
    ds_read_b128 v[100:103], v2 offset:1024
    ds_read_b128 v[104:107], v2 offset:25728
    ds_read_b128 v[108:111], v2 offset:26752
    v_lshrrev_b32 v1, 3, v0
    s_lshl_b32 s74, s88, 4
    v_add_u32 v1, s74, v1
    v_and_b32 v2, 0x70, v6
    v_mov_b32 v9, 0x7ffffff0
    v_cmp_gt_u32 vcc, 73, v1
    v_lshl_add_u32 v10, v1, 15, v2
    v_add_u32 v8, 0x40000, v10
    v_cndmask_b32 v10, v9, v10, vcc
    v_cmp_gt_u32 vcc, 65, v1
    s_nop 1
    v_cndmask_b32 v8, v9, v8, vcc
    s_waitcnt lgkmcnt(0)
.Lp0_nor8:
    s_lshl_b32 s75, s26, 5
    s_cmp_lg_u32 s88, 7
    s_cbranch_scc1 .Lwf2_done
    v_and_b32 v72, 31, v0
    v_add_u32 v72, s75, v72
    v_lshlrev_b32 v72, 3, v72
    s_mov_b32 s87, 0
.Lwf2_loop:
    s_mov_b32 s86, 0x3300000
    buffer_load_dwordx2 v[76:77], v72, s[92:95], s86 offen sc1
    s_waitcnt vmcnt(0)
    v_xor_b32 v76, s90, v76
    v_xor_b32 v77, s91, v77
    v_lshrrev_b32 v75, 4, v77
    v_or_b32 v74, v76, v75
    v_cmp_ne_u32 vcc, 0, v74
    s_nop 4
    s_cbranch_vccz .Lwf2_ok
    s_sleep 1
    s_add_u32 s87, s87, 1
    s_cmp_lt_u32 s87, 0x40000
    s_cbranch_scc1 .Lwf2_loop
.Lwf2_ok:
.Lwf2_done:
    s_barrier
    buffer_load_dwordx4 v[112:115], v6, s[92:95], s72 offen offset:0 sc1
    buffer_load_dwordx4 v[116:119], v6, s[92:95], s73 offen offset:0 sc1
    buffer_load_dwordx4 v[120:123], v6, s[92:95], s72 offen offset:1024 sc1
    buffer_load_dwordx4 v[124:127], v6, s[92:95], s73 offen offset:1024 sc1
    buffer_load_dwordx4 v[128:131], v6, s[92:95], s72 offen offset:2048 sc1
    buffer_load_dwordx4 v[132:135], v6, s[92:95], s73 offen offset:2048 sc1
    buffer_load_dwordx4 v[136:139], v6, s[92:95], s72 offen offset:3072 sc1
    buffer_load_dwordx4 v[140:143], v6, s[92:95], s73 offen offset:3072 sc1
    s_cmp_ge_u32 s88, 5
    s_cbranch_scc1 .Lp0_nor9
    s_add_u32 s74, s77, 0x2400000
    s_add_u32 s75, s77, 0x2700000
    buffer_store_dwordx4 v[96:99], v10, s[92:95], s74 offen sc1
    buffer_store_dwordx4 v[100:103], v8, s[92:95], s74 offen sc1
    buffer_store_dwordx4 v[104:107], v10, s[92:95], s75 offen sc1
    buffer_store_dwordx4 v[108:111], v8, s[92:95], s75 offen sc1
.Lp0_nor9:
    v_lshrrev_b32 v7, 4, v0
    v_lshlrev_b32 v13, 4, v7
    v_add_u32 v13, 0x1b000, v13
    ds_read_b128 v[40:43], v13 offset:0
    ds_read_b128 v[44:47], v13 offset:64
    ds_read_b128 v[48:51], v13 offset:128
    ds_read_b128 v[52:55], v13 offset:192
    ds_read_b128 v[56:59], v13 offset:256
    ds_read_b128 v[60:63], v13 offset:320
    v_add_u32 v10, s69, v6
    v_add_u32 v11, 0x24000, v10
    v_lshrrev_b32 v7, 2, v0
    v_mul_u32_u24 v1, 192, v7
    v_and_b32 v8, 3, v0
    v_lshl_add_u32 v1, v8, 3, v1
    v_mul_u32_u24 v9, 96, v7
    v_lshl_add_u32 v9, v8, 3, v9
    v_bfe_u32 v8, v0, 4, 1
    v_lshlrev_b32 v8, 5, v8
    v_sub_u32 v2, v1, v8
    v_add_u32 v2, 32, v2
    v_add_u32 v1, v1, v8
    v_mov_b32 v12, 0xbdd2d3e8
    s_mul_i32 s65, s27, 9
    s_add_u32 s68, s65, s67
    s_lshl_b32 s68, s68, 9
    s_add_u32 s69, s68, 4096
    s_sub_u32 s64, s68, 512
    s_cmp_eq_u32 s67, 1
    s_cselect_b32 s69, s64, s69
    s_load_dwordx2 s[32:33], s[0:1], 48
    s_mov_b32 s34, 0x510000
    s_mov_b32 s35, 0x20000
    s_lshr_b32 s39, s84, 1
    s_lshl_b32 s39, s39, 5
    s_add_u32 s39, s39, s85
    s_mul_i32 s44, s39, 41472
    s_mul_i32 s39, s88, 5248
    s_add_u32 s44, s44, s39
    s_mov_b32 s47, s44
    s_waitcnt lgkmcnt(0)
    s_barrier
    s_waitcnt vmcnt(28)
    ds_read_b64_tr_b16 v[16:17], v1 offset:0
    s_waitcnt vmcnt(24)
    ds_read_b64_tr_b16 v[18:19], v1 offset:3072
    s_waitcnt vmcnt(20)
    ds_read_b64_tr_b16 v[20:21], v2 offset:0
    s_waitcnt vmcnt(16)
    ds_read_b64_tr_b16 v[22:23], v2 offset:3072
    ds_read_b64_tr_b16 v[24:25], v1 offset:64
    ds_read_b64_tr_b16 v[26:27], v1 offset:3136
    ds_read_b64_tr_b16 v[28:29], v2 offset:64
    s_waitcnt vmcnt(15)
    ds_read_b64_tr_b16 v[30:31], v2 offset:3136
    ds_read_b64_tr_b16 v[32:33], v1 offset:128
    ds_read_b64_tr_b16 v[34:35], v1 offset:3200
    s_waitcnt vmcnt(7) lgkmcnt(8)
    v_mfma_f32_16x16x32_bf16 v[64:67], v[16:19], v[112:115], v[40:43]
    ds_read_b64_tr_b16 v[36:37], v2 offset:128
    s_waitcnt vmcnt(6)
    v_mfma_f32_16x16x32_bf16 v[72:75], v[16:19], v[116:119], v[40:43]
    ds_read_b64_tr_b16 v[38:39], v2 offset:3200
    s_add_u32 s72, s72, 4096
    buffer_load_dwordx4 v[144:147], v6, s[92:95], s72 offen offset:0 sc1
    s_waitcnt lgkmcnt(8)
    v_mfma_f32_16x16x32_bf16 v[68:71], v[20:23], v[112:115], v[44:47]
    ds_read_b64_tr_b16 v[16:17], v1 offset:6144
    v_mfma_f32_16x16x32_bf16 v[76:79], v[20:23], v[116:119], v[44:47]
    ds_read_b64_tr_b16 v[18:19], v1 offset:9216
    s_add_u32 s73, s73, 4096
    buffer_load_dwordx4 v[148:151], v6, s[92:95], s73 offen offset:0 sc1
    s_waitcnt lgkmcnt(8)
    v_mfma_f32_16x16x32_bf16 v[80:83], v[24:27], v[112:115], v[48:51]
    ds_read_b64_tr_b16 v[20:21], v2 offset:6144
    v_mfma_f32_16x16x32_bf16 v[88:91], v[24:27], v[116:119], v[48:51]
    ds_read_b64_tr_b16 v[22:23], v2 offset:9216
    buffer_load_dwordx4 v[152:155], v6, s[92:95], s72 offen offset:1024 sc1
    s_waitcnt lgkmcnt(8)
    v_mfma_f32_16x16x32_bf16 v[84:87], v[28:31], v[112:115], v[52:55]
    ds_read_b64_tr_b16 v[24:25], v1 offset:6208
    v_mfma_f32_16x16x32_bf16 v[92:95], v[28:31], v[116:119], v[52:55]
    ds_read_b64_tr_b16 v[26:27], v1 offset:9280
    buffer_load_dwordx4 v[156:159], v6, s[92:95], s73 offen offset:1024 sc1
    s_waitcnt lgkmcnt(8)
    v_mfma_f32_16x16x32_bf16 v[96:99], v[32:35], v[112:115], v[56:59]
    ds_read_b64_tr_b16 v[28:29], v2 offset:6208
    v_mfma_f32_16x16x32_bf16 v[104:107], v[32:35], v[116:119], v[56:59]
    ds_read_b64_tr_b16 v[30:31], v2 offset:9280
    buffer_load_dwordx4 v[160:163], v6, s[92:95], s72 offen offset:2048 sc1
    s_waitcnt lgkmcnt(8)
    v_mfma_f32_16x16x32_bf16 v[100:103], v[36:39], v[112:115], v[60:63]
    ds_read_b64_tr_b16 v[32:33], v1 offset:6272
    v_mfma_f32_16x16x32_bf16 v[108:111], v[36:39], v[116:119], v[60:63]
    ds_read_b64_tr_b16 v[34:35], v1 offset:9344
    buffer_load_dwordx4 v[164:167], v6, s[92:95], s73 offen offset:2048 sc1
    s_waitcnt vmcnt(11) lgkmcnt(8)
    v_mfma_f32_16x16x32_bf16 v[64:67], v[16:19], v[120:123], v[64:67]
    ds_read_b64_tr_b16 v[36:37], v2 offset:6272
    s_waitcnt vmcnt(10)
    v_mfma_f32_16x16x32_bf16 v[72:75], v[16:19], v[124:127], v[72:75]
    ds_read_b64_tr_b16 v[38:39], v2 offset:9344
    buffer_load_dwordx4 v[168:171], v6, s[92:95], s72 offen offset:3072 sc1
    s_waitcnt lgkmcnt(8)
    v_mfma_f32_16x16x32_bf16 v[68:71], v[20:23], v[120:123], v[68:71]
    ds_read_b64_tr_b16 v[16:17], v1 offset:12288
    v_mfma_f32_16x16x32_bf16 v[76:79], v[20:23], v[124:127], v[76:79]
    ds_read_b64_tr_b16 v[18:19], v1 offset:15360
    buffer_load_dwordx4 v[172:175], v6, s[92:95], s73 offen offset:3072 sc1
    s_waitcnt lgkmcnt(8)
    v_mfma_f32_16x16x32_bf16 v[80:83], v[24:27], v[120:123], v[80:83]
    ds_read_b64_tr_b16 v[20:21], v2 offset:12288
    v_mfma_f32_16x16x32_bf16 v[88:91], v[24:27], v[124:127], v[88:91]
    ds_read_b64_tr_b16 v[22:23], v2 offset:15360
    s_add_u32 s72, s72, 4096
    buffer_load_dwordx4 v[176:179], v6, s[92:95], s72 offen offset:0 sc1
    s_waitcnt lgkmcnt(8)
    v_mfma_f32_16x16x32_bf16 v[84:87], v[28:31], v[120:123], v[84:87]
    ds_read_b64_tr_b16 v[24:25], v1 offset:12352
    v_mfma_f32_16x16x32_bf16 v[92:95], v[28:31], v[124:127], v[92:95]
    ds_read_b64_tr_b16 v[26:27], v1 offset:15424
    s_add_u32 s73, s73, 4096
    buffer_load_dwordx4 v[180:183], v6, s[92:95], s73 offen offset:0 sc1
    s_waitcnt lgkmcnt(8)
    v_mfma_f32_16x16x32_bf16 v[96:99], v[32:35], v[120:123], v[96:99]
    ds_read_b64_tr_b16 v[28:29], v2 offset:12352
    v_mfma_f32_16x16x32_bf16 v[104:107], v[32:35], v[124:127], v[104:107]
    ds_read_b64_tr_b16 v[30:31], v2 offset:15424
    buffer_load_dwordx4 v[184:187], v6, s[92:95], s72 offen offset:1024 sc1
    s_waitcnt lgkmcnt(8)
    v_mfma_f32_16x16x32_bf16 v[100:103], v[36:39], v[120:123], v[100:103]
    ds_read_b64_tr_b16 v[32:33], v1 offset:12416
    v_mfma_f32_16x16x32_bf16 v[108:111], v[36:39], v[124:127], v[108:111]
    ds_read_b64_tr_b16 v[34:35], v1 offset:15488
    buffer_load_dwordx4 v[188:191], v6, s[92:95], s73 offen offset:1024 sc1
    s_barrier
    s_waitcnt vmcnt(15) lgkmcnt(8)
    v_mfma_f32_16x16x32_bf16 v[64:67], v[16:19], v[128:131], v[64:67]
    ds_read_b64_tr_b16 v[36:37], v2 offset:12416
    s_waitcnt vmcnt(14)
    v_mfma_f32_16x16x32_bf16 v[72:75], v[16:19], v[132:135], v[72:75]
    ds_read_b64_tr_b16 v[38:39], v2 offset:15488
    s_waitcnt lgkmcnt(8)
    v_mfma_f32_16x16x32_bf16 v[68:71], v[20:23], v[128:131], v[68:71]
    ds_read_b64_tr_b16 v[16:17], v1 offset:18432
    v_mfma_f32_16x16x32_bf16 v[76:79], v[20:23], v[132:135], v[76:79]
    ds_read_b64_tr_b16 v[18:19], v1 offset:21504
    s_waitcnt lgkmcnt(8)
    v_mfma_f32_16x16x32_bf16 v[80:83], v[24:27], v[128:131], v[80:83]
    ds_read_b64_tr_b16 v[20:21], v2 offset:18432
    s_cmp_lg_u32 s88, 0
    s_cbranch_scc1 .Lp0_nowm
    v_mov_b32 v14, 0x26d00
    ds_read_b32 v15, v14
    s_lshl_b32 s74, s2, 2
    s_add_u32 s74, s74, 0x2d00000
    v_mov_b32 v14, 0
    s_waitcnt lgkmcnt(0)
    buffer_store_dword v15, v14, s[92:95], s74 offen sc1
.Lp0_nowm:
    v_mfma_f32_16x16x32_bf16 v[88:91], v[24:27], v[132:135], v[88:91]
    ds_read_b64_tr_b16 v[22:23], v2 offset:21504
    s_waitcnt lgkmcnt(8)
    v_mfma_f32_16x16x32_bf16 v[84:87], v[28:31], v[128:131], v[84:87]
    ds_read_b64_tr_b16 v[24:25], v1 offset:18496
    v_mfma_f32_16x16x32_bf16 v[92:95], v[28:31], v[132:135], v[92:95]
    ds_read_b64_tr_b16 v[26:27], v1 offset:21568
    s_waitcnt lgkmcnt(8)
    v_mfma_f32_16x16x32_bf16 v[96:99], v[32:35], v[128:131], v[96:99]
    ds_read_b64_tr_b16 v[28:29], v2 offset:18496
    v_mfma_f32_16x16x32_bf16 v[104:107], v[32:35], v[132:135], v[104:107]
    ds_read_b64_tr_b16 v[30:31], v2 offset:21568
    buffer_load_dwordx4 v[192:195], v6, s[92:95], s72 offen offset:2048 sc1
    s_waitcnt lgkmcnt(8)
    v_mfma_f32_16x16x32_bf16 v[100:103], v[36:39], v[128:131], v[100:103]
    ds_read_b64_tr_b16 v[32:33], v1 offset:18560
    v_mfma_f32_16x16x32_bf16 v[108:111], v[36:39], v[132:135], v[108:111]
    ds_read_b64_tr_b16 v[34:35], v1 offset:21632
    s_waitcnt vmcnt(14) lgkmcnt(8)
    v_mfma_f32_16x16x32_bf16 v[64:67], v[16:19], v[136:139], v[64:67]
    ds_read_b64_tr_b16 v[36:37], v2 offset:18560
    s_waitcnt vmcnt(13)
    v_mfma_f32_16x16x32_bf16 v[72:75], v[16:19], v[140:143], v[72:75]
    ds_read_b64_tr_b16 v[38:39], v2 offset:21632
    s_waitcnt lgkmcnt(8)
    v_mfma_f32_16x16x32_bf16 v[68:71], v[20:23], v[136:139], v[68:71]
    buffer_load_dwordx4 v[196:199], v6, s[92:95], s73 offen offset:2048 sc1
    ds_read_b64_tr_b16 v[16:17], v1 offset:24576
    v_mfma_f32_16x16x32_bf16 v[76:79], v[20:23], v[140:143], v[76:79]
    ds_read_b64_tr_b16 v[18:19], v1 offset:27648
    s_waitcnt lgkmcnt(8)
    v_mfma_f32_16x16x32_bf16 v[80:83], v[24:27], v[136:139], v[80:83]
    ds_read_b64_tr_b16 v[20:21], v2 offset:24576
    v_mfma_f32_16x16x32_bf16 v[88:91], v[24:27], v[140:143], v[88:91]
    ds_read_b64_tr_b16 v[22:23], v2 offset:27648
    s_waitcnt lgkmcnt(8)
    v_mfma_f32_16x16x32_bf16 v[84:87], v[28:31], v[136:139], v[84:87]
    ds_read_b64_tr_b16 v[24:25], v1 offset:24640
    v_mfma_f32_16x16x32_bf16 v[92:95], v[28:31], v[140:143], v[92:95]
    buffer_load_dwordx4 v[200:203], v6, s[92:95], s72 offen offset:3072 sc1
    ds_read_b64_tr_b16 v[26:27], v1 offset:27712
    s_waitcnt lgkmcnt(8)
    v_mfma_f32_16x16x32_bf16 v[96:99], v[32:35], v[136:139], v[96:99]
    ds_read_b64_tr_b16 v[28:29], v2 offset:24640
    v_mfma_f32_16x16x32_bf16 v[104:107], v[32:35], v[140:143], v[104:107]
    ds_read_b64_tr_b16 v[30:31], v2 offset:27712
    s_waitcnt lgkmcnt(8)
    v_mfma_f32_16x16x32_bf16 v[100:103], v[36:39], v[136:139], v[100:103]
    ds_read_b64_tr_b16 v[32:33], v1 offset:24704
    v_mfma_f32_16x16x32_bf16 v[108:111], v[36:39], v[140:143], v[108:111]
    ds_read_b64_tr_b16 v[34:35], v1 offset:27776
    buffer_load_dwordx4 v[204:207], v6, s[92:95], s73 offen offset:3072 sc1
    s_barrier
    s_waitcnt vmcnt(15) lgkmcnt(8)
    v_mfma_f32_16x16x32_bf16 v[64:67], v[16:19], v[144:147], v[64:67]
    ds_read_b64_tr_b16 v[36:37], v2 offset:24704
    s_waitcnt vmcnt(14)
    v_mfma_f32_16x16x32_bf16 v[72:75], v[16:19], v[148:151], v[72:75]
    ds_read_b64_tr_b16 v[38:39], v2 offset:27776
    s_waitcnt lgkmcnt(8)
    v_mfma_f32_16x16x32_bf16 v[68:71], v[20:23], v[144:147], v[68:71]
    ds_read_b64_tr_b16 v[16:17], v1 offset:30720
    v_mfma_f32_16x16x32_bf16 v[76:79], v[20:23], v[148:151], v[76:79]
    ds_read_b64_tr_b16 v[18:19], v1 offset:33792
    s_waitcnt lgkmcnt(8)
    v_mfma_f32_16x16x32_bf16 v[80:83], v[24:27], v[144:147], v[80:83]
    ds_read_b64_tr_b16 v[20:21], v2 offset:30720
    v_mfma_f32_16x16x32_bf16 v[88:91], v[24:27], v[148:151], v[88:91]
    ds_read_b64_tr_b16 v[22:23], v2 offset:33792
    s_add_u32 s72, s72, 4096
    buffer_load_dwordx4 v[208:211], v6, s[92:95], s72 offen offset:0 sc1
    s_waitcnt lgkmcnt(8)
    v_mfma_f32_16x16x32_bf16 v[84:87], v[28:31], v[144:147], v[84:87]
    ds_read_b64_tr_b16 v[24:25], v1 offset:30784
    v_mfma_f32_16x16x32_bf16 v[92:95], v[28:31], v[148:151], v[92:95]
    ds_read_b64_tr_b16 v[26:27], v1 offset:33856
    s_waitcnt lgkmcnt(8)
    v_mfma_f32_16x16x32_bf16 v[96:99], v[32:35], v[144:147], v[96:99]
    ds_read_b64_tr_b16 v[28:29], v2 offset:30784
    v_mfma_f32_16x16x32_bf16 v[104:107], v[32:35], v[148:151], v[104:107]
    ds_read_b64_tr_b16 v[30:31], v2 offset:33856
    s_waitcnt lgkmcnt(8)
    v_mfma_f32_16x16x32_bf16 v[100:103], v[36:39], v[144:147], v[100:103]
    ds_read_b64_tr_b16 v[32:33], v1 offset:30848
    v_mfma_f32_16x16x32_bf16 v[108:111], v[36:39], v[148:151], v[108:111]
    ds_read_b64_tr_b16 v[34:35], v1 offset:33920
    s_add_u32 s73, s73, 4096
    buffer_load_dwordx4 v[212:215], v6, s[92:95], s73 offen offset:0 sc1
    s_waitcnt vmcnt(15) lgkmcnt(8)
    v_mfma_f32_16x16x32_bf16 v[64:67], v[16:19], v[152:155], v[64:67]
    ds_read_b64_tr_b16 v[36:37], v2 offset:30848
    s_waitcnt vmcnt(14)
    v_mfma_f32_16x16x32_bf16 v[72:75], v[16:19], v[156:159], v[72:75]
    ds_read_b64_tr_b16 v[38:39], v2 offset:33920
    s_waitcnt lgkmcnt(8)
    v_mfma_f32_16x16x32_bf16 v[68:71], v[20:23], v[152:155], v[68:71]
    ds_read_b64_tr_b16 v[16:17], v1 offset:36864
    v_mfma_f32_16x16x32_bf16 v[76:79], v[20:23], v[156:159], v[76:79]
    ds_read_b64_tr_b16 v[18:19], v1 offset:39936
    s_waitcnt lgkmcnt(8)
    v_mfma_f32_16x16x32_bf16 v[80:83], v[24:27], v[152:155], v[80:83]
    ds_read_b64_tr_b16 v[20:21], v2 offset:36864
    v_mfma_f32_16x16x32_bf16 v[88:91], v[24:27], v[156:159], v[88:91]
    ds_read_b64_tr_b16 v[22:23], v2 offset:39936
    buffer_load_dwordx4 v[216:219], v6, s[92:95], s72 offen offset:1024 sc1
    s_waitcnt lgkmcnt(8)
    v_mfma_f32_16x16x32_bf16 v[84:87], v[28:31], v[152:155], v[84:87]
    ds_read_b64_tr_b16 v[24:25], v1 offset:36928
    v_mfma_f32_16x16x32_bf16 v[92:95], v[28:31], v[156:159], v[92:95]
    ds_read_b64_tr_b16 v[26:27], v1 offset:40000
    s_waitcnt lgkmcnt(8)
    v_mfma_f32_16x16x32_bf16 v[96:99], v[32:35], v[152:155], v[96:99]
    ds_read_b64_tr_b16 v[28:29], v2 offset:36928
    v_mfma_f32_16x16x32_bf16 v[104:107], v[32:35], v[156:159], v[104:107]
    ds_read_b64_tr_b16 v[30:31], v2 offset:40000
    s_waitcnt lgkmcnt(8)
    v_mfma_f32_16x16x32_bf16 v[100:103], v[36:39], v[152:155], v[100:103]
    ds_read_b64_tr_b16 v[32:33], v1 offset:36992
    v_mfma_f32_16x16x32_bf16 v[108:111], v[36:39], v[156:159], v[108:111]
    ds_read_b64_tr_b16 v[34:35], v1 offset:40064
    buffer_load_dwordx4 v[220:223], v6, s[92:95], s73 offen offset:1024 sc1
    s_barrier
    s_waitcnt vmcnt(15) lgkmcnt(8)
    v_mfma_f32_16x16x32_bf16 v[64:67], v[16:19], v[160:163], v[64:67]
    ds_read_b64_tr_b16 v[36:37], v2 offset:36992
    s_waitcnt vmcnt(14)
    v_mfma_f32_16x16x32_bf16 v[72:75], v[16:19], v[164:167], v[72:75]
    ds_read_b64_tr_b16 v[38:39], v2 offset:40064
    s_waitcnt lgkmcnt(8)
    v_mfma_f32_16x16x32_bf16 v[68:71], v[20:23], v[160:163], v[68:71]
    ds_read_b64_tr_b16 v[16:17], v1 offset:43008
    v_mfma_f32_16x16x32_bf16 v[76:79], v[20:23], v[164:167], v[76:79]
    ds_read_b64_tr_b16 v[18:19], v1 offset:46080
    s_waitcnt lgkmcnt(8)
    v_mfma_f32_16x16x32_bf16 v[80:83], v[24:27], v[160:163], v[80:83]
    ds_read_b64_tr_b16 v[20:21], v2 offset:43008
    v_mfma_f32_16x16x32_bf16 v[88:91], v[24:27], v[164:167], v[88:91]
    ds_read_b64_tr_b16 v[22:23], v2 offset:46080
    buffer_load_dwordx4 v[224:227], v6, s[92:95], s72 offen offset:2048 sc1
    s_waitcnt lgkmcnt(8)
    v_mfma_f32_16x16x32_bf16 v[84:87], v[28:31], v[160:163], v[84:87]
    ds_read_b64_tr_b16 v[24:25], v1 offset:43072
    v_mfma_f32_16x16x32_bf16 v[92:95], v[28:31], v[164:167], v[92:95]
    ds_read_b64_tr_b16 v[26:27], v1 offset:46144
    s_waitcnt lgkmcnt(8)
    v_mfma_f32_16x16x32_bf16 v[96:99], v[32:35], v[160:163], v[96:99]
    ds_read_b64_tr_b16 v[28:29], v2 offset:43072
    v_mfma_f32_16x16x32_bf16 v[104:107], v[32:35], v[164:167], v[104:107]
    ds_read_b64_tr_b16 v[30:31], v2 offset:46144
    s_waitcnt lgkmcnt(8)
    v_mfma_f32_16x16x32_bf16 v[100:103], v[36:39], v[160:163], v[100:103]
    ds_read_b64_tr_b16 v[32:33], v1 offset:43136
    v_mfma_f32_16x16x32_bf16 v[108:111], v[36:39], v[164:167], v[108:111]
    ds_read_b64_tr_b16 v[34:35], v1 offset:46208
    buffer_load_dwordx4 v[228:231], v6, s[92:95], s73 offen offset:2048 sc1
    s_waitcnt vmcnt(15) lgkmcnt(8)
    v_mfma_f32_16x16x32_bf16 v[64:67], v[16:19], v[168:171], v[64:67]
    ds_read_b64_tr_b16 v[36:37], v2 offset:43136
    s_waitcnt vmcnt(14)
    v_mfma_f32_16x16x32_bf16 v[72:75], v[16:19], v[172:175], v[72:75]
    ds_read_b64_tr_b16 v[38:39], v2 offset:46208
    s_waitcnt lgkmcnt(8)
    v_mfma_f32_16x16x32_bf16 v[68:71], v[20:23], v[168:171], v[68:71]
    ds_read_b64_tr_b16 v[16:17], v1 offset:49152
    v_mfma_f32_16x16x32_bf16 v[76:79], v[20:23], v[172:175], v[76:79]
    ds_read_b64_tr_b16 v[18:19], v1 offset:52224
    s_waitcnt lgkmcnt(8)
    v_mfma_f32_16x16x32_bf16 v[80:83], v[24:27], v[168:171], v[80:83]
    ds_read_b64_tr_b16 v[20:21], v2 offset:49152
    v_mfma_f32_16x16x32_bf16 v[88:91], v[24:27], v[172:175], v[88:91]
    ds_read_b64_tr_b16 v[22:23], v2 offset:52224
    buffer_load_dwordx4 v[232:235], v6, s[92:95], s72 offen offset:3072 sc1
    s_waitcnt lgkmcnt(8)
    v_mfma_f32_16x16x32_bf16 v[84:87], v[28:31], v[168:171], v[84:87]
    ds_read_b64_tr_b16 v[24:25], v1 offset:49216
    v_mfma_f32_16x16x32_bf16 v[92:95], v[28:31], v[172:175], v[92:95]
    ds_read_b64_tr_b16 v[26:27], v1 offset:52288
    s_waitcnt lgkmcnt(8)
    v_mfma_f32_16x16x32_bf16 v[96:99], v[32:35], v[168:171], v[96:99]
    ds_read_b64_tr_b16 v[28:29], v2 offset:49216
    v_mfma_f32_16x16x32_bf16 v[104:107], v[32:35], v[172:175], v[104:107]
    ds_read_b64_tr_b16 v[30:31], v2 offset:52288
    s_waitcnt lgkmcnt(8)
    v_mfma_f32_16x16x32_bf16 v[100:103], v[36:39], v[168:171], v[100:103]
    ds_read_b64_tr_b16 v[32:33], v1 offset:49280
    v_mfma_f32_16x16x32_bf16 v[108:111], v[36:39], v[172:175], v[108:111]
    ds_read_b64_tr_b16 v[34:35], v1 offset:52352
    buffer_load_dwordx4 v[236:239], v6, s[92:95], s73 offen offset:3072 sc1
    s_waitcnt vmcnt(12)
    s_barrier
    s_waitcnt lgkmcnt(8)
    v_mfma_f32_16x16x32_bf16 v[64:67], v[16:19], v[176:179], v[64:67]
    ds_read_b64_tr_b16 v[36:37], v2 offset:49280
    s_cmp_lg_u32 s88, 7
    s_cbranch_scc1 .Lpub3
    s_lshl_b32 s86, s76, 3
    s_add_u32 s86, s86, 0x3301800
    v_mov_b32 v60, s90
    v_mov_b32 v61, s91
    v_mov_b32 v62, 0
    s_mov_b64 exec, 1
    buffer_store_dwordx2 v[60:61], v62, s[92:95], s86 offen sc1
    s_mov_b64 exec, -1
.Lpub3:
    v_mfma_f32_16x16x32_bf16 v[72:75], v[16:19], v[180:183], v[72:75]
    s_add_u32 s72, s72, 4096
    buffer_load_dwordx4 v[240:243], v6, s[92:95], s72 offen offset:0 sc1
    ds_read_b64_tr_b16 v[38:39], v2 offset:52352
    s_add_u32 s73, s73, 4096
    buffer_load_dwordx4 v[244:247], v6, s[92:95], s73 offen offset:0 sc1
    s_waitcnt lgkmcnt(8)
    v_mfma_f32_16x16x32_bf16 v[68:71], v[20:23], v[176:179], v[68:71]
    s_lshl_b32 s64, s88, 6
    s_mov_b32 s65, 0x2aaab
    s_lshl_b32 s82, s67, 5
    s_add_u32 s82, s82, 192
    s_mul_i32 s83, s67, 288
    v_add_u32 v3, s64, v0
    ds_read_b64_tr_b16 v[16:17], v1 offset:55296
    v_mul_u32_u24 v7, s65, v3
    v_mfma_f32_16x16x32_bf16 v[76:79], v[20:23], v[180:183], v[76:79]
    v_lshrrev_b32 v7, 20, v7
    ds_read_b64_tr_b16 v[18:19], v1 offset:58368
    v_mul_u32_u24 v8, 6, v7
    s_waitcnt lgkmcnt(8)
    v_mfma_f32_16x16x32_bf16 v[80:83], v[24:27], v[176:179], v[80:83]
    ds_read_b64_tr_b16 v[20:21], v2 offset:55296
    v_sub_u32 v3, v3, v8
    v_mfma_f32_16x16x32_bf16 v[88:91], v[24:27], v[180:183], v[88:91]
    v_lshrrev_b32 v8, 2, v3
    ds_read_b64_tr_b16 v[22:23], v2 offset:58368
    v_mul_u32_u24 v8, s83, v8
    s_waitcnt lgkmcnt(8)
    v_mfma_f32_16x16x32_bf16 v[84:87], v[28:31], v[176:179], v[84:87]
    v_lshlrev_b32 v3, 4, v3
    ds_read_b64_tr_b16 v[24:25], v1 offset:55360
    v_add_u32 v3, s82, v3
    v_mfma_f32_16x16x32_bf16 v[92:95], v[28:31], v[180:183], v[92:95]
    v_sub_u32 v3, v3, v8
    ds_read_b64_tr_b16 v[26:27], v1 offset:58432
    v_mul_u32_u24 v7, 9216, v7
    s_waitcnt lgkmcnt(8)
    v_mfma_f32_16x16x32_bf16 v[96:99], v[32:35], v[176:179], v[96:99]
    ds_read_b64_tr_b16 v[28:29], v2 offset:55360
    v_add_u32 v3, v3, v7
    v_mfma_f32_16x16x32_bf16 v[104:107], v[32:35], v[180:183], v[104:107]
    v_add_u32 v4, s64, v0
    ds_read_b64_tr_b16 v[30:31], v2 offset:58432
    v_add_u32 v4, 512, v4
    s_waitcnt lgkmcnt(8)
    v_mfma_f32_16x16x32_bf16 v[100:103], v[36:39], v[176:179], v[100:103]
    v_mul_u32_u24 v7, s65, v4
    ds_read_b64_tr_b16 v[32:33], v1 offset:55424
    v_lshrrev_b32 v7, 20, v7
    v_mfma_f32_16x16x32_bf16 v[108:111], v[36:39], v[180:183], v[108:111]
    v_mul_u32_u24 v8, 6, v7
    ds_read_b64_tr_b16 v[34:35], v1 offset:58496
    v_sub_u32 v4, v4, v8
    s_waitcnt lgkmcnt(8)
    v_mfma_f32_16x16x32_bf16 v[64:67], v[16:19], v[184:187], v[64:67]
    v_lshrrev_b32 v8, 2, v4
    ds_read_b64_tr_b16 v[36:37], v2 offset:55424
    v_mfma_f32_16x16x32_bf16 v[72:75], v[16:19], v[188:191], v[72:75]
    v_mul_u32_u24 v8, s83, v8
    ds_read_b64_tr_b16 v[38:39], v2 offset:58496
    v_lshlrev_b32 v4, 4, v4
    s_waitcnt lgkmcnt(8)
    v_mfma_f32_16x16x32_bf16 v[68:71], v[20:23], v[184:187], v[68:71]
    v_add_u32 v4, s82, v4
    v_add_u32 v1, 0xf000, v1
    v_sub_u32 v4, v4, v8
    ds_read_b64_tr_b16 v[16:17], v1 offset:0
    v_mul_u32_u24 v7, 9216, v7
    v_mfma_f32_16x16x32_bf16 v[76:79], v[20:23], v[188:191], v[76:79]
    v_add_u32 v4, v4, v7
    ds_read_b64_tr_b16 v[18:19], v1 offset:3072
    v_add_u32 v5, s64, v0
    s_waitcnt lgkmcnt(8)
    v_mfma_f32_16x16x32_bf16 v[80:83], v[24:27], v[184:187], v[80:83]
    v_add_u32 v2, 0xf000, v2
    v_add_u32 v5, 1024, v5
    ds_read_b64_tr_b16 v[20:21], v2 offset:0
    v_mul_u32_u24 v7, s65, v5
    v_mfma_f32_16x16x32_bf16 v[88:91], v[24:27], v[188:191], v[88:91]
    v_lshrrev_b32 v7, 20, v7
    ds_read_b64_tr_b16 v[22:23], v2 offset:3072
    v_mul_u32_u24 v8, 6, v7
    s_waitcnt lgkmcnt(8)
    v_mfma_f32_16x16x32_bf16 v[84:87], v[28:31], v[184:187], v[84:87]
    v_sub_u32 v5, v5, v8
    ds_read_b64_tr_b16 v[24:25], v1 offset:64
    v_lshrrev_b32 v8, 2, v5
    v_mfma_f32_16x16x32_bf16 v[92:95], v[28:31], v[188:191], v[92:95]
    v_mul_u32_u24 v8, s83, v8
    ds_read_b64_tr_b16 v[26:27], v1 offset:3136
    s_waitcnt lgkmcnt(8)
    v_mfma_f32_16x16x32_bf16 v[96:99], v[32:35], v[184:187], v[96:99]
    v_lshlrev_b32 v5, 4, v5
    ds_read_b64_tr_b16 v[28:29], v2 offset:64
    v_add_u32 v5, s82, v5
    v_mfma_f32_16x16x32_bf16 v[104:107], v[32:35], v[188:191], v[104:107]
    v_sub_u32 v5, v5, v8
    ds_read_b64_tr_b16 v[30:31], v2 offset:3136
    v_mul_u32_u24 v7, 9216, v7
    s_waitcnt lgkmcnt(8)
    v_mfma_f32_16x16x32_bf16 v[100:103], v[36:39], v[184:187], v[100:103]
    v_add_u32 v5, v5, v7
    ds_read_b64_tr_b16 v[32:33], v1 offset:128
    s_add_u32 s80, s66, 0x0
    s_add_u32 m0, s71, 0x1c000
    s_nop 0
    buffer_load_dwordx4 v3, s[16:19], s80 offen lds
    v_mfma_f32_16x16x32_bf16 v[108:111], v[36:39], v[188:191], v[108:111]
    buffer_load_dwordx4 v[248:251], v6, s[92:95], s72 offen offset:1024 sc1
    ds_read_b64_tr_b16 v[34:35], v1 offset:3200
    buffer_load_dwordx4 v[252:255], v6, s[92:95], s73 offen offset:1024 sc1
    s_barrier
    s_waitcnt vmcnt(16) lgkmcnt(8)
    v_mfma_f32_16x16x32_bf16 v[64:67], v[16:19], v[192:195], v[64:67]
    ds_read_b64_tr_b16 v[36:37], v2 offset:128
    s_waitcnt vmcnt(15)
    v_mfma_f32_16x16x32_bf16 v[72:75], v[16:19], v[196:199], v[72:75]
    ds_read_b64_tr_b16 v[38:39], v2 offset:3200
    s_waitcnt lgkmcnt(8)
    v_mfma_f32_16x16x32_bf16 v[68:71], v[20:23], v[192:195], v[68:71]
    ds_read_b64_tr_b16 v[16:17], v1 offset:6144
    v_mfma_f32_16x16x32_bf16 v[76:79], v[20:23], v[196:199], v[76:79]
    ds_read_b64_tr_b16 v[18:19], v1 offset:9216
    s_waitcnt lgkmcnt(8)
    v_mfma_f32_16x16x32_bf16 v[80:83], v[24:27], v[192:195], v[80:83]
    ds_read_b64_tr_b16 v[20:21], v2 offset:6144
    v_mfma_f32_16x16x32_bf16 v[88:91], v[24:27], v[196:199], v[88:91]
    ds_read_b64_tr_b16 v[22:23], v2 offset:9216
    s_waitcnt lgkmcnt(8)
    v_mfma_f32_16x16x32_bf16 v[84:87], v[28:31], v[192:195], v[84:87]
    ds_read_b64_tr_b16 v[24:25], v1 offset:6208
    v_mfma_f32_16x16x32_bf16 v[92:95], v[28:31], v[196:199], v[92:95]
    ds_read_b64_tr_b16 v[26:27], v1 offset:9280
    s_waitcnt lgkmcnt(8)
    v_mfma_f32_16x16x32_bf16 v[96:99], v[32:35], v[192:195], v[96:99]
    ds_read_b64_tr_b16 v[28:29], v2 offset:6208
    v_mfma_f32_16x16x32_bf16 v[104:107], v[32:35], v[196:199], v[104:107]
    ds_read_b64_tr_b16 v[30:31], v2 offset:9280
    s_waitcnt lgkmcnt(8)
    v_mfma_f32_16x16x32_bf16 v[100:103], v[36:39], v[192:195], v[100:103]
    ds_read_b64_tr_b16 v[32:33], v1 offset:6272
    v_mfma_f32_16x16x32_bf16 v[108:111], v[36:39], v[196:199], v[108:111]
    ds_read_b64_tr_b16 v[34:35], v1 offset:9344
    s_add_u32 s81, s66, 0x0
    s_add_u32 m0, s71, 0x1e000
    s_nop 0
    buffer_load_dwordx4 v4, s[16:19], s81 offen lds
    s_waitcnt vmcnt(15) lgkmcnt(8)
    v_mfma_f32_16x16x32_bf16 v[64:67], v[16:19], v[200:203], v[64:67]
    ds_read_b64_tr_b16 v[36:37], v2 offset:6272
    s_waitcnt vmcnt(14)
    v_mfma_f32_16x16x32_bf16 v[72:75], v[16:19], v[204:207], v[72:75]
    ds_read_b64_tr_b16 v[38:39], v2 offset:9344
    s_waitcnt lgkmcnt(8)
    v_mfma_f32_16x16x32_bf16 v[68:71], v[20:23], v[200:203], v[68:71]
    ds_read_b64_tr_b16 v[16:17], v1 offset:12288
    v_mfma_f32_16x16x32_bf16 v[76:79], v[20:23], v[204:207], v[76:79]
    ds_read_b64_tr_b16 v[18:19], v1 offset:15360
    s_waitcnt lgkmcnt(8)
    v_mfma_f32_16x16x32_bf16 v[80:83], v[24:27], v[200:203], v[80:83]
    ds_read_b64_tr_b16 v[20:21], v2 offset:12288
    v_mfma_f32_16x16x32_bf16 v[88:91], v[24:27], v[204:207], v[88:91]
    ds_read_b64_tr_b16 v[22:23], v2 offset:15360
    s_waitcnt lgkmcnt(8)
    v_mfma_f32_16x16x32_bf16 v[84:87], v[28:31], v[200:203], v[84:87]
    ds_read_b64_tr_b16 v[24:25], v1 offset:12352
    v_mfma_f32_16x16x32_bf16 v[92:95], v[28:31], v[204:207], v[92:95]
    ds_read_b64_tr_b16 v[26:27], v1 offset:15424
    s_waitcnt lgkmcnt(8)
    v_mfma_f32_16x16x32_bf16 v[96:99], v[32:35], v[200:203], v[96:99]
    ds_read_b64_tr_b16 v[28:29], v2 offset:12352
    v_mfma_f32_16x16x32_bf16 v[104:107], v[32:35], v[204:207], v[104:107]
    ds_read_b64_tr_b16 v[30:31], v2 offset:15424
    s_waitcnt lgkmcnt(8)
    v_mfma_f32_16x16x32_bf16 v[100:103], v[36:39], v[200:203], v[100:103]
    ds_read_b64_tr_b16 v[32:33], v1 offset:12416
    v_mfma_f32_16x16x32_bf16 v[108:111], v[36:39], v[204:207], v[108:111]
    ds_read_b64_tr_b16 v[34:35], v1 offset:15488
    s_add_u32 s80, s66, 0x0
    s_add_u32 m0, s71, 0x20000
    s_nop 0
    buffer_load_dwordx4 v5, s[16:19], s80 offen lds
    s_barrier
    s_waitcnt vmcnt(14) lgkmcnt(8)
    v_mfma_f32_16x16x32_bf16 v[64:67], v[16:19], v[208:211], v[64:67]
    ds_read_b64_tr_b16 v[36:37], v2 offset:12416
    s_waitcnt vmcnt(13)
    v_mfma_f32_16x16x32_bf16 v[72:75], v[16:19], v[212:215], v[72:75]
    ds_read_b64_tr_b16 v[38:39], v2 offset:15488
    s_waitcnt lgkmcnt(8)
    v_mfma_f32_16x16x32_bf16 v[68:71], v[20:23], v[208:211], v[68:71]
    ds_read_b64_tr_b16 v[16:17], v1 offset:18432
    v_mfma_f32_16x16x32_bf16 v[76:79], v[20:23], v[212:215], v[76:79]
    ds_read_b64_tr_b16 v[18:19], v1 offset:21504
    s_waitcnt lgkmcnt(8)
    v_mfma_f32_16x16x32_bf16 v[80:83], v[24:27], v[208:211], v[80:83]
    ds_read_b64_tr_b16 v[20:21], v2 offset:18432
    v_mfma_f32_16x16x32_bf16 v[88:91], v[24:27], v[212:215], v[88:91]
    ds_read_b64_tr_b16 v[22:23], v2 offset:21504
    s_waitcnt lgkmcnt(8)
    v_mfma_f32_16x16x32_bf16 v[84:87], v[28:31], v[208:211], v[84:87]
    ds_read_b64_tr_b16 v[24:25], v1 offset:18496
    v_mfma_f32_16x16x32_bf16 v[92:95], v[28:31], v[212:215], v[92:95]
    ds_read_b64_tr_b16 v[26:27], v1 offset:21568
    s_add_u32 s81, s66, 0x240000
    s_add_u32 m0, s71, 0x22000
    s_nop 0
    buffer_load_dwordx4 v3, s[16:19], s81 offen lds
    s_waitcnt lgkmcnt(8)
    v_mfma_f32_16x16x32_bf16 v[96:99], v[32:35], v[208:211], v[96:99]
    ds_read_b64_tr_b16 v[28:29], v2 offset:18496
    v_mfma_f32_16x16x32_bf16 v[104:107], v[32:35], v[212:215], v[104:107]
    ds_read_b64_tr_b16 v[30:31], v2 offset:21568
    s_waitcnt lgkmcnt(8)
    v_mfma_f32_16x16x32_bf16 v[100:103], v[36:39], v[208:211], v[100:103]
    ds_read_b64_tr_b16 v[32:33], v1 offset:18560
    v_mfma_f32_16x16x32_bf16 v[108:111], v[36:39], v[212:215], v[108:111]
    ds_read_b64_tr_b16 v[34:35], v1 offset:21632
    s_waitcnt vmcnt(13) lgkmcnt(8)
    v_mfma_f32_16x16x32_bf16 v[64:67], v[16:19], v[216:219], v[64:67]
    ds_read_b64_tr_b16 v[36:37], v2 offset:18560
    s_waitcnt vmcnt(12)
    v_mfma_f32_16x16x32_bf16 v[72:75], v[16:19], v[220:223], v[72:75]
    ds_read_b64_tr_b16 v[38:39], v2 offset:21632
    s_waitcnt lgkmcnt(8)
    v_mfma_f32_16x16x32_bf16 v[68:71], v[20:23], v[216:219], v[68:71]
    ds_read_b64_tr_b16 v[16:17], v1 offset:24576
    v_mfma_f32_16x16x32_bf16 v[76:79], v[20:23], v[220:223], v[76:79]
    ds_read_b64_tr_b16 v[18:19], v1 offset:27648
    s_cmp_lg_u32 s88, 0
    s_cbranch_scc1 .Ltw2_0
    v_cmp_gt_u32 vcc, 41, v0
    v_lshlrev_b32 v14, 7, v0
    v_mov_b32 v15, 0x7ffffff0
    v_cndmask_b32 v14, v15, v14, vcc
    buffer_load_dword v15, v14, s[32:35], s44 offen
.Ltw2_0:
    s_waitcnt lgkmcnt(8)
    v_mfma_f32_16x16x32_bf16 v[80:83], v[24:27], v[216:219], v[80:83]
    ds_read_b64_tr_b16 v[20:21], v2 offset:24576
    v_mfma_f32_16x16x32_bf16 v[88:91], v[24:27], v[220:223], v[88:91]
    ds_read_b64_tr_b16 v[22:23], v2 offset:27648
    s_waitcnt lgkmcnt(8)
    v_mfma_f32_16x16x32_bf16 v[84:87], v[28:31], v[216:219], v[84:87]
    ds_read_b64_tr_b16 v[24:25], v1 offset:24640
    v_mfma_f32_16x16x32_bf16 v[92:95], v[28:31], v[220:223], v[92:95]
    ds_read_b64_tr_b16 v[26:27], v1 offset:27712
    s_waitcnt lgkmcnt(8)
    v_mfma_f32_16x16x32_bf16 v[96:99], v[32:35], v[216:219], v[96:99]
    ds_read_b64_tr_b16 v[28:29], v2 offset:24640
    v_mfma_f32_16x16x32_bf16 v[104:107], v[32:35], v[220:223], v[104:107]
    ds_read_b64_tr_b16 v[30:31], v2 offset:27712
    s_waitcnt lgkmcnt(8)
    v_mfma_f32_16x16x32_bf16 v[100:103], v[36:39], v[216:219], v[100:103]
    ds_read_b64_tr_b16 v[32:33], v1 offset:24704
    v_mfma_f32_16x16x32_bf16 v[108:111], v[36:39], v[220:223], v[108:111]
    ds_read_b64_tr_b16 v[34:35], v1 offset:27776
    s_cmp_lg_u32 s88, 1
    s_cbranch_scc1 .Ltw2_1
    v_cmp_gt_u32 vcc, 41, v0
    v_lshlrev_b32 v14, 7, v0
    s_waitcnt vmcnt(0)
    v_mov_b32 v15, 0x7ffffff0
    v_cndmask_b32 v14, v15, v14, vcc
    buffer_load_dword v15, v14, s[32:35], s44 offen
.Ltw2_1:
    s_barrier
    s_waitcnt vmcnt(11) lgkmcnt(8)
    v_mfma_f32_16x16x32_bf16 v[64:67], v[16:19], v[224:227], v[64:67]
    ds_read_b64_tr_b16 v[36:37], v2 offset:24704
    s_waitcnt vmcnt(10)
    v_mfma_f32_16x16x32_bf16 v[72:75], v[16:19], v[228:231], v[72:75]
    ds_read_b64_tr_b16 v[38:39], v2 offset:27776
    s_waitcnt lgkmcnt(8)
    v_mfma_f32_16x16x32_bf16 v[68:71], v[20:23], v[224:227], v[68:71]
    ds_read_b64_tr_b16 v[16:17], v1 offset:30720
    v_mfma_f32_16x16x32_bf16 v[76:79], v[20:23], v[228:231], v[76:79]
    ds_read_b64_tr_b16 v[18:19], v1 offset:33792
    s_waitcnt lgkmcnt(8)
    v_mfma_f32_16x16x32_bf16 v[80:83], v[24:27], v[224:227], v[80:83]
    ds_read_b64_tr_b16 v[20:21], v2 offset:30720
    v_mfma_f32_16x16x32_bf16 v[88:91], v[24:27], v[228:231], v[88:91]
    ds_read_b64_tr_b16 v[22:23], v2 offset:33792
    s_add_u32 s80, s66, 0x240000
    s_add_u32 m0, s71, 0x24000
    s_nop 0
    buffer_load_dwordx4 v4, s[16:19], s80 offen lds
    s_waitcnt lgkmcnt(8)
    v_mfma_f32_16x16x32_bf16 v[84:87], v[28:31], v[224:227], v[84:87]
    ds_read_b64_tr_b16 v[24:25], v1 offset:30784
    v_mfma_f32_16x16x32_bf16 v[92:95], v[28:31], v[228:231], v[92:95]
    ds_read_b64_tr_b16 v[26:27], v1 offset:33856
    s_waitcnt lgkmcnt(8)
    v_mfma_f32_16x16x32_bf16 v[96:99], v[32:35], v[224:227], v[96:99]
    ds_read_b64_tr_b16 v[28:29], v2 offset:30784
    v_mfma_f32_16x16x32_bf16 v[104:107], v[32:35], v[228:231], v[104:107]
    ds_read_b64_tr_b16 v[30:31], v2 offset:33856
    s_waitcnt lgkmcnt(8)
    v_mfma_f32_16x16x32_bf16 v[100:103], v[36:39], v[224:227], v[100:103]
    ds_read_b64_tr_b16 v[32:33], v1 offset:30848
    v_mfma_f32_16x16x32_bf16 v[108:111], v[36:39], v[228:231], v[108:111]
    ds_read_b64_tr_b16 v[34:35], v1 offset:33920
    s_add_u32 s81, s66, 0x240000
    s_add_u32 m0, s71, 0x26000
    s_nop 0
    buffer_load_dwordx4 v5, s[16:19], s81 offen lds
    s_waitcnt vmcnt(11) lgkmcnt(8)
    v_mfma_f32_16x16x32_bf16 v[64:67], v[16:19], v[232:235], v[64:67]
    ds_read_b64_tr_b16 v[36:37], v2 offset:30848
    s_waitcnt vmcnt(10)
    v_mfma_f32_16x16x32_bf16 v[72:75], v[16:19], v[236:239], v[72:75]
    ds_read_b64_tr_b16 v[38:39], v2 offset:33920
    s_waitcnt lgkmcnt(8)
    v_mfma_f32_16x16x32_bf16 v[68:71], v[20:23], v[232:235], v[68:71]
    ds_read_b64_tr_b16 v[16:17], v1 offset:36864
    v_mfma_f32_16x16x32_bf16 v[76:79], v[20:23], v[236:239], v[76:79]
    ds_read_b64_tr_b16 v[18:19], v1 offset:39936
    s_waitcnt lgkmcnt(8)
    v_mfma_f32_16x16x32_bf16 v[80:83], v[24:27], v[232:235], v[80:83]
    ds_read_b64_tr_b16 v[20:21], v2 offset:36864
    v_mfma_f32_16x16x32_bf16 v[88:91], v[24:27], v[236:239], v[88:91]
    ds_read_b64_tr_b16 v[22:23], v2 offset:39936
    s_cmp_lg_u32 s88, 2
    s_cbranch_scc1 .Ltw2_2
    v_cmp_gt_u32 vcc, 41, v0
    v_lshlrev_b32 v14, 7, v0
    s_waitcnt vmcnt(2)
    v_mov_b32 v15, 0x7ffffff0
    v_cndmask_b32 v14, v15, v14, vcc
    buffer_load_dword v15, v14, s[32:35], s44 offen
.Ltw2_2:
    s_waitcnt lgkmcnt(8)
    v_mfma_f32_16x16x32_bf16 v[84:87], v[28:31], v[232:235], v[84:87]
    ds_read_b64_tr_b16 v[24:25], v1 offset:36928
    v_mfma_f32_16x16x32_bf16 v[92:95], v[28:31], v[236:239], v[92:95]
    ds_read_b64_tr_b16 v[26:27], v1 offset:40000
    s_waitcnt lgkmcnt(8)
    v_mfma_f32_16x16x32_bf16 v[96:99], v[32:35], v[232:235], v[96:99]
    ds_read_b64_tr_b16 v[28:29], v2 offset:36928
    v_mfma_f32_16x16x32_bf16 v[104:107], v[32:35], v[236:239], v[104:107]
    ds_read_b64_tr_b16 v[30:31], v2 offset:40000
    s_waitcnt lgkmcnt(8)
    v_mfma_f32_16x16x32_bf16 v[100:103], v[36:39], v[232:235], v[100:103]
    ds_read_b64_tr_b16 v[32:33], v1 offset:36992
    v_mfma_f32_16x16x32_bf16 v[108:111], v[36:39], v[236:239], v[108:111]
    ds_read_b64_tr_b16 v[34:35], v1 offset:40064
    s_cmp_lg_u32 s88, 3
    s_cbranch_scc1 .Ltw2_3
    v_cmp_gt_u32 vcc, 41, v0
    v_lshlrev_b32 v14, 7, v0
    s_waitcnt vmcnt(0)
    v_mov_b32 v15, 0x7ffffff0
    v_cndmask_b32 v14, v15, v14, vcc
    buffer_load_dword v15, v14, s[32:35], s44 offen
.Ltw2_3:
    s_waitcnt vmcnt(7)
    s_barrier
    s_waitcnt lgkmcnt(8)
    v_mfma_f32_16x16x32_bf16 v[64:67], v[16:19], v[240:243], v[64:67]
    ds_read_b64_tr_b16 v[36:37], v2 offset:36992
    v_mfma_f32_16x16x32_bf16 v[72:75], v[16:19], v[244:247], v[72:75]
    ds_read_b64_tr_b16 v[38:39], v2 offset:40064
    s_waitcnt lgkmcnt(8)
    v_mfma_f32_16x16x32_bf16 v[68:71], v[20:23], v[240:243], v[68:71]
    ds_read_b64_tr_b16 v[16:17], v1 offset:43008
    s_cmp_ge_u32 s88, 6
    s_cbranch_scc1 .Lk1_dma20
    s_add_u32 s80, s66, 0x480000
    s_add_u32 m0, s71, 0x0
    s_nop 0
    buffer_load_dwordx4 v3, s[16:19], s80 offen lds
.Lk1_dma20:
    v_mfma_f32_16x16x32_bf16 v[76:79], v[20:23], v[244:247], v[76:79]
    ds_read_b64_tr_b16 v[18:19], v1 offset:46080
    s_waitcnt lgkmcnt(8)
    v_mfma_f32_16x16x32_bf16 v[80:83], v[24:27], v[240:243], v[80:83]
    ds_read_b64_tr_b16 v[20:21], v2 offset:43008
    v_mfma_f32_16x16x32_bf16 v[88:91], v[24:27], v[244:247], v[88:91]
    ds_read_b128 v[40:43], v13 offset:384
    ds_read_b64_tr_b16 v[22:23], v2 offset:46080
    s_waitcnt lgkmcnt(9)
    v_mfma_f32_16x16x32_bf16 v[84:87], v[28:31], v[240:243], v[84:87]
    ds_read_b64_tr_b16 v[24:25], v1 offset:43072
    v_mfma_f32_16x16x32_bf16 v[92:95], v[28:31], v[244:247], v[92:95]
    ds_read_b64_tr_b16 v[26:27], v1 offset:46144
    s_waitcnt lgkmcnt(9)
    v_mfma_f32_16x16x32_bf16 v[96:99], v[32:35], v[240:243], v[96:99]
    ds_read_b128 v[48:51], v13 offset:384
    ds_read_b64_tr_b16 v[28:29], v2 offset:43072
    v_mfma_f32_16x16x32_bf16 v[104:107], v[32:35], v[244:247], v[104:107]
    ds_read_b64_tr_b16 v[30:31], v2 offset:46144
    s_waitcnt lgkmcnt(10)
    v_mfma_f32_16x16x32_bf16 v[100:103], v[36:39], v[240:243], v[100:103]
    ds_read_b64_tr_b16 v[32:33], v1 offset:43136
    ds_read_b128 v[44:47], v13 offset:448
    v_mfma_f32_16x16x32_bf16 v[108:111], v[36:39], v[244:247], v[108:111]
    ds_read_b64_tr_b16 v[34:35], v1 offset:46208
    s_waitcnt vmcnt(6) lgkmcnt(11)
    v_mfma_f32_16x16x32_bf16 v[64:67], v[16:19], v[248:251], v[64:67]
    ds_read_b64_tr_b16 v[36:37], v2 offset:43136
    s_waitcnt vmcnt(5)
    v_mfma_f32_16x16x32_bf16 v[72:75], v[16:19], v[252:255], v[72:75]
    ds_read_b64_tr_b16 v[38:39], v2 offset:46208
    ds_read_b128 v[52:55], v13 offset:448
    s_waitcnt lgkmcnt(11)
    v_mfma_f32_16x16x32_bf16 v[68:71], v[20:23], v[248:251], v[68:71]
    v_add_u32 v9, 0x1c000, v9
    ds_read_b64_tr_b16 v[16:17], v9 offset:0
    v_mfma_f32_16x16x32_bf16 v[76:79], v[20:23], v[252:255], v[76:79]
    ds_read_b64_tr_b16 v[18:19], v9 offset:1536
    ds_read_b128 v[56:59], v13 offset:512
    s_waitcnt lgkmcnt(12)
    v_mfma_f32_16x16x32_bf16 v[80:83], v[24:27], v[248:251], v[80:83]
    ds_read_b64_tr_b16 v[20:21], v9 offset:32
    v_mfma_f32_16x16x32_bf16 v[88:91], v[24:27], v[252:255], v[88:91]
    ds_read_b64_tr_b16 v[22:23], v9 offset:1568
    s_waitcnt lgkmcnt(11)
    v_mfma_f32_16x16x32_bf16 v[84:87], v[28:31], v[248:251], v[84:87]
    ds_read_b64_tr_b16 v[24:25], v9 offset:64
    ds_read_b128 v[60:63], v13 offset:512
    v_mfma_f32_16x16x32_bf16 v[92:95], v[28:31], v[252:255], v[92:95]
    ds_read_b64_tr_b16 v[26:27], v9 offset:1600
    s_waitcnt lgkmcnt(11)
    v_mfma_f32_16x16x32_bf16 v[96:99], v[32:35], v[248:251], v[96:99]
    ds_read_b64_tr_b16 v[28:29], v9 offset:3072
    v_mfma_f32_16x16x32_bf16 v[104:107], v[32:35], v[252:255], v[104:107]
    s_cmp_lg_u32 s88, 4
    s_cbranch_scc1 .Ltw2_4
    v_cmp_gt_u32 vcc, 41, v0
    v_lshlrev_b32 v14, 7, v0
    s_waitcnt vmcnt(0)
    v_mov_b32 v15, 0x7ffffff0
    v_cndmask_b32 v14, v15, v14, vcc
    buffer_load_dword v15, v14, s[32:35], s44 offen
.Ltw2_4:
    ds_read_b64_tr_b16 v[30:31], v9 offset:4608
    s_waitcnt lgkmcnt(11)
    v_mfma_f32_16x16x32_bf16 v[100:103], v[36:39], v[248:251], v[100:103]
    ds_read_b64_tr_b16 v[32:33], v9 offset:3104
    v_mfma_f32_16x16x32_bf16 v[108:111], v[36:39], v[252:255], v[108:111]
    ds_read_b64_tr_b16 v[34:35], v9 offset:4640
    s_cmp_lg_u32 s88, 5
    s_cbranch_scc1 .Ltw2_5
    v_cmp_gt_u32 vcc, 41, v0
    v_lshlrev_b32 v14, 7, v0
    s_waitcnt vmcnt(0)
    v_mov_b32 v15, 0x7ffffff0
    v_cndmask_b32 v14, v15, v14, vcc
    buffer_load_dword v15, v14, s[32:35], s44 offen
.Ltw2_5:
    s_waitcnt vmcnt(3)
    s_barrier
    s_waitcnt lgkmcnt(10)
    v_mfma_f32_16x16x32_bf16 v[40:43], v[16:19], v[112:115], v[40:43]
    s_cmp_lg_u32 s88, 6
    s_cbranch_scc1 .Ltw2_6
    v_cmp_gt_u32 vcc, 41, v0
    v_lshlrev_b32 v14, 7, v0
    s_waitcnt vmcnt(0)
    v_mov_b32 v15, 0x7ffffff0
    v_cndmask_b32 v14, v15, v14, vcc
    buffer_load_dword v15, v14, s[32:35], s44 offen
.Ltw2_6:
    s_cmp_lg_u32 s88, 7
    s_cbranch_scc1 .Ltw2_7
    v_cmp_gt_u32 vcc, 41, v0
    v_lshlrev_b32 v14, 7, v0
    s_waitcnt vmcnt(0)
    v_mov_b32 v15, 0x7ffffff0
    v_cndmask_b32 v14, v15, v14, vcc
    buffer_load_dword v15, v14, s[32:35], s44 offen
.Ltw2_7:
    ds_read_b64_tr_b16 v[36:37], v9 offset:3136
    s_lshr_b32 s36, s84, 1
    s_and_b32 s37, s84, 1
    s_lshl_b32 s37, s37, 3
    s_and_b32 s39, s85, 7
    s_add_u32 s37, s37, s39
    s_lshr_b32 s38, s85, 3
    s_mul_i32 s41, s36, 1327104
    s_mul_i32 s39, s38, 288
    s_add_u32 s41, s41, s39
    v_mov_b32 v7, v7
    s_lshl_b32 s39, s88, 6
    s_mov_b32 s40, 0x15556
    v_add_u32 v3, s39, v0
    v_mfma_f32_16x16x32_bf16 v[48:51], v[16:19], v[116:119], v[48:51]
    v_mul_u32_u24 v7, s40, v3
    v_lshrrev_b32 v7, 20, v7
    ds_read_b64_tr_b16 v[38:39], v9 offset:4672
    v_mul_u32_u24 v8, 12, v7
    v_sub_u32 v3, v3, v8
    v_bfe_u32 v8, v7, 2, 1
    s_waitcnt lgkmcnt(9)
    v_mfma_f32_16x16x32_bf16 v[44:47], v[20:23], v[112:115], v[44:47]
    v_lshlrev_b32 v8, 1, v8
    v_xor_b32 v3, v3, v8
    ds_read_b64_tr_b16 v[16:17], v9 offset:6144
    v_lshlrev_b32 v3, 4, v3
    v_bfe_u32 v8, v7, 5, 1
    v_mfma_f32_16x16x32_bf16 v[52:55], v[20:23], v[116:119], v[52:55]
    v_mul_u32_u24 v8, 663552, v8
    v_add_u32 v3, v3, v8
    v_lshrrev_b32 v8, 6, v7
    ds_read_b64_tr_b16 v[18:19], v9 offset:7680
    v_and_b32 v7, 31, v7
    v_lshl_add_u32 v7, v8, 5, v7
    s_waitcnt lgkmcnt(8)
    v_mfma_f32_16x16x32_bf16 v[56:59], v[24:27], v[112:115], v[56:59]
    v_mul_u32_u24 v7, 1152, v7
    v_add_u32 v3, v3, v7
    ds_read_b64_tr_b16 v[20:21], v9 offset:6176
    v_add_u32 v4, s39, v0
    v_add_u32 v4, 512, v4
    v_mul_u32_u24 v7, s40, v4
    v_mfma_f32_16x16x32_bf16 v[60:63], v[24:27], v[116:119], v[60:63]
    v_lshrrev_b32 v7, 20, v7
    v_mul_u32_u24 v8, 12, v7
    ds_read_b64_tr_b16 v[22:23], v9 offset:7712
    v_sub_u32 v4, v4, v8
    v_bfe_u32 v8, v7, 2, 1
    s_waitcnt lgkmcnt(8)
    v_mfma_f32_16x16x32_bf16 v[40:43], v[28:31], v[120:123], v[40:43]
    v_lshlrev_b32 v8, 1, v8
    v_xor_b32 v4, v4, v8
    v_lshlrev_b32 v4, 4, v4
    ds_read_b64_tr_b16 v[24:25], v9 offset:6208
    v_bfe_u32 v8, v7, 5, 1
    v_mul_u32_u24 v8, 663552, v8
    v_mfma_f32_16x16x32_bf16 v[48:51], v[28:31], v[124:127], v[48:51]
    v_add_u32 v4, v4, v8
    v_lshrrev_b32 v8, 6, v7
    ds_read_b64_tr_b16 v[26:27], v9 offset:7744
    v_and_b32 v7, 31, v7
    v_lshl_add_u32 v7, v8, 5, v7
    s_waitcnt lgkmcnt(8)
    v_mfma_f32_16x16x32_bf16 v[44:47], v[32:35], v[120:123], v[44:47]
    v_mul_u32_u24 v7, 1152, v7
    v_add_u32 v4, v4, v7
    v_add_u32 v5, s39, v0
    ds_read_b64_tr_b16 v[28:29], v9 offset:9216
    v_add_u32 v5, 1024, v5
    v_mul_u32_u24 v7, s40, v5
    v_mfma_f32_16x16x32_bf16 v[52:55], v[32:35], v[124:127], v[52:55]
    v_lshrrev_b32 v7, 20, v7
    v_mul_u32_u24 v8, 12, v7
    ds_read_b64_tr_b16 v[30:31], v9 offset:10752
    v_sub_u32 v5, v5, v8
    v_bfe_u32 v8, v7, 2, 1
    v_lshlrev_b32 v8, 1, v8
    s_waitcnt lgkmcnt(8)
    v_mfma_f32_16x16x32_bf16 v[56:59], v[36:39], v[120:123], v[56:59]
    v_xor_b32 v5, v5, v8
    v_lshlrev_b32 v5, 4, v5
    ds_read_b64_tr_b16 v[32:33], v9 offset:9248
    v_bfe_u32 v8, v7, 5, 1
    v_mul_u32_u24 v8, 663552, v8
    v_mfma_f32_16x16x32_bf16 v[60:63], v[36:39], v[124:127], v[60:63]
    v_add_u32 v5, v5, v8
    v_lshrrev_b32 v8, 6, v7
    v_and_b32 v7, 31, v7
    ds_read_b64_tr_b16 v[34:35], v9 offset:10784
    v_lshl_add_u32 v7, v8, 5, v7
    v_mul_u32_u24 v7, 1152, v7
    s_waitcnt lgkmcnt(8)
    v_mfma_f32_16x16x32_bf16 v[40:43], v[16:19], v[128:131], v[40:43]
    v_add_u32 v5, v5, v7
    s_lshl_b32 s49, s84, 2
    s_add_u32 s49, s49, s85
    s_cmp_eq_u32 s2, 32
    s_cselect_b32 s49, 32, s49
    s_add_u32 s49, s49, 256
    s_mov_b32 s48, s76
    v_lshrrev_b32 v7, 1, v0
    ds_read_b64_tr_b16 v[36:37], v9 offset:9280
    v_lshlrev_b32 v7, 7, v7
    v_and_b32 v8, 1, v0
    v_lshl_add_u32 v13, v8, 4, v7
    v_mfma_f32_16x16x32_bf16 v[48:51], v[16:19], v[132:135], v[48:51]
    v_mul_f32 v112, v64, v64
    ds_read_b64_tr_b16 v[38:39], v9 offset:10816
    v_mul_f32 v113, v65, v65
    v_mul_f32 v114, v66, v66
    s_waitcnt lgkmcnt(8)
    v_mfma_f32_16x16x32_bf16 v[44:47], v[20:23], v[128:131], v[44:47]
    v_mul_f32 v115, v67, v67
    v_mul_f32 v116, v68, v68
    ds_read_b64_tr_b16 v[16:17], v9 offset:12288
    v_mul_f32 v117, v69, v69
    v_mul_f32 v118, v70, v70
    v_mfma_f32_16x16x32_bf16 v[52:55], v[20:23], v[132:135], v[52:55]
    v_mul_f32 v119, v71, v71
    v_fmaak_f32 v112, v12, v112, 0xc0135761
    ds_read_b64_tr_b16 v[18:19], v9 offset:13824
    v_fmaak_f32 v113, v12, v113, 0xc0135761
    v_fmaak_f32 v114, v12, v114, 0xc0135761
    s_waitcnt lgkmcnt(8)
    v_mfma_f32_16x16x32_bf16 v[56:59], v[24:27], v[128:131], v[56:59]
    v_fmaak_f32 v115, v12, v115, 0xc0135761
    v_fmaak_f32 v116, v12, v116, 0xc0135761
    ds_read_b64_tr_b16 v[20:21], v9 offset:12320
    v_fmaak_f32 v117, v12, v117, 0xc0135761
    v_fmaak_f32 v118, v12, v118, 0xc0135761
    v_mfma_f32_16x16x32_bf16 v[60:63], v[24:27], v[132:135], v[60:63]
    v_fmaak_f32 v119, v12, v119, 0xc0135761
    v_mul_f32 v112, v112, v64
    ds_read_b64_tr_b16 v[22:23], v9 offset:13856
    v_mul_f32 v113, v113, v65
    v_mul_f32 v114, v114, v66
    s_waitcnt lgkmcnt(8)
    v_mfma_f32_16x16x32_bf16 v[40:43], v[28:31], v[136:139], v[40:43]
    v_mul_f32 v115, v115, v67
    v_mul_f32 v116, v116, v68
    ds_read_b64_tr_b16 v[24:25], v9 offset:12352
    v_mul_f32 v117, v117, v69
    v_mul_f32 v118, v118, v70
    v_mfma_f32_16x16x32_bf16 v[48:51], v[28:31], v[140:143], v[48:51]
    v_mul_f32 v119, v119, v71
    v_exp_f32 v112, v112
    ds_read_b64_tr_b16 v[26:27], v9 offset:13888
    v_exp_f32 v113, v113
    v_exp_f32 v114, v114
    s_waitcnt lgkmcnt(8)
    v_mfma_f32_16x16x32_bf16 v[44:47], v[32:35], v[136:139], v[44:47]
    v_exp_f32 v115, v115
    v_exp_f32 v116, v116
    ds_read_b64_tr_b16 v[28:29], v9 offset:15360
    v_exp_f32 v117, v117
    v_exp_f32 v118, v118
    v_mfma_f32_16x16x32_bf16 v[52:55], v[32:35], v[140:143], v[52:55]
    v_exp_f32 v119, v119
    v_add_f32 v112, 1.0, v112
    ds_read_b64_tr_b16 v[30:31], v9 offset:16896
    v_add_f32 v113, 1.0, v113
    v_add_f32 v114, 1.0, v114
    s_waitcnt lgkmcnt(8)
    v_mfma_f32_16x16x32_bf16 v[56:59], v[36:39], v[136:139], v[56:59]
    v_add_f32 v115, 1.0, v115
    v_add_f32 v116, 1.0, v116
    ds_read_b64_tr_b16 v[32:33], v9 offset:15392
    v_add_f32 v117, 1.0, v117
    v_add_f32 v118, 1.0, v118
    v_mfma_f32_16x16x32_bf16 v[60:63], v[36:39], v[140:143], v[60:63]
    v_add_f32 v119, 1.0, v119
    v_rcp_f32 v112, v112
    ds_read_b64_tr_b16 v[34:35], v9 offset:16928
    v_rcp_f32 v113, v113
    v_rcp_f32 v114, v114
    s_waitcnt vmcnt(2)
    s_nop 0
    s_cmp_lg_u32 s88, 7
    s_cbranch_scc1 .Lwf4_done
    v_and_b32 v128, 63, v0
    v_lshlrev_b32 v128, 3, v128
    s_mov_b32 s87, 0
.Lwf4_loop:
    s_mov_b32 s86, 0x3301800
    buffer_load_dwordx2 v[132:133], v128, s[92:95], s86 offen sc1
    s_mov_b32 s86, 0x3301a00
    buffer_load_dwordx2 v[134:135], v128, s[92:95], s86 offen sc1
    s_mov_b32 s86, 0x3301c00
    buffer_load_dwordx2 v[136:137], v128, s[92:95], s86 offen sc1
    s_mov_b32 s86, 0x3301e00
    buffer_load_dwordx2 v[138:139], v128, s[92:95], s86 offen sc1
    s_waitcnt vmcnt(0)
    v_xor_b32 v132, s90, v132
    v_xor_b32 v133, s91, v133
    v_lshrrev_b32 v131, 4, v133
    v_or_b32 v130, v132, v131
    v_xor_b32 v134, s90, v134
    v_xor_b32 v135, s91, v135
    v_lshrrev_b32 v131, 4, v135
    v_or3_b32 v130, v134, v131, v130
    v_xor_b32 v136, s90, v136
    v_xor_b32 v137, s91, v137
    v_lshrrev_b32 v131, 4, v137
    v_or3_b32 v130, v136, v131, v130
    v_xor_b32 v138, s90, v138
    v_xor_b32 v139, s91, v139
    v_lshrrev_b32 v131, 4, v139
    v_or3_b32 v130, v138, v131, v130
    v_cmp_ne_u32 vcc, 0, v130
    s_nop 4
    s_cbranch_vccz .Lwf4_ok
    s_sleep 1
    s_add_u32 s87, s87, 1
    s_cmp_lt_u32 s87, 0x40000
    s_cbranch_scc1 .Lwf4_loop
.Lwf4_ok:
.Lwf4_done:
    s_barrier
    s_waitcnt lgkmcnt(8)
    v_mfma_f32_16x16x32_bf16 v[40:43], v[16:19], v[144:147], v[40:43]
    v_rcp_f32 v115, v115
    v_rcp_f32 v116, v116
    ds_read_b64_tr_b16 v[36:37], v9 offset:15424
    v_rcp_f32 v117, v117
    v_rcp_f32 v118, v118
    v_mfma_f32_16x16x32_bf16 v[48:51], v[16:19], v[148:151], v[48:51]
    v_rcp_f32 v119, v119
    v_mul_f32 v112, v64, v112
    ds_read_b64_tr_b16 v[38:39], v9 offset:16960
    v_mul_f32 v113, v65, v113
    v_mul_f32 v114, v66, v114
    s_waitcnt lgkmcnt(8)
    v_mfma_f32_16x16x32_bf16 v[44:47], v[20:23], v[144:147], v[44:47]
    v_mul_f32 v115, v67, v115
    v_mul_f32 v116, v68, v116
    ds_read_b64_tr_b16 v[16:17], v9 offset:18432
    v_mul_f32 v117, v69, v117
    v_mul_f32 v118, v70, v118
    v_mfma_f32_16x16x32_bf16 v[52:55], v[20:23], v[148:151], v[52:55]
    v_mul_f32 v119, v71, v119
    v_cvt_pk_bf16_f32 v64, v112, v113
    ds_read_b64_tr_b16 v[18:19], v9 offset:19968
    v_cvt_pk_bf16_f32 v65, v114, v115
    v_cvt_pk_bf16_f32 v66, v116, v117
    s_waitcnt lgkmcnt(8)
    v_mfma_f32_16x16x32_bf16 v[56:59], v[24:27], v[144:147], v[56:59]
    s_lshr_b32 s52, s48, 2
    s_lshl_b32 s52, s52, 15
    s_and_b32 s53, s48, 3
    s_lshl_b32 s53, s53, 5
    s_add_u32 s52, s52, s53
    s_lshl_b32 s53, s88, 12
    s_add_u32 s52, s52, s53
    s_add_u32 s53, s52, 0x2400000
    s_add_u32 m0, s71, 0x2000
    s_nop 0
    buffer_load_dwordx4 v13, s[92:95], s53 offen sc1 lds
    v_cvt_pk_bf16_f32 v67, v118, v119
    ds_read_b64_tr_b16 v[20:21], v9 offset:18464
    buffer_store_dwordx4 v[64:67], v10, s[92:95], s68 offen offset:0 sc1
    v_mul_f32 v120, v72, v72
    v_mfma_f32_16x16x32_bf16 v[60:63], v[24:27], v[148:151], v[60:63]
    v_mul_f32 v121, v73, v73
    v_mul_f32 v122, v74, v74
    ds_read_b64_tr_b16 v[22:23], v9 offset:20000
    v_mul_f32 v123, v75, v75
    v_mul_f32 v124, v76, v76
    s_waitcnt lgkmcnt(8)
    v_mfma_f32_16x16x32_bf16 v[40:43], v[28:31], v[152:155], v[40:43]
    v_mul_f32 v125, v77, v77
    v_mul_f32 v126, v78, v78
    ds_read_b64_tr_b16 v[24:25], v9 offset:18496
    v_mul_f32 v127, v79, v79
    v_fmaak_f32 v120, v12, v120, 0xc0135761
    v_mfma_f32_16x16x32_bf16 v[48:51], v[28:31], v[156:159], v[48:51]
    v_fmaak_f32 v121, v12, v121, 0xc0135761
    v_fmaak_f32 v122, v12, v122, 0xc0135761
    ds_read_b64_tr_b16 v[26:27], v9 offset:20032
    v_fmaak_f32 v123, v12, v123, 0xc0135761
    v_fmaak_f32 v124, v12, v124, 0xc0135761
    s_waitcnt lgkmcnt(8)
    v_mfma_f32_16x16x32_bf16 v[44:47], v[32:35], v[152:155], v[44:47]
    s_add_u32 s53, s52, 0x2700000
    s_add_u32 m0, s71, 0x4000
    s_nop 0
    buffer_load_dwordx4 v13, s[92:95], s53 offen sc1 lds
    v_fmaak_f32 v125, v12, v125, 0xc0135761
    ds_read_b64_tr_b16 v[28:29], v9 offset:21504
    v_fmaak_f32 v126, v12, v126, 0xc0135761
    v_fmaak_f32 v127, v12, v127, 0xc0135761
    v_mfma_f32_16x16x32_bf16 v[52:55], v[32:35], v[156:159], v[52:55]
    v_mul_f32 v120, v120, v72
    v_mul_f32 v121, v121, v73
    ds_read_b64_tr_b16 v[30:31], v9 offset:23040
    v_mul_f32 v122, v122, v74
    v_mul_f32 v123, v123, v75
    s_waitcnt lgkmcnt(8)
    v_mfma_f32_16x16x32_bf16 v[56:59], v[36:39], v[152:155], v[56:59]
    v_mul_f32 v124, v124, v76
    v_mul_f32 v125, v125, v77
    ds_read_b64_tr_b16 v[32:33], v9 offset:21536
    v_mul_f32 v126, v126, v78
    v_mul_f32 v127, v127, v79
    v_mfma_f32_16x16x32_bf16 v[60:63], v[36:39], v[156:159], v[60:63]
    v_exp_f32 v120, v120
    v_exp_f32 v121, v121
    ds_read_b64_tr_b16 v[34:35], v9 offset:23072
    v_exp_f32 v122, v122
    v_exp_f32 v123, v123
    s_cmp_gt_u32 s2, 32
    s_cbranch_scc1 .Lk2_nod2
    s_lshr_b32 s52, s49, 2
    s_lshl_b32 s52, s52, 15
    s_and_b32 s53, s49, 3
    s_lshl_b32 s53, s53, 5
    s_add_u32 s52, s52, s53
    s_lshl_b32 s53, s88, 12
    s_add_u32 s52, s52, s53
    s_add_u32 s53, s52, 0x2400000
    s_add_u32 m0, s71, 0x18000
    s_nop 0
    buffer_load_dwordx4 v13, s[92:95], s53 offen sc1 lds
    s_add_u32 s53, s52, 0x2700000
    s_add_u32 m0, s71, 0x1a000
    s_nop 0
    buffer_load_dwordx4 v13, s[92:95], s53 offen sc1 lds
.Lk2_nod2:
    s_waitcnt lgkmcnt(8)
    v_mfma_f32_16x16x32_bf16 v[40:43], v[16:19], v[160:163], v[40:43]
    v_exp_f32 v124, v124
    v_exp_f32 v125, v125
    ds_read_b64_tr_b16 v[36:37], v9 offset:21568
    v_exp_f32 v126, v126
    v_exp_f32 v127, v127
    v_mfma_f32_16x16x32_bf16 v[48:51], v[16:19], v[164:167], v[48:51]
    v_add_f32 v120, 1.0, v120
    v_add_f32 v121, 1.0, v121
    ds_read_b64_tr_b16 v[38:39], v9 offset:23104
    v_add_f32 v122, 1.0, v122
    v_add_f32 v123, 1.0, v123
    s_waitcnt lgkmcnt(8)
    v_mfma_f32_16x16x32_bf16 v[44:47], v[20:23], v[160:163], v[44:47]
    v_add_f32 v124, 1.0, v124
    v_add_f32 v125, 1.0, v125
    ds_read_b64_tr_b16 v[16:17], v9 offset:24576
    v_add_f32 v126, 1.0, v126
    v_add_f32 v127, 1.0, v127
    v_mfma_f32_16x16x32_bf16 v[52:55], v[20:23], v[164:167], v[52:55]
    v_rcp_f32 v120, v120
    v_rcp_f32 v121, v121
    ds_read_b64_tr_b16 v[18:19], v9 offset:26112
    v_rcp_f32 v122, v122
    v_rcp_f32 v123, v123
    s_waitcnt lgkmcnt(8)
    v_mfma_f32_16x16x32_bf16 v[56:59], v[24:27], v[160:163], v[56:59]
    s_add_u32 s50, s41, 0x0
    s_add_u32 m0, s71, 0x6000
    s_nop 0
    buffer_load_dwordx4 v3, s[32:35], s50 offen lds
    v_rcp_f32 v124, v124
    ds_read_b64_tr_b16 v[20:21], v9 offset:24608
    v_rcp_f32 v125, v125
    v_rcp_f32 v126, v126
    v_mfma_f32_16x16x32_bf16 v[60:63], v[24:27], v[164:167], v[60:63]
    v_rcp_f32 v127, v127
    v_mul_f32 v120, v72, v120
    ds_read_b64_tr_b16 v[22:23], v9 offset:26144
    v_mul_f32 v121, v73, v121
    v_mul_f32 v122, v74, v122
    s_waitcnt lgkmcnt(8)
    v_mfma_f32_16x16x32_bf16 v[40:43], v[28:31], v[168:171], v[40:43]
    v_mul_f32 v123, v75, v123
    v_mul_f32 v124, v76, v124
    ds_read_b64_tr_b16 v[24:25], v9 offset:24640
    v_mul_f32 v125, v77, v125
    v_mul_f32 v126, v78, v126
    v_mfma_f32_16x16x32_bf16 v[48:51], v[28:31], v[172:175], v[48:51]
    v_mul_f32 v127, v79, v127
    v_cvt_pk_bf16_f32 v72, v120, v121
    ds_read_b64_tr_b16 v[26:27], v9 offset:26176
    v_cvt_pk_bf16_f32 v73, v122, v123
    v_cvt_pk_bf16_f32 v74, v124, v125
    s_waitcnt lgkmcnt(8)
    v_mfma_f32_16x16x32_bf16 v[44:47], v[32:35], v[168:171], v[44:47]
    s_add_u32 s51, s41, 0x0
    s_add_u32 m0, s71, 0x8000
    s_nop 0
    buffer_load_dwordx4 v4, s[32:35], s51 offen lds
    v_cvt_pk_bf16_f32 v75, v126, v127
    ds_read_b64_tr_b16 v[28:29], v9 offset:27648
    buffer_store_dwordx4 v[72:75], v11, s[92:95], s68 offen offset:0 sc1
    v_mul_f32 v112, v80, v80
    v_mfma_f32_16x16x32_bf16 v[52:55], v[32:35], v[172:175], v[52:55]
    v_mul_f32 v113, v81, v81
    v_mul_f32 v114, v82, v82
    ds_read_b64_tr_b16 v[30:31], v9 offset:29184
    v_mul_f32 v115, v83, v83
    v_mul_f32 v116, v84, v84
    s_waitcnt lgkmcnt(8)
    v_mfma_f32_16x16x32_bf16 v[56:59], v[36:39], v[168:171], v[56:59]
    v_mul_f32 v117, v85, v85
    v_mul_f32 v118, v86, v86
    ds_read_b64_tr_b16 v[32:33], v9 offset:27680
    v_mul_f32 v119, v87, v87
    v_fmaak_f32 v112, v12, v112, 0xc0135761
    v_mfma_f32_16x16x32_bf16 v[60:63], v[36:39], v[172:175], v[60:63]
    v_fmaak_f32 v113, v12, v113, 0xc0135761
    v_fmaak_f32 v114, v12, v114, 0xc0135761
    ds_read_b64_tr_b16 v[34:35], v9 offset:29216
    v_fmaak_f32 v115, v12, v115, 0xc0135761
    v_fmaak_f32 v116, v12, v116, 0xc0135761
    s_add_u32 s50, s41, 0x0
    s_add_u32 m0, s71, 0xa000
    s_nop 0
    buffer_load_dwordx4 v5, s[32:35], s50 offen lds
    s_waitcnt vmcnt(7)
    s_barrier
    s_waitcnt lgkmcnt(8)
    v_mfma_f32_16x16x32_bf16 v[40:43], v[16:19], v[176:179], v[40:43]
    v_fmaak_f32 v117, v12, v117, 0xc0135761
    v_fmaak_f32 v118, v12, v118, 0xc0135761
    ds_read_b64_tr_b16 v[36:37], v9 offset:27712
    v_fmaak_f32 v119, v12, v119, 0xc0135761
    v_mul_f32 v112, v112, v80
    v_mfma_f32_16x16x32_bf16 v[48:51], v[16:19], v[180:183], v[48:51]
    v_mul_f32 v113, v113, v81
    v_mul_f32 v114, v114, v82
    ds_read_b64_tr_b16 v[38:39], v9 offset:29248
    v_mul_f32 v115, v115, v83
    v_mul_f32 v116, v116, v84
    s_waitcnt lgkmcnt(8)
    v_mfma_f32_16x16x32_bf16 v[44:47], v[20:23], v[176:179], v[44:47]
    v_mul_f32 v117, v117, v85
    v_mul_f32 v118, v118, v86
    ds_read_b64_tr_b16 v[16:17], v9 offset:30720
    v_mul_f32 v119, v119, v87
    v_exp_f32 v112, v112
    v_mfma_f32_16x16x32_bf16 v[52:55], v[20:23], v[180:183], v[52:55]
    v_exp_f32 v113, v113
    s_movk_i32 s52, 0x3400
    buffer_load_dwordx4 v[144:147], v6, s[96:99], s52 offen
    ds_read_b64_tr_b16 v[18:19], v9 offset:32256
    v_exp_f32 v114, v114
    v_exp_f32 v115, v115
    s_waitcnt lgkmcnt(8)
    v_mfma_f32_16x16x32_bf16 v[56:59], v[24:27], v[176:179], v[56:59]
    v_exp_f32 v116, v116
    v_exp_f32 v117, v117
    ds_read_b64_tr_b16 v[20:21], v9 offset:30752
    v_exp_f32 v118, v118
    v_exp_f32 v119, v119
    v_mfma_f32_16x16x32_bf16 v[60:63], v[24:27], v[180:183], v[60:63]
    v_add_f32 v112, 1.0, v112
    v_add_f32 v113, 1.0, v113
    ds_read_b64_tr_b16 v[22:23], v9 offset:32288
    v_add_f32 v114, 1.0, v114
    v_add_f32 v115, 1.0, v115
    s_waitcnt lgkmcnt(8)
    v_mfma_f32_16x16x32_bf16 v[40:43], v[28:31], v[184:187], v[40:43]
    v_add_f32 v116, 1.0, v116
    v_add_f32 v117, 1.0, v117
    ds_read_b64_tr_b16 v[24:25], v9 offset:30784
    v_add_f32 v118, 1.0, v118
    s_movk_i32 s52, 0x3800
    buffer_load_dwordx4 v[148:151], v6, s[96:99], s52 offen
    v_mfma_f32_16x16x32_bf16 v[48:51], v[28:31], v[188:191], v[48:51]
    v_add_f32 v119, 1.0, v119
    v_rcp_f32 v112, v112
    ds_read_b64_tr_b16 v[26:27], v9 offset:32320
    v_rcp_f32 v113, v113
    v_rcp_f32 v114, v114
    s_waitcnt lgkmcnt(8)
    v_mfma_f32_16x16x32_bf16 v[44:47], v[32:35], v[184:187], v[44:47]
    v_rcp_f32 v115, v115
    v_rcp_f32 v116, v116
    ds_read_b64_tr_b16 v[28:29], v9 offset:33792
    v_rcp_f32 v117, v117
    v_rcp_f32 v118, v118
    v_mfma_f32_16x16x32_bf16 v[52:55], v[32:35], v[188:191], v[52:55]
    v_rcp_f32 v119, v119
    v_mul_f32 v112, v80, v112
    ds_read_b64_tr_b16 v[30:31], v9 offset:35328
    v_mul_f32 v113, v81, v113
    v_mul_f32 v114, v82, v114
    s_waitcnt lgkmcnt(8)
    v_mfma_f32_16x16x32_bf16 v[56:59], v[36:39], v[184:187], v[56:59]
    v_mul_f32 v115, v83, v115
    s_movk_i32 s52, 0x3c00
    buffer_load_dwordx4 v[152:155], v6, s[96:99], s52 offen
    ds_read_b64_tr_b16 v[32:33], v9 offset:33824
    v_mul_f32 v116, v84, v116
    v_mul_f32 v117, v85, v117
    v_mfma_f32_16x16x32_bf16 v[60:63], v[36:39], v[188:191], v[60:63]
    v_mul_f32 v118, v86, v118
    v_mul_f32 v119, v87, v119
    ds_read_b64_tr_b16 v[34:35], v9 offset:35360
    v_cvt_pk_bf16_f32 v80, v112, v113
    v_cvt_pk_bf16_f32 v81, v114, v115
    v_cvt_pk_bf16_f32 v82, v116, v117
    s_waitcnt lgkmcnt(8)
    v_mfma_f32_16x16x32_bf16 v[40:43], v[16:19], v[192:195], v[40:43]
    v_cvt_pk_bf16_f32 v83, v118, v119
    buffer_store_dwordx4 v[80:83], v10, s[92:95], s68 offen offset:1024 sc1
    ds_read_b64_tr_b16 v[36:37], v9 offset:33856
    v_mul_f32 v120, v88, v88
    v_mul_f32 v121, v89, v89
    v_mfma_f32_16x16x32_bf16 v[48:51], v[16:19], v[196:199], v[48:51]
    v_mul_f32 v122, v90, v90
    v_mul_f32 v123, v91, v91
    ds_read_b64_tr_b16 v[38:39], v9 offset:35392
    s_movk_i32 s52, 0x4000
    buffer_load_dwordx4 v[156:159], v6, s[96:99], s52 offen
    v_mul_f32 v124, v92, v92
    s_waitcnt lgkmcnt(8)
    v_mfma_f32_16x16x32_bf16 v[44:47], v[20:23], v[192:195], v[44:47]
    v_mul_f32 v125, v93, v93
    v_mul_f32 v126, v94, v94
    ds_read_b64_tr_b16 v[16:17], v9 offset:36864
    v_mul_f32 v127, v95, v95
    v_fmaak_f32 v120, v12, v120, 0xc0135761
    v_mfma_f32_16x16x32_bf16 v[52:55], v[20:23], v[196:199], v[52:55]
    v_fmaak_f32 v121, v12, v121, 0xc0135761
    v_fmaak_f32 v122, v12, v122, 0xc0135761
    ds_read_b64_tr_b16 v[18:19], v9 offset:38400
    v_fmaak_f32 v123, v12, v123, 0xc0135761
    v_fmaak_f32 v124, v12, v124, 0xc0135761
    s_waitcnt lgkmcnt(8)
    v_mfma_f32_16x16x32_bf16 v[56:59], v[24:27], v[192:195], v[56:59]
    v_fmaak_f32 v125, v12, v125, 0xc0135761
    v_fmaak_f32 v126, v12, v126, 0xc0135761
    ds_read_b64_tr_b16 v[20:21], v9 offset:36896
    v_fmaak_f32 v127, v12, v127, 0xc0135761
    v_mul_f32 v120, v120, v88
    v_mfma_f32_16x16x32_bf16 v[60:63], v[24:27], v[196:199], v[60:63]
    s_mov_b32 s52, 0x2d00000
    buffer_load_dwordx4 v[160:163], v6, s[92:95], s52 offen sc1
    v_mul_f32 v121, v121, v89
    ds_read_b64_tr_b16 v[22:23], v9 offset:38432
    v_mul_f32 v122, v122, v90
    v_mul_f32 v123, v123, v91
    s_waitcnt lgkmcnt(8)
    v_mfma_f32_16x16x32_bf16 v[40:43], v[28:31], v[200:203], v[40:43]
    v_mul_f32 v124, v124, v92
    v_mul_f32 v125, v125, v93
    ds_read_b64_tr_b16 v[24:25], v9 offset:36928
    v_mul_f32 v126, v126, v94
    v_mul_f32 v127, v127, v95
    v_mfma_f32_16x16x32_bf16 v[48:51], v[28:31], v[204:207], v[48:51]
    v_exp_f32 v120, v120
    v_exp_f32 v121, v121
    ds_read_b64_tr_b16 v[26:27], v9 offset:38464
    v_exp_f32 v122, v122
    v_exp_f32 v123, v123
    s_waitcnt lgkmcnt(8)
    v_mfma_f32_16x16x32_bf16 v[44:47], v[32:35], v[200:203], v[44:47]
    v_exp_f32 v124, v124
    v_exp_f32 v125, v125
    ds_read_b64_tr_b16 v[28:29], v9 offset:39936
    s_add_u32 s51, s41, 0x2d000
    s_add_u32 m0, s71, 0xc000
    s_nop 0
    buffer_load_dwordx4 v3, s[32:35], s51 offen lds
    v_exp_f32 v126, v126
    v_mfma_f32_16x16x32_bf16 v[52:55], v[32:35], v[204:207], v[52:55]
    v_exp_f32 v127, v127
    v_add_f32 v120, 1.0, v120
    ds_read_b64_tr_b16 v[30:31], v9 offset:41472
    v_add_f32 v121, 1.0, v121
    v_add_f32 v122, 1.0, v122
    s_waitcnt lgkmcnt(8)
    v_mfma_f32_16x16x32_bf16 v[56:59], v[36:39], v[200:203], v[56:59]
    v_add_f32 v123, 1.0, v123
    v_add_f32 v124, 1.0, v124
    ds_read_b64_tr_b16 v[32:33], v9 offset:39968
    v_add_f32 v125, 1.0, v125
    v_add_f32 v126, 1.0, v126
    v_mfma_f32_16x16x32_bf16 v[60:63], v[36:39], v[204:207], v[60:63]
    v_add_f32 v127, 1.0, v127
    v_rcp_f32 v120, v120
    ds_read_b64_tr_b16 v[34:35], v9 offset:41504
    v_rcp_f32 v121, v121
    v_rcp_f32 v122, v122
    s_add_u32 s50, s41, 0x2d000
    s_add_u32 m0, s71, 0xe000
    s_nop 0
    buffer_load_dwordx4 v4, s[32:35], s50 offen lds
    s_waitcnt vmcnt(15)
    s_barrier
    s_waitcnt lgkmcnt(8)
    v_mfma_f32_16x16x32_bf16 v[40:43], v[16:19], v[208:211], v[40:43]
    v_rcp_f32 v123, v123
    ds_read_b64_tr_b16 v[36:37], v9 offset:40000
    v_rcp_f32 v124, v124
    v_rcp_f32 v125, v125
    v_mfma_f32_16x16x32_bf16 v[48:51], v[16:19], v[212:215], v[48:51]
    v_rcp_f32 v126, v126
    v_rcp_f32 v127, v127
    ds_read_b64_tr_b16 v[38:39], v9 offset:41536
    v_mul_f32 v120, v88, v120
    v_mul_f32 v121, v89, v121
    s_waitcnt lgkmcnt(8)
    v_mfma_f32_16x16x32_bf16 v[44:47], v[20:23], v[208:211], v[44:47]
    v_mul_f32 v122, v90, v122
    v_mul_f32 v123, v91, v123
    ds_read_b64_tr_b16 v[16:17], v9 offset:43008
    v_mul_f32 v124, v92, v124
    v_mul_f32 v125, v93, v125
    v_mfma_f32_16x16x32_bf16 v[52:55], v[20:23], v[212:215], v[52:55]
    v_mul_f32 v126, v94, v126
    v_mul_f32 v127, v95, v127
    ds_read_b64_tr_b16 v[18:19], v9 offset:44544
    v_cvt_pk_bf16_f32 v88, v120, v121
    v_cvt_pk_bf16_f32 v89, v122, v123
    s_waitcnt lgkmcnt(8)
    v_mfma_f32_16x16x32_bf16 v[56:59], v[24:27], v[208:211], v[56:59]
    v_cvt_pk_bf16_f32 v90, v124, v125
    v_cvt_pk_bf16_f32 v91, v126, v127
    ds_read_b64_tr_b16 v[20:21], v9 offset:43040
    buffer_store_dwordx4 v[88:91], v11, s[92:95], s68 offen offset:1024 sc1
    v_mul_f32 v112, v96, v96
    v_mfma_f32_16x16x32_bf16 v[60:63], v[24:27], v[212:215], v[60:63]
    v_mul_f32 v113, v97, v97
    v_mul_f32 v114, v98, v98
    ds_read_b64_tr_b16 v[22:23], v9 offset:44576
    v_mul_f32 v115, v99, v99
    v_mul_f32 v116, v100, v100
    s_waitcnt lgkmcnt(8)
    v_mfma_f32_16x16x32_bf16 v[40:43], v[28:31], v[216:219], v[40:43]
    v_mul_f32 v117, v101, v101
    ds_read_b64_tr_b16 v[24:25], v9 offset:43072
    v_mul_f32 v118, v102, v102
    v_mul_f32 v119, v103, v103
    v_mfma_f32_16x16x32_bf16 v[48:51], v[28:31], v[220:223], v[48:51]
    v_fmaak_f32 v112, v12, v112, 0xc0135761
    v_fmaak_f32 v113, v12, v113, 0xc0135761
    ds_read_b64_tr_b16 v[26:27], v9 offset:44608
    v_fmaak_f32 v114, v12, v114, 0xc0135761
    v_fmaak_f32 v115, v12, v115, 0xc0135761
    s_waitcnt lgkmcnt(8)
    v_mfma_f32_16x16x32_bf16 v[44:47], v[32:35], v[216:219], v[44:47]
    v_fmaak_f32 v116, v12, v116, 0xc0135761
    v_fmaak_f32 v117, v12, v117, 0xc0135761
    ds_read_b64_tr_b16 v[28:29], v9 offset:46080
    v_fmaak_f32 v118, v12, v118, 0xc0135761
    v_fmaak_f32 v119, v12, v119, 0xc0135761
    v_mfma_f32_16x16x32_bf16 v[52:55], v[32:35], v[220:223], v[52:55]
    v_mul_f32 v112, v112, v96
    v_mul_f32 v113, v113, v97
    ds_read_b64_tr_b16 v[30:31], v9 offset:47616
    v_mul_f32 v114, v114, v98
    v_mul_f32 v115, v115, v99
    s_waitcnt lgkmcnt(8)
    v_mfma_f32_16x16x32_bf16 v[56:59], v[36:39], v[216:219], v[56:59]
    v_mul_f32 v116, v116, v100
    v_mul_f32 v117, v117, v101
    ds_read_b64_tr_b16 v[32:33], v9 offset:46112
    v_mul_f32 v118, v118, v102
    v_mul_f32 v119, v119, v103
    v_mfma_f32_16x16x32_bf16 v[60:63], v[36:39], v[220:223], v[60:63]
    v_exp_f32 v112, v112
    v_exp_f32 v113, v113
    ds_read_b64_tr_b16 v[34:35], v9 offset:47648
    v_exp_f32 v114, v114
    v_exp_f32 v115, v115
    s_waitcnt lgkmcnt(8)
    v_mfma_f32_16x16x32_bf16 v[40:43], v[16:19], v[224:227], v[40:43]
    s_add_u32 s51, s41, 0x2d000
    s_add_u32 m0, s71, 0x10000
    s_nop 0
    buffer_load_dwordx4 v5, s[32:35], s51 offen lds
    ds_read_b64_tr_b16 v[36:37], v9 offset:46144
    v_exp_f32 v116, v116
    v_exp_f32 v117, v117
    v_mfma_f32_16x16x32_bf16 v[48:51], v[16:19], v[228:231], v[48:51]
    v_exp_f32 v118, v118
    v_exp_f32 v119, v119
    ds_read_b64_tr_b16 v[38:39], v9 offset:47680
    v_add_f32 v112, 1.0, v112
    v_add_f32 v113, 1.0, v113
    s_waitcnt lgkmcnt(8)
    v_mfma_f32_16x16x32_bf16 v[44:47], v[20:23], v[224:227], v[44:47]
    v_add_f32 v114, 1.0, v114
    v_add_f32 v115, 1.0, v115
    v_add_u32 v9, 0xfffe4000, v9
    v_add_f32 v116, 1.0, v116
    v_add_f32 v117, 1.0, v117
    ds_read_b64_tr_b16 v[16:17], v9 offset:0
    v_add_f32 v118, 1.0, v118
    v_add_f32 v119, 1.0, v119
    v_mfma_f32_16x16x32_bf16 v[52:55], v[20:23], v[228:231], v[52:55]
    v_rcp_f32 v112, v112
    v_rcp_f32 v113, v113
    ds_read_b64_tr_b16 v[18:19], v9 offset:1536
    v_rcp_f32 v114, v114
    v_rcp_f32 v115, v115
    s_waitcnt lgkmcnt(8)
    v_mfma_f32_16x16x32_bf16 v[56:59], v[24:27], v[224:227], v[56:59]
    v_rcp_f32 v116, v116
    v_rcp_f32 v117, v117
    ds_read_b64_tr_b16 v[20:21], v9 offset:32
    v_rcp_f32 v118, v118
    v_rcp_f32 v119, v119
    v_mfma_f32_16x16x32_bf16 v[60:63], v[24:27], v[228:231], v[60:63]
    v_mul_f32 v112, v96, v112
    v_mul_f32 v113, v97, v113
    ds_read_b64_tr_b16 v[22:23], v9 offset:1568
    v_mul_f32 v114, v98, v114
    s_waitcnt lgkmcnt(8)
    v_mfma_f32_16x16x32_bf16 v[40:43], v[28:31], v[232:235], v[40:43]
    v_mul_f32 v115, v99, v115
    v_mul_f32 v116, v100, v116
    ds_read_b64_tr_b16 v[24:25], v9 offset:64
    v_mul_f32 v117, v101, v117
    v_mul_f32 v118, v102, v118
    v_mfma_f32_16x16x32_bf16 v[48:51], v[28:31], v[236:239], v[48:51]
    v_mul_f32 v119, v103, v119
    v_cvt_pk_bf16_f32 v96, v112, v113
    ds_read_b64_tr_b16 v[26:27], v9 offset:1600
    v_cvt_pk_bf16_f32 v97, v114, v115
    v_cvt_pk_bf16_f32 v98, v116, v117
    s_waitcnt lgkmcnt(8)
    v_mfma_f32_16x16x32_bf16 v[44:47], v[32:35], v[232:235], v[44:47]
    v_cvt_pk_bf16_f32 v99, v118, v119
    buffer_store_dwordx4 v[96:99], v10, s[92:95], s68 offen offset:2048 sc1
    ds_read_b64_tr_b16 v[28:29], v9 offset:3072
    v_mul_f32 v120, v104, v104
    v_mul_f32 v121, v105, v105
    v_mfma_f32_16x16x32_bf16 v[52:55], v[32:35], v[236:239], v[52:55]
    v_mul_f32 v122, v106, v106
    v_mul_f32 v123, v107, v107
    ds_read_b64_tr_b16 v[30:31], v9 offset:4608
    v_mul_f32 v124, v108, v108
    v_mul_f32 v125, v109, v109
    s_waitcnt lgkmcnt(8)
    v_mfma_f32_16x16x32_bf16 v[56:59], v[36:39], v[232:235], v[56:59]
    v_mul_f32 v126, v110, v110
    v_mul_f32 v127, v111, v111
    ds_read_b64_tr_b16 v[32:33], v9 offset:3104
    v_fmaak_f32 v120, v12, v120, 0xc0135761
    v_fmaak_f32 v121, v12, v121, 0xc0135761
    v_mfma_f32_16x16x32_bf16 v[60:63], v[36:39], v[236:239], v[60:63]
    v_fmaak_f32 v122, v12, v122, 0xc0135761
    v_fmaak_f32 v123, v12, v123, 0xc0135761
    ds_read_b64_tr_b16 v[34:35], v9 offset:4640
    v_fmaak_f32 v124, v12, v124, 0xc0135761
    s_add_u32 s50, s41, 0x51000
    s_add_u32 m0, s71, 0x12000
    s_nop 0
    buffer_load_dwordx4 v3, s[32:35], s50 offen lds
    s_barrier
    s_waitcnt lgkmcnt(8)
    v_mfma_f32_16x16x32_bf16 v[40:43], v[16:19], v[240:243], v[40:43]
    v_fmaak_f32 v125, v12, v125, 0xc0135761
    v_fmaak_f32 v126, v12, v126, 0xc0135761
    v_fmaak_f32 v127, v12, v127, 0xc0135761
    ds_read_b64_tr_b16 v[36:37], v9 offset:3136
    v_mul_f32 v120, v120, v104
    v_mul_f32 v121, v121, v105
    v_mul_f32 v122, v122, v106
    v_mul_f32 v123, v123, v107
    v_mfma_f32_16x16x32_bf16 v[48:51], v[16:19], v[244:247], v[48:51]
    v_mul_f32 v124, v124, v108
    v_mul_f32 v125, v125, v109
    v_mul_f32 v126, v126, v110
    ds_read_b64_tr_b16 v[38:39], v9 offset:4672
    v_mul_f32 v127, v127, v111
    v_exp_f32 v120, v120
    v_exp_f32 v121, v121
    v_exp_f32 v122, v122
    s_waitcnt lgkmcnt(8)
    v_mfma_f32_16x16x32_bf16 v[44:47], v[20:23], v[240:243], v[44:47]
    v_exp_f32 v123, v123
    v_exp_f32 v124, v124
    v_exp_f32 v125, v125
    v_mfma_f32_16x16x32_bf16 v[52:55], v[20:23], v[244:247], v[52:55]
    v_exp_f32 v126, v126
    v_exp_f32 v127, v127
    v_add_f32 v120, 1.0, v120
    v_add_f32 v121, 1.0, v121
    s_waitcnt lgkmcnt(6)
    v_mfma_f32_16x16x32_bf16 v[56:59], v[24:27], v[240:243], v[56:59]
    v_add_f32 v122, 1.0, v122
    v_add_f32 v123, 1.0, v123
    v_add_f32 v124, 1.0, v124
    s_add_u32 s51, s41, 0x51000
    s_add_u32 m0, s71, 0x14000
    s_nop 0
    buffer_load_dwordx4 v4, s[32:35], s51 offen lds
    v_mfma_f32_16x16x32_bf16 v[60:63], v[24:27], v[244:247], v[60:63]
    v_add_f32 v125, 1.0, v125
    v_add_f32 v126, 1.0, v126
    v_add_f32 v127, 1.0, v127
    s_waitcnt lgkmcnt(4)
    v_mfma_f32_16x16x32_bf16 v[40:43], v[28:31], v[248:251], v[40:43]
    v_rcp_f32 v120, v120
    v_rcp_f32 v121, v121
    v_rcp_f32 v122, v122
    v_rcp_f32 v123, v123
    v_mfma_f32_16x16x32_bf16 v[48:51], v[28:31], v[252:255], v[48:51]
    v_rcp_f32 v124, v124
    v_rcp_f32 v125, v125
    v_rcp_f32 v126, v126
    s_waitcnt lgkmcnt(2)
    v_mfma_f32_16x16x32_bf16 v[44:47], v[32:35], v[248:251], v[44:47]
    v_rcp_f32 v127, v127
    v_mul_f32 v120, v104, v120
    v_mul_f32 v121, v105, v121
    v_mul_f32 v122, v106, v122
    v_mfma_f32_16x16x32_bf16 v[52:55], v[32:35], v[252:255], v[52:55]
    v_mul_f32 v123, v107, v123
    v_mul_f32 v124, v108, v124
    v_mul_f32 v125, v109, v125
    s_waitcnt lgkmcnt(0)
    v_mfma_f32_16x16x32_bf16 v[56:59], v[36:39], v[248:251], v[56:59]
    v_mul_f32 v126, v110, v126
    v_mul_f32 v127, v111, v127
    v_cvt_pk_bf16_f32 v104, v120, v121
    v_cvt_pk_bf16_f32 v105, v122, v123
    v_mfma_f32_16x16x32_bf16 v[60:63], v[36:39], v[252:255], v[60:63]
    v_cvt_pk_bf16_f32 v106, v124, v125
    v_cvt_pk_bf16_f32 v107, v126, v127
    buffer_store_dwordx4 v[104:107], v11, s[92:95], s68 offen offset:2048 sc1
    s_add_u32 s50, s41, 0x51000
    s_add_u32 m0, s71, 0x16000
    s_nop 0
    buffer_load_dwordx4 v5, s[32:35], s50 offen lds
    v_mul_f32 v112, v40, v40
    v_mul_f32 v113, v41, v41
    v_mul_f32 v114, v42, v42
    v_mul_f32 v115, v43, v43
    v_mul_f32 v116, v44, v44
    v_mul_f32 v117, v45, v45
    v_mul_f32 v118, v46, v46
    v_mul_f32 v119, v47, v47
    v_fmaak_f32 v112, v12, v112, 0xc0135761
    v_fmaak_f32 v113, v12, v113, 0xc0135761
    v_fmaak_f32 v114, v12, v114, 0xc0135761
    v_fmaak_f32 v115, v12, v115, 0xc0135761
    v_fmaak_f32 v116, v12, v116, 0xc0135761
    v_fmaak_f32 v117, v12, v117, 0xc0135761
    v_fmaak_f32 v118, v12, v118, 0xc0135761
    v_fmaak_f32 v119, v12, v119, 0xc0135761
    v_mul_f32 v112, v112, v40
    v_mul_f32 v113, v113, v41
    v_mul_f32 v114, v114, v42
    v_mul_f32 v115, v115, v43
    v_mul_f32 v116, v116, v44
    v_mul_f32 v117, v117, v45
    v_mul_f32 v118, v118, v46
    v_mul_f32 v119, v119, v47
    v_exp_f32 v112, v112
    v_exp_f32 v113, v113
    v_exp_f32 v114, v114
    v_exp_f32 v115, v115
    v_exp_f32 v116, v116
    v_exp_f32 v117, v117
    v_exp_f32 v118, v118
    v_exp_f32 v119, v119
    v_add_f32 v112, 1.0, v112
    v_add_f32 v113, 1.0, v113
    v_add_f32 v114, 1.0, v114
    v_add_f32 v115, 1.0, v115
    v_add_f32 v116, 1.0, v116
    v_add_f32 v117, 1.0, v117
    v_add_f32 v118, 1.0, v118
    v_add_f32 v119, 1.0, v119
    v_rcp_f32 v112, v112
    v_rcp_f32 v113, v113
    v_rcp_f32 v114, v114
    v_rcp_f32 v115, v115
    v_rcp_f32 v116, v116
    v_rcp_f32 v117, v117
    v_rcp_f32 v118, v118
    v_rcp_f32 v119, v119
    v_mul_f32 v112, v40, v112
    v_mul_f32 v113, v41, v113
    v_mul_f32 v114, v42, v114
    v_mul_f32 v115, v43, v115
    v_mul_f32 v116, v44, v116
    v_mul_f32 v117, v45, v117
    v_mul_f32 v118, v46, v118
    v_mul_f32 v119, v47, v119
    v_cvt_pk_bf16_f32 v40, v112, v113
    v_cvt_pk_bf16_f32 v41, v114, v115
    v_cvt_pk_bf16_f32 v42, v116, v117
    v_cvt_pk_bf16_f32 v43, v118, v119
    buffer_store_dwordx4 v[40:43], v10, s[92:95], s68 offen offset:3072 sc1
    v_mul_f32 v120, v48, v48
    v_mul_f32 v121, v49, v49
    v_mul_f32 v122, v50, v50
    v_mul_f32 v123, v51, v51
    v_mul_f32 v124, v52, v52
    v_mul_f32 v125, v53, v53
    v_mul_f32 v126, v54, v54
    v_mul_f32 v127, v55, v55
    v_fmaak_f32 v120, v12, v120, 0xc0135761
    v_fmaak_f32 v121, v12, v121, 0xc0135761
    v_fmaak_f32 v122, v12, v122, 0xc0135761
    v_fmaak_f32 v123, v12, v123, 0xc0135761
    v_fmaak_f32 v124, v12, v124, 0xc0135761
    v_fmaak_f32 v125, v12, v125, 0xc0135761
    v_fmaak_f32 v126, v12, v126, 0xc0135761
    v_fmaak_f32 v127, v12, v127, 0xc0135761
    v_mul_f32 v120, v120, v48
    v_mul_f32 v121, v121, v49
    v_mul_f32 v122, v122, v50
    v_mul_f32 v123, v123, v51
    v_mul_f32 v124, v124, v52
    v_mul_f32 v125, v125, v53
    v_mul_f32 v126, v126, v54
    v_mul_f32 v127, v127, v55
    v_exp_f32 v120, v120
    v_exp_f32 v121, v121
    v_exp_f32 v122, v122
    v_exp_f32 v123, v123
    v_exp_f32 v124, v124
    v_exp_f32 v125, v125
    v_exp_f32 v126, v126
    v_exp_f32 v127, v127
    v_add_f32 v120, 1.0, v120
    v_add_f32 v121, 1.0, v121
    v_add_f32 v122, 1.0, v122
    v_add_f32 v123, 1.0, v123
    v_add_f32 v124, 1.0, v124
    v_add_f32 v125, 1.0, v125
    v_add_f32 v126, 1.0, v126
    v_add_f32 v127, 1.0, v127
    v_rcp_f32 v120, v120
    v_rcp_f32 v121, v121
    v_rcp_f32 v122, v122
    v_rcp_f32 v123, v123
    v_rcp_f32 v124, v124
    v_rcp_f32 v125, v125
    v_rcp_f32 v126, v126
    v_rcp_f32 v127, v127
    v_mul_f32 v120, v48, v120
    v_mul_f32 v121, v49, v121
    v_mul_f32 v122, v50, v122
    v_mul_f32 v123, v51, v123
    v_mul_f32 v124, v52, v124
    v_mul_f32 v125, v53, v125
    v_mul_f32 v126, v54, v126
    v_mul_f32 v127, v55, v127
    v_cvt_pk_bf16_f32 v48, v120, v121
    v_cvt_pk_bf16_f32 v49, v122, v123
    v_cvt_pk_bf16_f32 v50, v124, v125
    v_cvt_pk_bf16_f32 v51, v126, v127
    buffer_store_dwordx4 v[48:51], v11, s[92:95], s68 offen offset:3072 sc1
    v_mul_f32 v128, v56, v56
    v_mul_f32 v129, v57, v57
    v_mul_f32 v130, v58, v58
    v_mul_f32 v131, v59, v59
    v_fmaak_f32 v128, v12, v128, 0xc0135761
    v_fmaak_f32 v129, v12, v129, 0xc0135761
    v_fmaak_f32 v130, v12, v130, 0xc0135761
    v_fmaak_f32 v131, v12, v131, 0xc0135761
    v_mul_f32 v128, v128, v56
    v_mul_f32 v129, v129, v57
    v_mul_f32 v130, v130, v58
    v_mul_f32 v131, v131, v59
    v_exp_f32 v128, v128
    v_exp_f32 v129, v129
    v_exp_f32 v130, v130
    v_exp_f32 v131, v131
    v_add_f32 v128, 1.0, v128
    v_add_f32 v129, 1.0, v129
    v_add_f32 v130, 1.0, v130
    v_add_f32 v131, 1.0, v131
    v_rcp_f32 v128, v128
    v_rcp_f32 v129, v129
    v_rcp_f32 v130, v130
    v_rcp_f32 v131, v131
    v_mul_f32 v128, v56, v128
    v_mul_f32 v129, v57, v129
    v_mul_f32 v130, v58, v130
    v_mul_f32 v131, v59, v131
    v_cvt_pk_bf16_f32 v56, v128, v129
    v_cvt_pk_bf16_f32 v57, v130, v131
    v_lshlrev_b32 v132, 3, v0
    v_sub_u32 v133, v10, v132
    buffer_store_dwordx2 v[56:57], v133, s[92:95], s69 offen sc1
    v_mul_f32 v136, v60, v60
    v_mul_f32 v137, v61, v61
    v_mul_f32 v138, v62, v62
    v_mul_f32 v139, v63, v63
    v_fmaak_f32 v136, v12, v136, 0xc0135761
    v_fmaak_f32 v137, v12, v137, 0xc0135761
    v_fmaak_f32 v138, v12, v138, 0xc0135761
    v_fmaak_f32 v139, v12, v139, 0xc0135761
    v_mul_f32 v136, v136, v60
    v_mul_f32 v137, v137, v61
    v_mul_f32 v138, v138, v62
    v_mul_f32 v139, v139, v63
    v_exp_f32 v136, v136
    v_exp_f32 v137, v137
    v_exp_f32 v138, v138
    v_exp_f32 v139, v139
    v_add_f32 v136, 1.0, v136
    v_add_f32 v137, 1.0, v137
    v_add_f32 v138, 1.0, v138
    v_add_f32 v139, 1.0, v139
    v_rcp_f32 v136, v136
    v_rcp_f32 v137, v137
    v_rcp_f32 v138, v138
    v_rcp_f32 v139, v139
    v_mul_f32 v136, v60, v136
    v_mul_f32 v137, v61, v137
    v_mul_f32 v138, v62, v138
    v_mul_f32 v139, v63, v139
    v_cvt_pk_bf16_f32 v60, v136, v137
    v_cvt_pk_bf16_f32 v61, v138, v139
    v_lshlrev_b32 v132, 3, v0
    v_sub_u32 v134, v11, v132
    buffer_store_dwordx2 v[60:61], v134, s[92:95], s69 offen sc1
    s_and_b32 s64, s85, 3
    s_lshl_b32 s64, s64, 3
    s_lshr_b32 s65, s85, 2
    s_add_u32 s64, s64, s65
    s_lshl_b32 s65, s84, 5
    s_add_u32 s25, s64, s65
    s_waitcnt vmcnt(5)
    s_barrier
    s_cmp_lg_u32 s88, 7
    s_cbranch_scc1 .Lpub5
    s_lshl_b32 s86, s25, 3
    s_add_u32 s86, s86, 0x3300800
    v_mov_b32 v16, s90
    v_mov_b32 v17, s91
    v_mov_b32 v18, 0
    s_mov_b64 exec, 1
    buffer_store_dwordx2 v[16:17], v18, s[92:95], s86 offen sc1
    s_mov_b64 exec, -1
.Lpub5:
    s_and_b32 s46, s88, 3
    s_lshr_b32 s45, s88, 2
    s_lshl_b32 s39, s37, 3
    s_lshl_b32 s40, s46, 1
    s_add_u32 s39, s39, s40
    s_mul_i32 s42, s39, 144
    s_mul_i32 s40, s36, 36
    s_add_u32 s42, s42, s40
    s_mul_i32 s40, s45, 18
    s_add_u32 s42, s42, s40
    s_lshl_b32 s42, s42, 10
    s_mul_i32 s40, s45, 147456
    s_add_u32 s43, s42, 147456
    s_sub_u32 s43, s43, s40
    s_add_u32 s42, s42, s40
    s_add_u32 s39, s39, s45
    s_lshl_b32 s40, s36, 7
    s_add_u32 s39, s39, s40
    s_mul_i32 s44, s39, 36
    s_lshl_b32 s44, s44, 10
    s_add_u32 s44, s44, 0x1200000
    s_mul_i32 s40, s38, 3072
    s_add_u32 s54, s44, s40
    s_add_u32 s54, s54, 24576
    s_lshl_b32 s40, s40, 1
    s_add_u32 s44, s44, s40
    s_lshl_b32 s39, s84, 5
    s_bfe_u32 s40, s85, 0x20001
    s_lshl_b32 s40, s40, 3
    s_add_u32 s24, s39, s40
    v_lshrrev_b32 v7, 4, v0
    v_and_b32 v8, 15, v0
    v_lshl_add_u32 v15, v7, 6, v8
    s_lshl_b32 s39, s88, 2
    v_lshlrev_b32 v15, 5, v15
    v_add_u32 v15, s39, v15
    v_add_u32 v15, 0x2000, v15
    v_lshrrev_b32 v13, 5, v0
    v_lshlrev_b32 v13, 4, v13
    v_add_u32 v13, v13, v8
    v_lshlrev_b32 v13, 3, v13
    v_add_u32 v13, s88, v13
    v_lshlrev_b32 v13, 5, v13
    v_and_b32 v7, 1, v7
    v_lshl_add_u32 v13, v7, 4, v13
    v_add_u32 v13, 0x4000, v13
    v_add_u32 v9, s71, v6
    v_lshrrev_b32 v12, 7, v9
    v_mul_u32_u24 v12, 36992, v12
    v_and_b32 v7, 0x70, v6
    v_add_u32 v12, v12, v7
    v_add_u32 v9, 0x2000, v9
    v_max_u32 v160, v160, v161
    v_max_u32 v162, v162, v163
    v_max_u32 v160, v160, v162
    s_nop 1
    v_max_u32_dpp v160, v160, v160 row_ror:8 row_mask:0xf bank_mask:0xf
    s_nop 1
    v_max_u32_dpp v160, v160, v160 row_ror:4 row_mask:0xf bank_mask:0xf
    s_nop 1
    v_max_u32_dpp v160, v160, v160 row_ror:2 row_mask:0xf bank_mask:0xf
    s_nop 1
    v_max_u32_dpp v160, v160, v160 row_ror:1 row_mask:0xf bank_mask:0xf
    v_mov_b32 v14, v160
    s_nop 1
    v_permlane16_swap_b32 v160, v14
    v_max_u32 v160, v160, v14
    v_mov_b32 v14, v160
    s_nop 1
    v_permlane32_swap_b32 v160, v14
    v_max_u32 v160, v160, v14
    v_lshlrev_b32 v160, 16, v160
    v_frexp_exp_i32_f32 v160, v160
    v_sub_u32 v160, 0, v160
    v_ldexp_f32 v160, 1.0, v160
    v_mov_b32 v14, v160
    ds_read_b32 v176, v15 offset:0
    ds_read_b32 v177, v15 offset:512
    ds_read_b32 v178, v15 offset:1024
    ds_read_b32 v179, v15 offset:1536
    ds_read_b128 v[196:199], v13
    s_waitcnt lgkmcnt(1)
    v_mfma_f32_16x16x32_f16 v[180:183], v[176:179], v[144:147], 0
    v_mfma_f32_16x16x32_f16 v[184:187], v[176:179], v[148:151], 0
    s_waitcnt lgkmcnt(0)
    v_lshlrev_b32 v200, 16, v196
    v_and_b32 v204, 0xffff0000, v196
    v_lshlrev_b32 v201, 16, v197
    v_and_b32 v205, 0xffff0000, v197
    v_lshlrev_b32 v202, 16, v198
    v_and_b32 v206, 0xffff0000, v198
    v_lshlrev_b32 v203, 16, v199
    v_and_b32 v207, 0xffff0000, v199
    v_mul_f32 v188, v180, v152
    v_mul_f32 v192, v180, v156
    v_mul_f32 v189, v181, v153
    v_mul_f32 v193, v181, v157
    v_mul_f32 v190, v182, v154
    v_mul_f32 v194, v182, v158
    v_mul_f32 v191, v183, v155
    v_mul_f32 v195, v183, v159
    v_fma_f32 v188, -v184, v156, v188
    v_fmac_f32 v192, v184, v152
    v_fma_f32 v189, -v185, v157, v189
    v_fmac_f32 v193, v185, v153
    v_fma_f32 v190, -v186, v158, v190
    v_fmac_f32 v194, v186, v154
    v_fma_f32 v191, -v187, v159, v191
    v_fmac_f32 v195, v187, v155
    v_cvt_pk_f16_f32 v176, v188, v192
    v_cvt_pk_f16_f32 v177, v189, v193
    v_cvt_pk_f16_f32 v178, v190, v194
    v_cvt_pk_f16_f32 v179, v191, v195
    s_nop 1
    v_mfma_f32_16x16x32_f16 v[180:183], v[144:147], v[176:179], 0
    v_mfma_f32_16x16x32_f16 v[184:187], v[148:151], v[176:179], 0
    v_mul_f32 v200, v14, v200
    v_mul_f32 v204, v14, v204
    v_mul_f32 v201, v14, v201
    v_mul_f32 v205, v14, v205
    v_mul_f32 v202, v14, v202
    v_mul_f32 v206, v14, v206
    v_mul_f32 v203, v14, v203
    v_mul_f32 v207, v14, v207
    v_mul_f32 v188, v180, v200
    v_mul_f32 v192, v180, v204
    v_mul_f32 v189, v181, v201
    v_mul_f32 v193, v181, v205
    v_mul_f32 v190, v182, v202
    v_mul_f32 v194, v182, v206
    v_mul_f32 v191, v183, v203
    v_mul_f32 v195, v183, v207
    v_fma_f32 v188, -v184, v204, v188
    v_fmac_f32 v192, v184, v200
    v_fma_f32 v189, -v185, v205, v189
    v_fmac_f32 v193, v185, v201
    v_fma_f32 v190, -v186, v206, v190
    v_fmac_f32 v194, v186, v202
    v_fma_f32 v191, -v187, v207, v191
    v_fmac_f32 v195, v187, v203
    v_cvt_pk_f16_f32 v176, v192, v188
    v_cvt_pk_f16_f32 v177, v193, v189
    v_cvt_pk_f16_f32 v178, v194, v190
    v_cvt_pk_f16_f32 v179, v195, v191
    s_nop 1
    v_mfma_f32_16x16x32_f16 v[180:183], v[176:179], v[144:147], 0
    v_mfma_f32_16x16x32_f16 v[184:187], v[176:179], v[148:151], 0
    s_nop 6
    v_mul_f32 v188, v180, v152
    v_mul_f32 v192, v180, v156
    v_mul_f32 v189, v181, v153
    v_mul_f32 v193, v181, v157
    v_mul_f32 v190, v182, v154
    v_mul_f32 v194, v182, v158
    v_mul_f32 v191, v183, v155
    v_mul_f32 v195, v183, v159
    v_fma_f32 v188, -v184, v156, v188
    v_fmac_f32 v192, v184, v152
    v_fma_f32 v189, -v185, v157, v189
    v_fmac_f32 v193, v185, v153
    v_fma_f32 v190, -v186, v158, v190
    v_fmac_f32 v194, v186, v154
    v_fma_f32 v191, -v187, v159, v191
    v_fmac_f32 v195, v187, v155
    v_cvt_pk_f16_f32 v176, v188, v192
    v_cvt_pk_f16_f32 v177, v189, v193
    v_cvt_pk_f16_f32 v178, v190, v194
    v_cvt_pk_f16_f32 v179, v191, v195
    s_nop 1
    v_mfma_f32_16x16x32_f16 v[180:183], v[144:147], v[176:179], 0
    v_mfma_f32_16x16x32_f16 v[184:187], v[148:151], v[176:179], 0
    s_nop 7
    v_cvt_pk_f16_f32 v176, v184, v180
    v_cvt_pk_f16_f32 v177, v185, v181
    v_cvt_pk_f16_f32 v178, v186, v182
    v_cvt_pk_f16_f32 v179, v187, v183
    ds_write_b32 v15, v176 offset:0
    ds_write_b32 v15, v177 offset:512
    ds_write_b32 v15, v178 offset:1024
    ds_write_b32 v15, v179 offset:1536
    s_cmp_gt_u32 s2, 32
    s_cbranch_scc1 .Lk2_noc2
    v_add_u32 v15, 0x16000, v15
    v_add_u32 v13, 0x16000, v13
    ds_read_b32 v176, v15 offset:0
    ds_read_b32 v177, v15 offset:512
    ds_read_b32 v178, v15 offset:1024
    ds_read_b32 v179, v15 offset:1536
    ds_read_b128 v[196:199], v13
    s_waitcnt lgkmcnt(1)
    v_mfma_f32_16x16x32_f16 v[180:183], v[176:179], v[144:147], 0
    v_mfma_f32_16x16x32_f16 v[184:187], v[176:179], v[148:151], 0
    s_waitcnt lgkmcnt(0)
    v_lshlrev_b32 v200, 16, v196
    v_and_b32 v204, 0xffff0000, v196
    v_lshlrev_b32 v201, 16, v197
    v_and_b32 v205, 0xffff0000, v197
    v_lshlrev_b32 v202, 16, v198
    v_and_b32 v206, 0xffff0000, v198
    v_lshlrev_b32 v203, 16, v199
    v_and_b32 v207, 0xffff0000, v199
    v_mul_f32 v188, v180, v152
    v_mul_f32 v192, v180, v156
    v_mul_f32 v189, v181, v153
    v_mul_f32 v193, v181, v157
    v_mul_f32 v190, v182, v154
    v_mul_f32 v194, v182, v158
    v_mul_f32 v191, v183, v155
    v_mul_f32 v195, v183, v159
    v_fma_f32 v188, -v184, v156, v188
    v_fmac_f32 v192, v184, v152
    v_fma_f32 v189, -v185, v157, v189
    v_fmac_f32 v193, v185, v153
    v_fma_f32 v190, -v186, v158, v190
    v_fmac_f32 v194, v186, v154
    v_fma_f32 v191, -v187, v159, v191
    v_fmac_f32 v195, v187, v155
    v_cvt_pk_f16_f32 v176, v188, v192
    v_cvt_pk_f16_f32 v177, v189, v193
    v_cvt_pk_f16_f32 v178, v190, v194
    v_cvt_pk_f16_f32 v179, v191, v195
    s_nop 1
    v_mfma_f32_16x16x32_f16 v[180:183], v[144:147], v[176:179], 0
    v_mfma_f32_16x16x32_f16 v[184:187], v[148:151], v[176:179], 0
    v_mul_f32 v200, v14, v200
    v_mul_f32 v204, v14, v204
    v_mul_f32 v201, v14, v201
    v_mul_f32 v205, v14, v205
    v_mul_f32 v202, v14, v202
    v_mul_f32 v206, v14, v206
    v_mul_f32 v203, v14, v203
    v_mul_f32 v207, v14, v207
    v_mul_f32 v188, v180, v200
    v_mul_f32 v192, v180, v204
    v_mul_f32 v189, v181, v201
    v_mul_f32 v193, v181, v205
    v_mul_f32 v190, v182, v202
    v_mul_f32 v194, v182, v206
    v_mul_f32 v191, v183, v203
    v_mul_f32 v195, v183, v207
    v_fma_f32 v188, -v184, v204, v188
    v_fmac_f32 v192, v184, v200
    v_fma_f32 v189, -v185, v205, v189
    v_fmac_f32 v193, v185, v201
    v_fma_f32 v190, -v186, v206, v190
    v_fmac_f32 v194, v186, v202
    v_fma_f32 v191, -v187, v207, v191
    v_fmac_f32 v195, v187, v203
    v_cvt_pk_f16_f32 v176, v192, v188
    v_cvt_pk_f16_f32 v177, v193, v189
    v_cvt_pk_f16_f32 v178, v194, v190
    v_cvt_pk_f16_f32 v179, v195, v191
    s_nop 1
    v_mfma_f32_16x16x32_f16 v[180:183], v[176:179], v[144:147], 0
    v_mfma_f32_16x16x32_f16 v[184:187], v[176:179], v[148:151], 0
    s_nop 6
    v_mul_f32 v188, v180, v152
    v_mul_f32 v192, v180, v156
    v_mul_f32 v189, v181, v153
    v_mul_f32 v193, v181, v157
    v_mul_f32 v190, v182, v154
    v_mul_f32 v194, v182, v158
    v_mul_f32 v191, v183, v155
    v_mul_f32 v195, v183, v159
    v_fma_f32 v188, -v184, v156, v188
    v_fmac_f32 v192, v184, v152
    v_fma_f32 v189, -v185, v157, v189
    v_fmac_f32 v193, v185, v153
    v_fma_f32 v190, -v186, v158, v190
    v_fmac_f32 v194, v186, v154
    v_fma_f32 v191, -v187, v159, v191
    v_fmac_f32 v195, v187, v155
    v_cvt_pk_f16_f32 v176, v188, v192
    v_cvt_pk_f16_f32 v177, v189, v193
    v_cvt_pk_f16_f32 v178, v190, v194
    v_cvt_pk_f16_f32 v179, v191, v195
    s_nop 1
    v_mfma_f32_16x16x32_f16 v[180:183], v[144:147], v[176:179], 0
    v_mfma_f32_16x16x32_f16 v[184:187], v[148:151], v[176:179], 0
    s_nop 7
    v_cvt_pk_f16_f32 v176, v184, v180
    v_cvt_pk_f16_f32 v177, v185, v181
    v_cvt_pk_f16_f32 v178, v186, v182
    v_cvt_pk_f16_f32 v179, v187, v183
    ds_write_b32 v15, v176 offset:0
    ds_write_b32 v15, v177 offset:512
    ds_write_b32 v15, v178 offset:1024
    ds_write_b32 v15, v179 offset:1536
.Lk2_noc2:
    s_waitcnt lgkmcnt(0)
    s_cmp_lg_u32 s88, 7
    s_cbranch_scc1 .Lwf6_done
    v_and_b32 v16, 7, v0
    v_add_u32 v16, s24, v16
    v_lshlrev_b32 v16, 3, v16
    s_mov_b32 s87, 0
.Lwf6_loop:
    s_mov_b32 s86, 0x3300800
    buffer_load_dwordx2 v[20:21], v16, s[92:95], s86 offen sc1
    s_waitcnt vmcnt(0)
    v_xor_b32 v20, s90, v20
    v_xor_b32 v21, s91, v21
    v_lshrrev_b32 v19, 4, v21
    v_or_b32 v18, v20, v19
    v_cmp_ne_u32 vcc, 0, v18
    s_nop 4
    s_cbranch_vccz .Lwf6_ok
    s_sleep 1
    s_add_u32 s87, s87, 1
    s_cmp_lt_u32 s87, 0x40000
    s_cbranch_scc1 .Lwf6_loop
.Lwf6_ok:
.Lwf6_done:
    s_barrier
    ds_read_b128 v[208:211], v9
    v_add_u32 v9, 0x16000, v9
    ds_read_b128 v[212:215], v9
    s_add_u32 s52, s42, 0
    buffer_load_dwordx4 v[112:115], v6, s[92:95], s52 offen offset:0 sc1
    s_add_u32 s52, s43, 0
    buffer_load_dwordx4 v[116:119], v6, s[92:95], s52 offen offset:0 sc1
    s_add_u32 s52, s42, 0
    buffer_load_dwordx4 v[120:123], v6, s[92:95], s52 offen offset:1024 sc1
    s_add_u32 s52, s43, 0
    buffer_load_dwordx4 v[124:127], v6, s[92:95], s52 offen offset:1024 sc1
    s_add_u32 s52, s42, 4096
    buffer_load_dwordx4 v[128:131], v6, s[92:95], s52 offen offset:1024 sc1
    s_add_u32 s52, s43, 4096
    buffer_load_dwordx4 v[132:135], v6, s[92:95], s52 offen offset:1024 sc1
    s_add_u32 s52, s42, 4096
    buffer_load_dwordx4 v[136:139], v6, s[92:95], s52 offen offset:2048 sc1
    s_add_u32 s52, s43, 4096
    buffer_load_dwordx4 v[140:143], v6, s[92:95], s52 offen offset:2048 sc1
    s_lshl_b32 s39, s48, 7
    s_add_u32 s39, s39, 0x2a00000
    s_waitcnt lgkmcnt(1)
    buffer_store_dwordx4 v[208:211], v12, s[92:95], s39 offen sc1
    s_cmp_gt_u32 s2, 32
    s_cbranch_scc1 .Lk2_noo2
    s_lshl_b32 s39, s49, 7
    s_add_u32 s39, s39, 0x2a00000
    s_waitcnt lgkmcnt(0)
    buffer_store_dwordx4 v[212:215], v12, s[92:95], s39 offen sc1
.Lk2_noo2:
    s_add_u32 s52, s42, 8192
    buffer_load_dwordx4 v[144:147], v6, s[92:95], s52 offen offset:1024 sc1
    s_add_u32 s52, s43, 8192
    buffer_load_dwordx4 v[148:151], v6, s[92:95], s52 offen offset:1024 sc1
    s_add_u32 s52, s42, 8192
    buffer_load_dwordx4 v[152:155], v6, s[92:95], s52 offen offset:2048 sc1
    s_add_u32 s52, s43, 8192
    buffer_load_dwordx4 v[156:159], v6, s[92:95], s52 offen offset:2048 sc1
    s_add_u32 s52, s42, 12288
    buffer_load_dwordx4 v[160:163], v6, s[92:95], s52 offen offset:2048 sc1
    s_add_u32 s52, s43, 12288
    buffer_load_dwordx4 v[164:167], v6, s[92:95], s52 offen offset:2048 sc1
    s_add_u32 s52, s42, 12288
    buffer_load_dwordx4 v[168:171], v6, s[92:95], s52 offen offset:3072 sc1
    s_add_u32 s52, s43, 12288
    buffer_load_dwordx4 v[172:175], v6, s[92:95], s52 offen offset:3072 sc1
    v_lshlrev_b32 v12, 3, v0
    v_lshrrev_b32 v7, 2, v0
    v_mul_u32_u24 v1, 192, v7
    v_and_b32 v8, 3, v0
    v_lshl_add_u32 v1, v8, 3, v1
    s_mul_i32 s39, s45, 6144
    v_add_u32 v1, s39, v1
    v_mul_u32_u24 v9, 96, v7
    v_lshl_add_u32 v9, v8, 3, v9
    s_mul_i32 s39, s45, 3072
    v_add_u32 v9, s39, v9
    v_bfe_u32 v8, v0, 4, 1
    v_lshlrev_b32 v8, 5, v8
    v_sub_u32 v2, v1, v8
    v_add_u32 v2, 32, v2
    v_add_u32 v1, v1, v8
    s_mul_i32 s39, s88, 3072
    s_add_u32 s39, s39, 0x1e000
    v_add_u32 v10, s39, v6
    s_xor_b32 s40, s88, 4
    s_mul_i32 s39, s40, 3072
    s_add_u32 s39, s39, 0x1e000
    v_add_u32 v11, s39, v6
    s_waitcnt vmcnt(17) lgkmcnt(0)
    s_barrier
    s_cmp_lg_u32 s88, 7
    s_cbranch_scc1 .Lpub7
    s_lshl_b32 s86, s25, 3
    s_add_u32 s86, s86, 0x3302800
    v_mov_b32 v40, s90
    v_mov_b32 v41, s91
    v_mov_b32 v42, 0
    s_mov_b64 exec, 1
    buffer_store_dwordx2 v[40:41], v42, s[92:95], s86 offen sc1
    s_mov_b64 exec, -1
.Lpub7:
    s_waitcnt vmcnt(17)
    ds_read_b64_tr_b16 v[16:17], v1 offset:24576
    ds_read_b64_tr_b16 v[18:19], v1 offset:27648
    ds_read_b64_tr_b16 v[20:21], v2 offset:24576
    ds_read_b64_tr_b16 v[22:23], v2 offset:27648
    ds_read_b64_tr_b16 v[24:25], v1 offset:24640
    ds_read_b64_tr_b16 v[26:27], v1 offset:27712
    ds_read_b64_tr_b16 v[28:29], v2 offset:24640
    ds_read_b64_tr_b16 v[30:31], v2 offset:27712
    ds_read_b64_tr_b16 v[32:33], v1 offset:24704
    ds_read_b64_tr_b16 v[34:35], v1 offset:27776
    s_waitcnt vmcnt(16) lgkmcnt(8)
    v_mfma_f32_16x16x32_bf16 v[64:67], v[16:19], v[112:115], 0
    ds_read_b64_tr_b16 v[36:37], v2 offset:24704
    s_waitcnt vmcnt(15)
    v_mfma_f32_16x16x32_bf16 v[68:71], v[16:19], v[116:119], 0
    ds_read_b64_tr_b16 v[38:39], v2 offset:27776
    s_waitcnt lgkmcnt(8)
    v_mfma_f32_16x16x32_bf16 v[72:75], v[20:23], v[112:115], 0
    s_add_u32 s52, s42, 0
    buffer_load_dwordx4 v[176:179], v6, s[92:95], s52 offen offset:2048 sc1
    ds_read_b64_tr_b16 v[16:17], v1 offset:36864
    v_mfma_f32_16x16x32_bf16 v[76:79], v[20:23], v[116:119], 0
    ds_read_b64_tr_b16 v[18:19], v1 offset:39936
    s_waitcnt lgkmcnt(8)
    v_mfma_f32_16x16x32_bf16 v[80:83], v[24:27], v[112:115], 0
    ds_read_b64_tr_b16 v[20:21], v2 offset:36864
    s_add_u32 s52, s43, 0
    buffer_load_dwordx4 v[180:183], v6, s[92:95], s52 offen offset:2048 sc1
    v_mfma_f32_16x16x32_bf16 v[84:87], v[24:27], v[116:119], 0
    ds_read_b64_tr_b16 v[22:23], v2 offset:39936
    s_waitcnt lgkmcnt(8)
    v_mfma_f32_16x16x32_bf16 v[88:91], v[28:31], v[112:115], 0
    ds_read_b64_tr_b16 v[24:25], v1 offset:36928
    v_mfma_f32_16x16x32_bf16 v[92:95], v[28:31], v[116:119], 0
    s_add_u32 s51, s41, 0x7e000
    s_add_u32 m0, s71, 0x18000
    s_nop 0
    buffer_load_dwordx4 v3, s[32:35], s51 offen lds
    ds_read_b64_tr_b16 v[26:27], v1 offset:40000
    s_waitcnt lgkmcnt(8)
    v_mfma_f32_16x16x32_bf16 v[96:99], v[32:35], v[112:115], 0
    ds_read_b64_tr_b16 v[28:29], v2 offset:36928
    v_mfma_f32_16x16x32_bf16 v[100:103], v[32:35], v[116:119], 0
    ds_read_b64_tr_b16 v[30:31], v2 offset:40000
    s_add_u32 s50, s41, 0x7e000
    s_add_u32 m0, s71, 0x1a000
    s_nop 0
    buffer_load_dwordx4 v4, s[32:35], s50 offen lds
    s_waitcnt lgkmcnt(8)
    v_mfma_f32_16x16x32_bf16 v[104:107], v[36:39], v[112:115], 0
    ds_read_b64_tr_b16 v[32:33], v1 offset:36992
    v_mfma_f32_16x16x32_bf16 v[108:111], v[36:39], v[116:119], 0
    ds_read_b64_tr_b16 v[34:35], v1 offset:40064
    s_add_u32 s52, s42, 4096
    buffer_load_dwordx4 v[184:187], v6, s[92:95], s52 offen offset:3072 sc1
    s_waitcnt vmcnt(19) lgkmcnt(8)
    v_mfma_f32_16x16x32_bf16 v[64:67], v[16:19], v[120:123], v[64:67]
    ds_read_b64_tr_b16 v[36:37], v2 offset:36992
    s_waitcnt vmcnt(18)
    v_mfma_f32_16x16x32_bf16 v[68:71], v[16:19], v[124:127], v[68:71]
    ds_read_b64_tr_b16 v[38:39], v2 offset:40064
    s_waitcnt lgkmcnt(8)
    v_mfma_f32_16x16x32_bf16 v[72:75], v[20:23], v[120:123], v[72:75]
    s_add_u32 s52, s43, 4096
    buffer_load_dwordx4 v[188:191], v6, s[92:95], s52 offen offset:3072 sc1
    ds_read_b64_tr_b16 v[16:17], v1 offset:49152
    v_mfma_f32_16x16x32_bf16 v[76:79], v[20:23], v[124:127], v[76:79]
    ds_read_b64_tr_b16 v[18:19], v1 offset:52224
    s_waitcnt lgkmcnt(8)
    v_mfma_f32_16x16x32_bf16 v[80:83], v[24:27], v[120:123], v[80:83]
    ds_read_b64_tr_b16 v[20:21], v2 offset:49152
    s_add_u32 s51, s41, 0x7e000
    s_add_u32 m0, s71, 0x1c000
    s_nop 0
    buffer_load_dwordx4 v5, s[32:35], s51 offen lds
    v_mfma_f32_16x16x32_bf16 v[84:87], v[24:27], v[124:127], v[84:87]
    ds_read_b64_tr_b16 v[22:23], v2 offset:52224
    s_waitcnt lgkmcnt(8)
    v_mfma_f32_16x16x32_bf16 v[88:91], v[28:31], v[120:123], v[88:91]
    ds_read_b64_tr_b16 v[24:25], v1 offset:49216
    v_mfma_f32_16x16x32_bf16 v[92:95], v[28:31], v[124:127], v[92:95]
    s_add_u32 s50, s41, 0x12000
    s_add_u32 m0, s71, 0x0
    s_nop 0
    buffer_load_dwordx4 v3, s[32:35], s50 offen lds
    ds_read_b64_tr_b16 v[26:27], v1 offset:52288
    s_waitcnt lgkmcnt(8)
    v_mfma_f32_16x16x32_bf16 v[96:99], v[32:35], v[120:123], v[96:99]
    ds_read_b64_tr_b16 v[28:29], v2 offset:49216
    v_mfma_f32_16x16x32_bf16 v[100:103], v[32:35], v[124:127], v[100:103]
    ds_read_b64_tr_b16 v[30:31], v2 offset:52288
    s_lshr_b32 s51, s88, 2
    s_mul_i32 s51, s51, 0x24000
    s_add_u32 s51, s51, 0x12000
    s_add_u32 s51, s51, s41
    s_add_u32 m0, s71, 0x2000
    s_nop 0
    buffer_load_dwordx4 v4, s[32:35], s51 offen lds
    s_waitcnt lgkmcnt(8)
    v_mfma_f32_16x16x32_bf16 v[104:107], v[36:39], v[120:123], v[104:107]
    ds_read_b64_tr_b16 v[32:33], v1 offset:49280
    v_mfma_f32_16x16x32_bf16 v[108:111], v[36:39], v[124:127], v[108:111]
    ds_read_b64_tr_b16 v[34:35], v1 offset:52352
    s_add_u32 s50, s41, 0x36000
    s_add_u32 m0, s71, 0x4000
    s_nop 0
    buffer_load_dwordx4 v5, s[32:35], s50 offen lds
    s_barrier
    s_waitcnt vmcnt(22) lgkmcnt(8)
    v_mfma_f32_16x16x32_bf16 v[64:67], v[16:19], v[128:131], v[64:67]
    ds_read_b64_tr_b16 v[36:37], v2 offset:49280
    s_waitcnt vmcnt(21)
    v_mfma_f32_16x16x32_bf16 v[68:71], v[16:19], v[132:135], v[68:71]
    ds_read_b64_tr_b16 v[38:39], v2 offset:52352
    s_waitcnt lgkmcnt(8)
    v_mfma_f32_16x16x32_bf16 v[72:75], v[20:23], v[128:131], v[72:75]
    v_add_u32 v1, 0xf000, v1
    ds_read_b64_tr_b16 v[16:17], v1 offset:0
    v_mfma_f32_16x16x32_bf16 v[76:79], v[20:23], v[132:135], v[76:79]
    s_add_u32 s52, s42, 8192
    buffer_load_dwordx4 v[192:195], v6, s[92:95], s52 offen offset:3072 sc1
    ds_read_b64_tr_b16 v[18:19], v1 offset:3072
    s_waitcnt lgkmcnt(8)
    v_mfma_f32_16x16x32_bf16 v[80:83], v[24:27], v[128:131], v[80:83]
    v_add_u32 v2, 0xf000, v2
    ds_read_b64_tr_b16 v[20:21], v2 offset:0
    v_mfma_f32_16x16x32_bf16 v[84:87], v[24:27], v[132:135], v[84:87]
    ds_read_b64_tr_b16 v[22:23], v2 offset:3072
    s_waitcnt lgkmcnt(8)
    v_mfma_f32_16x16x32_bf16 v[88:91], v[28:31], v[128:131], v[88:91]
    s_add_u32 s52, s43, 8192
    buffer_load_dwordx4 v[196:199], v6, s[92:95], s52 offen offset:3072 sc1
    ds_read_b64_tr_b16 v[24:25], v1 offset:64
    v_mfma_f32_16x16x32_bf16 v[92:95], v[28:31], v[132:135], v[92:95]
    ds_read_b64_tr_b16 v[26:27], v1 offset:3136
    s_waitcnt lgkmcnt(8)
    v_mfma_f32_16x16x32_bf16 v[96:99], v[32:35], v[128:131], v[96:99]
    ds_read_b64_tr_b16 v[28:29], v2 offset:64
    v_mfma_f32_16x16x32_bf16 v[100:103], v[32:35], v[132:135], v[100:103]
    ds_read_b64_tr_b16 v[30:31], v2 offset:3136
    s_add_u32 s51, s41, 0x63000
    s_add_u32 m0, s71, 0x6000
    s_nop 0
    buffer_load_dwordx4 v3, s[32:35], s51 offen lds
    s_waitcnt lgkmcnt(8)
    v_mfma_f32_16x16x32_bf16 v[104:107], v[36:39], v[128:131], v[104:107]
    ds_read_b64_tr_b16 v[32:33], v1 offset:128
    v_mfma_f32_16x16x32_bf16 v[108:111], v[36:39], v[132:135], v[108:111]
    ds_read_b64_tr_b16 v[34:35], v1 offset:3200
    s_waitcnt vmcnt(23) lgkmcnt(8)
    v_mfma_f32_16x16x32_bf16 v[64:67], v[16:19], v[136:139], v[64:67]
    ds_read_b64_tr_b16 v[36:37], v2 offset:128
    s_waitcnt vmcnt(22)
    v_mfma_f32_16x16x32_bf16 v[68:71], v[16:19], v[140:143], v[68:71]
    s_lshr_b32 s50, s88, 2
    s_mul_i32 s50, s50, 0x24000
    s_add_u32 s50, s50, 0x63000
    s_add_u32 s50, s50, s41
    s_add_u32 m0, s71, 0x8000
    s_nop 0
    buffer_load_dwordx4 v4, s[32:35], s50 offen lds
    ds_read_b64_tr_b16 v[38:39], v2 offset:3200
    s_waitcnt lgkmcnt(8)
    v_mfma_f32_16x16x32_bf16 v[72:75], v[20:23], v[136:139], v[72:75]
    ds_read_b64_tr_b16 v[16:17], v1 offset:12288
    v_mfma_f32_16x16x32_bf16 v[76:79], v[20:23], v[140:143], v[76:79]
    ds_read_b64_tr_b16 v[18:19], v1 offset:15360
    s_waitcnt lgkmcnt(8)
    v_mfma_f32_16x16x32_bf16 v[80:83], v[24:27], v[136:139], v[80:83]
    ds_read_b64_tr_b16 v[20:21], v2 offset:12288
    s_add_u32 s52, s42, 16384
    buffer_load_dwordx4 v[200:203], v6, s[92:95], s52 offen offset:0 sc1
    v_mfma_f32_16x16x32_bf16 v[84:87], v[24:27], v[140:143], v[84:87]
    ds_read_b64_tr_b16 v[22:23], v2 offset:15360
    s_waitcnt lgkmcnt(8)
    v_mfma_f32_16x16x32_bf16 v[88:91], v[28:31], v[136:139], v[88:91]
    ds_read_b64_tr_b16 v[24:25], v1 offset:12352
    v_mfma_f32_16x16x32_bf16 v[92:95], v[28:31], v[140:143], v[92:95]
    ds_read_b64_tr_b16 v[26:27], v1 offset:15424
    s_waitcnt lgkmcnt(8)
    v_mfma_f32_16x16x32_bf16 v[96:99], v[32:35], v[136:139], v[96:99]
    s_add_u32 s52, s43, 16384
    buffer_load_dwordx4 v[204:207], v6, s[92:95], s52 offen offset:0 sc1
    ds_read_b64_tr_b16 v[28:29], v2 offset:12352
    v_mfma_f32_16x16x32_bf16 v[100:103], v[32:35], v[140:143], v[100:103]
    ds_read_b64_tr_b16 v[30:31], v2 offset:15424
    s_waitcnt lgkmcnt(8)
    v_mfma_f32_16x16x32_bf16 v[104:107], v[36:39], v[136:139], v[104:107]
    ds_read_b64_tr_b16 v[32:33], v1 offset:12416
    v_mfma_f32_16x16x32_bf16 v[108:111], v[36:39], v[140:143], v[108:111]
    ds_read_b64_tr_b16 v[34:35], v1 offset:15488
    s_add_u32 s51, s41, 0x87000
    s_add_u32 m0, s71, 0xa000
    s_nop 0
    buffer_load_dwordx4 v5, s[32:35], s51 offen lds
    s_waitcnt vmcnt(13)
    s_nop 0
    s_cmp_lg_u32 s88, 7
    s_cbranch_scc1 .Lwf8_done
    v_and_b32 v40, 7, v0
    v_add_u32 v40, s24, v40
    v_lshlrev_b32 v40, 3, v40
    s_mov_b32 s87, 0
.Lwf8_loop:
    s_mov_b32 s86, 0x3302800
    buffer_load_dwordx2 v[44:45], v40, s[92:95], s86 offen sc1
    s_waitcnt vmcnt(0)
    v_xor_b32 v44, s90, v44
    v_xor_b32 v45, s91, v45
    v_lshrrev_b32 v43, 4, v45
    v_or_b32 v42, v44, v43
    v_cmp_ne_u32 vcc, 0, v42
    s_nop 4
    s_cbranch_vccz .Lwf8_ok
    s_sleep 1
    s_add_u32 s87, s87, 1
    s_cmp_lt_u32 s87, 0x40000
    s_cbranch_scc1 .Lwf8_loop
.Lwf8_ok:
.Lwf8_done:
    s_barrier
    s_waitcnt lgkmcnt(8)
    v_mfma_f32_16x16x32_bf16 v[64:67], v[16:19], v[144:147], v[64:67]
    ds_read_b64_tr_b16 v[36:37], v2 offset:12416
    v_mfma_f32_16x16x32_bf16 v[68:71], v[16:19], v[148:151], v[68:71]
    ds_read_b64_tr_b16 v[38:39], v2 offset:15488
    s_waitcnt lgkmcnt(8)
    v_mfma_f32_16x16x32_bf16 v[72:75], v[20:23], v[144:147], v[72:75]
    ds_read_b64_tr_b16 v[16:17], v1 offset:24576
    s_add_u32 s52, s42, 0
    buffer_load_dwordx4 v[208:211], v6, s[92:95], s52 offen offset:3072 sc1
    v_mfma_f32_16x16x32_bf16 v[76:79], v[20:23], v[148:151], v[76:79]
    ds_read_b64_tr_b16 v[18:19], v1 offset:27648
    s_waitcnt lgkmcnt(8)
    v_mfma_f32_16x16x32_bf16 v[80:83], v[24:27], v[144:147], v[80:83]
    ds_read_b64_tr_b16 v[20:21], v2 offset:24576
    v_mfma_f32_16x16x32_bf16 v[84:87], v[24:27], v[148:151], v[84:87]
    s_add_u32 s52, s43, 0
    buffer_load_dwordx4 v[212:215], v6, s[92:95], s52 offen offset:3072 sc1
    ds_read_b64_tr_b16 v[22:23], v2 offset:27648
    s_waitcnt lgkmcnt(8)
    v_mfma_f32_16x16x32_bf16 v[88:91], v[28:31], v[144:147], v[88:91]
    ds_read_b64_tr_b16 v[24:25], v1 offset:24640
    v_mfma_f32_16x16x32_bf16 v[92:95], v[28:31], v[148:151], v[92:95]
    ds_read_b64_tr_b16 v[26:27], v1 offset:27712
    s_add_u32 s50, s41, 0x1b000
    s_add_u32 m0, s71, 0xc000
    s_nop 0
    buffer_load_dwordx4 v3, s[32:35], s50 offen lds
    s_waitcnt lgkmcnt(8)
    v_mfma_f32_16x16x32_bf16 v[96:99], v[32:35], v[144:147], v[96:99]
    ds_read_b64_tr_b16 v[28:29], v2 offset:24640
    v_mfma_f32_16x16x32_bf16 v[100:103], v[32:35], v[148:151], v[100:103]
    ds_read_b64_tr_b16 v[30:31], v2 offset:27712
    s_waitcnt lgkmcnt(8)
    v_mfma_f32_16x16x32_bf16 v[104:107], v[36:39], v[144:147], v[104:107]
    ds_read_b64_tr_b16 v[32:33], v1 offset:24704
    s_add_u32 s51, s41, 0x1b000
    s_add_u32 m0, s71, 0xe000
    s_nop 0
    buffer_load_dwordx4 v4, s[32:35], s51 offen lds
    v_mfma_f32_16x16x32_bf16 v[108:111], v[36:39], v[148:151], v[108:111]
    ds_read_b64_tr_b16 v[34:35], v1 offset:27776
    s_waitcnt lgkmcnt(8)
    v_mfma_f32_16x16x32_bf16 v[64:67], v[16:19], v[152:155], v[64:67]
    ds_read_b64_tr_b16 v[36:37], v2 offset:24704
    v_mfma_f32_16x16x32_bf16 v[68:71], v[16:19], v[156:159], v[68:71]
    s_add_u32 s52, s42, 4096
    buffer_load_dwordx2 v[216:217], v12, s[92:95], s52 offen offset:0 sc1
    ds_read_b64_tr_b16 v[38:39], v2 offset:27776
    s_waitcnt lgkmcnt(8)
    v_mfma_f32_16x16x32_bf16 v[72:75], v[20:23], v[152:155], v[72:75]
    ds_read_b64_tr_b16 v[16:17], v1 offset:36864
    v_mfma_f32_16x16x32_bf16 v[76:79], v[20:23], v[156:159], v[76:79]
    ds_read_b64_tr_b16 v[18:19], v1 offset:39936
    buffer_load_dwordx2 v[218:219], v12, s[92:95], s52 offen offset:512 sc1
    s_waitcnt lgkmcnt(8)
    v_mfma_f32_16x16x32_bf16 v[80:83], v[24:27], v[152:155], v[80:83]
    ds_read_b64_tr_b16 v[20:21], v2 offset:36864
    v_mfma_f32_16x16x32_bf16 v[84:87], v[24:27], v[156:159], v[84:87]
    ds_read_b64_tr_b16 v[22:23], v2 offset:39936
    s_waitcnt lgkmcnt(8)
    v_mfma_f32_16x16x32_bf16 v[88:91], v[28:31], v[152:155], v[88:91]
    ds_read_b64_tr_b16 v[24:25], v1 offset:36928
    s_add_u32 s52, s43, 4096
    buffer_load_dwordx2 v[220:221], v12, s[92:95], s52 offen offset:0 sc1
    v_mfma_f32_16x16x32_bf16 v[92:95], v[28:31], v[156:159], v[92:95]
    ds_read_b64_tr_b16 v[26:27], v1 offset:40000
    s_waitcnt lgkmcnt(8)
    v_mfma_f32_16x16x32_bf16 v[96:99], v[32:35], v[152:155], v[96:99]
    ds_read_b64_tr_b16 v[28:29], v2 offset:36928
    v_mfma_f32_16x16x32_bf16 v[100:103], v[32:35], v[156:159], v[100:103]
    buffer_load_dwordx2 v[222:223], v12, s[92:95], s52 offen offset:512 sc1
    ds_read_b64_tr_b16 v[30:31], v2 offset:40000
    s_waitcnt lgkmcnt(8)
    v_mfma_f32_16x16x32_bf16 v[104:107], v[36:39], v[152:155], v[104:107]
    ds_read_b64_tr_b16 v[32:33], v1 offset:36992
    v_mfma_f32_16x16x32_bf16 v[108:111], v[36:39], v[156:159], v[108:111]
    ds_read_b64_tr_b16 v[34:35], v1 offset:40064
    s_add_u32 s50, s41, 0x1b000
    s_add_u32 m0, s71, 0x10000
    s_nop 0
    buffer_load_dwordx4 v5, s[32:35], s50 offen lds
    s_waitcnt vmcnt(17)
    s_barrier
    s_waitcnt lgkmcnt(8)
    v_mfma_f32_16x16x32_bf16 v[64:67], v[16:19], v[160:163], v[64:67]
    ds_read_b64_tr_b16 v[36:37], v2 offset:36992
    v_mfma_f32_16x16x32_bf16 v[68:71], v[16:19], v[164:167], v[68:71]
    ds_read_b64_tr_b16 v[38:39], v2 offset:40064
    s_waitcnt lgkmcnt(8)
    v_mfma_f32_16x16x32_bf16 v[72:75], v[20:23], v[160:163], v[72:75]
    ds_read_b64_tr_b16 v[16:17], v1 offset:49152
    v_mfma_f32_16x16x32_bf16 v[76:79], v[20:23], v[164:167], v[76:79]
    s_cmp_lg_u32 s88, 7
    s_cbranch_scc1 .Lpub9
    s_lshl_b32 s86, s76, 3
    s_add_u32 s86, s86, 0x3302000
    v_mov_b32 v60, s90
    v_mov_b32 v61, s91
    v_mov_b32 v62, 0
    s_mov_b64 exec, 1
    buffer_store_dwordx2 v[60:61], v62, s[92:95], s86 offen sc1
    s_mov_b64 exec, -1
.Lpub9:
    ds_read_b64_tr_b16 v[18:19], v1 offset:52224
    s_waitcnt lgkmcnt(8)
    v_mfma_f32_16x16x32_bf16 v[80:83], v[24:27], v[160:163], v[80:83]
    ds_read_b64_tr_b16 v[20:21], v2 offset:49152
    v_mfma_f32_16x16x32_bf16 v[84:87], v[24:27], v[164:167], v[84:87]
    ds_read_b64_tr_b16 v[22:23], v2 offset:52224
    s_waitcnt lgkmcnt(8)
    v_mfma_f32_16x16x32_bf16 v[88:91], v[28:31], v[160:163], v[88:91]
    s_add_u32 s52, s42, 8192
    buffer_load_dwordx4 v[224:227], v6, s[92:95], s52 offen offset:0 sc1
    ds_read_b64_tr_b16 v[24:25], v1 offset:49216
    v_mfma_f32_16x16x32_bf16 v[92:95], v[28:31], v[164:167], v[92:95]
    ds_read_b64_tr_b16 v[26:27], v1 offset:52288
    s_waitcnt lgkmcnt(8)
    v_mfma_f32_16x16x32_bf16 v[96:99], v[32:35], v[160:163], v[96:99]
    ds_read_b64_tr_b16 v[28:29], v2 offset:49216
    v_mfma_f32_16x16x32_bf16 v[100:103], v[32:35], v[164:167], v[100:103]
    s_add_u32 s52, s43, 8192
    buffer_load_dwordx4 v[228:231], v6, s[92:95], s52 offen offset:0 sc1
    ds_read_b64_tr_b16 v[30:31], v2 offset:52288
    s_waitcnt lgkmcnt(8)
    v_mfma_f32_16x16x32_bf16 v[104:107], v[36:39], v[160:163], v[104:107]
    ds_read_b64_tr_b16 v[32:33], v1 offset:49280
    v_mfma_f32_16x16x32_bf16 v[108:111], v[36:39], v[164:167], v[108:111]
    ds_read_b64_tr_b16 v[34:35], v1 offset:52352
    s_waitcnt lgkmcnt(8)
    v_mfma_f32_16x16x32_bf16 v[64:67], v[16:19], v[168:171], v[64:67]
    s_add_u32 s51, s41, 0x48000
    s_add_u32 m0, s71, 0x12000
    s_nop 0
    buffer_load_dwordx4 v3, s[32:35], s51 offen lds
    ds_read_b64_tr_b16 v[36:37], v2 offset:49280
    v_mfma_f32_16x16x32_bf16 v[68:71], v[16:19], v[172:175], v[68:71]
    ds_read_b64_tr_b16 v[38:39], v2 offset:52352
    s_waitcnt lgkmcnt(8)
    v_mfma_f32_16x16x32_bf16 v[72:75], v[20:23], v[168:171], v[72:75]
    v_add_u32 v1, 0xffff1000, v1
    ds_read_b64_tr_b16 v[16:17], v1 offset:0
    v_mfma_f32_16x16x32_bf16 v[76:79], v[20:23], v[172:175], v[76:79]
    s_lshr_b32 s50, s88, 2
    s_mul_i32 s50, s50, 0x1b000
    s_add_u32 s50, s50, 0x48000
    s_add_u32 s50, s50, s41
    s_add_u32 m0, s71, 0x14000
    s_nop 0
    buffer_load_dwordx4 v4, s[32:35], s50 offen lds
    ds_read_b64_tr_b16 v[18:19], v1 offset:3072
    s_waitcnt lgkmcnt(8)
    v_mfma_f32_16x16x32_bf16 v[80:83], v[24:27], v[168:171], v[80:83]
    v_add_u32 v2, 0xffff1000, v2
    ds_read_b64_tr_b16 v[20:21], v2 offset:0
    v_mfma_f32_16x16x32_bf16 v[84:87], v[24:27], v[172:175], v[84:87]
    ds_read_b64_tr_b16 v[22:23], v2 offset:3072
    s_add_u32 s52, s42, 12288
    buffer_load_dwordx4 v[232:235], v6, s[92:95], s52 offen offset:0 sc1
    s_waitcnt lgkmcnt(8)
    v_mfma_f32_16x16x32_bf16 v[88:91], v[28:31], v[168:171], v[88:91]
    ds_read_b64_tr_b16 v[24:25], v1 offset:64
    v_mfma_f32_16x16x32_bf16 v[92:95], v[28:31], v[172:175], v[92:95]
    ds_read_b64_tr_b16 v[26:27], v1 offset:3136
    s_waitcnt lgkmcnt(8)
    v_mfma_f32_16x16x32_bf16 v[96:99], v[32:35], v[168:171], v[96:99]
    ds_read_b64_tr_b16 v[28:29], v2 offset:64
    s_add_u32 s52, s43, 12288
    buffer_load_dwordx4 v[236:239], v6, s[92:95], s52 offen offset:0 sc1
    v_mfma_f32_16x16x32_bf16 v[100:103], v[32:35], v[172:175], v[100:103]
    ds_read_b64_tr_b16 v[30:31], v2 offset:3136
    s_waitcnt lgkmcnt(8)
    v_mfma_f32_16x16x32_bf16 v[104:107], v[36:39], v[168:171], v[104:107]
    ds_read_b64_tr_b16 v[32:33], v1 offset:128
    v_mfma_f32_16x16x32_bf16 v[108:111], v[36:39], v[172:175], v[108:111]
    ds_read_b64_tr_b16 v[34:35], v1 offset:3200
    s_add_u32 s51, s41, 0x63000
    s_add_u32 m0, s71, 0x16000
    s_nop 0
    buffer_load_dwordx4 v5, s[32:35], s51 offen lds
    s_waitcnt vmcnt(19)
    s_barrier
    s_waitcnt lgkmcnt(8)
    v_mfma_f32_16x16x32_bf16 v[64:67], v[16:19], v[176:179], v[64:67]
    ds_read_b64_tr_b16 v[36:37], v2 offset:128
    v_mfma_f32_16x16x32_bf16 v[68:71], v[16:19], v[180:183], v[68:71]
    ds_read_b64_tr_b16 v[38:39], v2 offset:3200
    s_waitcnt lgkmcnt(8)
    v_mfma_f32_16x16x32_bf16 v[72:75], v[20:23], v[176:179], v[72:75]
    ds_read_b64_tr_b16 v[16:17], v1 offset:12288
    s_add_u32 s52, s42, 12288
    buffer_load_dwordx2 v[240:241], v12, s[92:95], s52 offen offset:1024 sc1
    v_mfma_f32_16x16x32_bf16 v[76:79], v[20:23], v[180:183], v[76:79]
    ds_read_b64_tr_b16 v[18:19], v1 offset:15360
    s_waitcnt lgkmcnt(8)
    v_mfma_f32_16x16x32_bf16 v[80:83], v[24:27], v[176:179], v[80:83]
    ds_read_b64_tr_b16 v[20:21], v2 offset:12288
    v_mfma_f32_16x16x32_bf16 v[84:87], v[24:27], v[180:183], v[84:87]
    buffer_load_dwordx2 v[242:243], v12, s[92:95], s52 offen offset:1536 sc1
    ds_read_b64_tr_b16 v[22:23], v2 offset:15360
    s_waitcnt lgkmcnt(8)
    v_mfma_f32_16x16x32_bf16 v[88:91], v[28:31], v[176:179], v[88:91]
    ds_read_b64_tr_b16 v[24:25], v1 offset:12352
    v_mfma_f32_16x16x32_bf16 v[92:95], v[28:31], v[180:183], v[92:95]
    ds_read_b64_tr_b16 v[26:27], v1 offset:15424
    s_add_u32 s52, s43, 12288
    buffer_load_dwordx2 v[244:245], v12, s[92:95], s52 offen offset:1024 sc1
    s_waitcnt lgkmcnt(8)
    v_mfma_f32_16x16x32_bf16 v[96:99], v[32:35], v[176:179], v[96:99]
    ds_read_b64_tr_b16 v[28:29], v2 offset:12352
    v_mfma_f32_16x16x32_bf16 v[100:103], v[32:35], v[180:183], v[100:103]
    ds_read_b64_tr_b16 v[30:31], v2 offset:15424
    s_waitcnt lgkmcnt(8)
    v_mfma_f32_16x16x32_bf16 v[104:107], v[36:39], v[176:179], v[104:107]
    ds_read_b64_tr_b16 v[32:33], v1 offset:12416
    buffer_load_dwordx2 v[246:247], v12, s[92:95], s52 offen offset:1536 sc1
    v_mfma_f32_16x16x32_bf16 v[108:111], v[36:39], v[180:183], v[108:111]
    ds_read_b64_tr_b16 v[34:35], v1 offset:15488
    s_waitcnt lgkmcnt(8)
    v_mfma_f32_16x16x32_bf16 v[64:67], v[16:19], v[184:187], v[64:67]
    ds_read_b64_tr_b16 v[36:37], v2 offset:12416
    v_mfma_f32_16x16x32_bf16 v[68:71], v[16:19], v[188:191], v[68:71]
    s_add_u32 s50, s41, 0x75000
    s_add_u32 m0, s71, 0x18000
    s_nop 0
    buffer_load_dwordx4 v3, s[32:35], s50 offen lds
    ds_read_b64_tr_b16 v[38:39], v2 offset:15488
    s_waitcnt lgkmcnt(8)
    v_mfma_f32_16x16x32_bf16 v[72:75], v[20:23], v[184:187], v[72:75]
    ds_read_b64_tr_b16 v[16:17], v1 offset:24576
    v_mfma_f32_16x16x32_bf16 v[76:79], v[20:23], v[188:191], v[76:79]
    ds_read_b64_tr_b16 v[18:19], v1 offset:27648
    s_lshr_b32 s51, s88, 2
    s_mul_i32 s51, s51, 0x1b000
    s_add_u32 s51, s51, 0x75000
    s_add_u32 s51, s51, s41
    s_add_u32 m0, s71, 0x1a000
    s_nop 0
    buffer_load_dwordx4 v4, s[32:35], s51 offen lds
    s_waitcnt lgkmcnt(8)
    v_mfma_f32_16x16x32_bf16 v[80:83], v[24:27], v[184:187], v[80:83]
    ds_read_b64_tr_b16 v[20:21], v2 offset:24576
    v_mfma_f32_16x16x32_bf16 v[84:87], v[24:27], v[188:191], v[84:87]
    ds_read_b64_tr_b16 v[22:23], v2 offset:27648
    s_waitcnt lgkmcnt(8)
    v_mfma_f32_16x16x32_bf16 v[88:91], v[28:31], v[184:187], v[88:91]
    ds_read_b64_tr_b16 v[24:25], v1 offset:24640
    s_add_u32 s52, s42, 16384
    buffer_load_dwordx4 v[248:251], v6, s[92:95], s52 offen offset:1024 sc1
    v_mfma_f32_16x16x32_bf16 v[92:95], v[28:31], v[188:191], v[92:95]
    ds_read_b64_tr_b16 v[26:27], v1 offset:27712
    s_waitcnt lgkmcnt(8)
    v_mfma_f32_16x16x32_bf16 v[96:99], v[32:35], v[184:187], v[96:99]
    ds_read_b64_tr_b16 v[28:29], v2 offset:24640
    v_mfma_f32_16x16x32_bf16 v[100:103], v[32:35], v[188:191], v[100:103]
    s_add_u32 s52, s43, 16384
    buffer_load_dwordx4 v[252:255], v6, s[92:95], s52 offen offset:1024 sc1
    ds_read_b64_tr_b16 v[30:31], v2 offset:27712
    s_waitcnt lgkmcnt(8)
    v_mfma_f32_16x16x32_bf16 v[104:107], v[36:39], v[184:187], v[104:107]
    ds_read_b64_tr_b16 v[32:33], v1 offset:24704
    v_mfma_f32_16x16x32_bf16 v[108:111], v[36:39], v[188:191], v[108:111]
    ds_read_b64_tr_b16 v[34:35], v1 offset:27776
    s_add_u32 s50, s41, 0x90000
    s_add_u32 m0, s71, 0x1c000
    s_nop 0
    buffer_load_dwordx4 v5, s[32:35], s50 offen lds
    s_waitcnt vmcnt(21)
    s_barrier
    s_waitcnt lgkmcnt(8)
    v_mfma_f32_16x16x32_bf16 v[64:67], v[16:19], v[192:195], v[64:67]
    ds_read_b64_tr_b16 v[36:37], v2 offset:24704
    s_lshl_b32 s39, s88, 6
    s_mov_b32 s40, 0x2aaab
    v_add_u32 v3, s39, v0
    v_mfma_f32_16x16x32_bf16 v[68:71], v[16:19], v[196:199], v[68:71]
    v_mul_u32_u24 v7, s40, v3
    ds_read_b64_tr_b16 v[38:39], v2 offset:27776
    v_lshrrev_b32 v7, 20, v7
    s_waitcnt lgkmcnt(8)
    v_mfma_f32_16x16x32_bf16 v[72:75], v[20:23], v[192:195], v[72:75]
    v_mul_u32_u24 v8, 6, v7
    ds_read_b64_tr_b16 v[16:17], v1 offset:36864
    v_sub_u32 v3, v3, v8
    v_mfma_f32_16x16x32_bf16 v[76:79], v[20:23], v[196:199], v[76:79]
    v_lshlrev_b32 v3, 4, v3
    ds_read_b64_tr_b16 v[18:19], v1 offset:39936
    v_bfe_u32 v8, v7, 5, 1
    s_waitcnt lgkmcnt(8)
    v_mfma_f32_16x16x32_bf16 v[80:83], v[24:27], v[192:195], v[80:83]
    v_mul_u32_u24 v8, 663552, v8
    ds_read_b64_tr_b16 v[20:21], v2 offset:36864
    v_add_u32 v3, v3, v8
    v_mfma_f32_16x16x32_bf16 v[84:87], v[24:27], v[196:199], v[84:87]
    v_lshrrev_b32 v8, 6, v7
    ds_read_b64_tr_b16 v[22:23], v2 offset:39936
    v_and_b32 v7, 31, v7
    s_waitcnt lgkmcnt(8)
    v_mfma_f32_16x16x32_bf16 v[88:91], v[28:31], v[192:195], v[88:91]
    v_lshl_add_u32 v7, v8, 5, v7
    ds_read_b64_tr_b16 v[24:25], v1 offset:36928
    v_mul_u32_u24 v7, 1152, v7
    v_mfma_f32_16x16x32_bf16 v[92:95], v[28:31], v[196:199], v[92:95]
    v_add_u32 v3, v3, v7
    ds_read_b64_tr_b16 v[26:27], v1 offset:40000
    v_add_u32 v4, s39, v0
    s_waitcnt lgkmcnt(8)
    v_mfma_f32_16x16x32_bf16 v[96:99], v[32:35], v[192:195], v[96:99]
    v_add_u32 v4, 512, v4
    ds_read_b64_tr_b16 v[28:29], v2 offset:36928
    v_mul_u32_u24 v7, s40, v4
    v_mfma_f32_16x16x32_bf16 v[100:103], v[32:35], v[196:199], v[100:103]
    v_lshrrev_b32 v7, 20, v7
    ds_read_b64_tr_b16 v[30:31], v2 offset:40000
    v_mul_u32_u24 v8, 6, v7
    s_waitcnt lgkmcnt(8)
    v_mfma_f32_16x16x32_bf16 v[104:107], v[36:39], v[192:195], v[104:107]
    v_sub_u32 v4, v4, v8
    ds_read_b64_tr_b16 v[32:33], v1 offset:36992
    v_lshlrev_b32 v4, 4, v4
    v_mfma_f32_16x16x32_bf16 v[108:111], v[36:39], v[196:199], v[108:111]
    v_bfe_u32 v8, v7, 5, 1
    ds_read_b64_tr_b16 v[34:35], v1 offset:40064
    v_mul_u32_u24 v8, 663552, v8
    s_waitcnt lgkmcnt(8)
    v_mfma_f32_16x16x32_bf16 v[64:67], v[16:19], v[200:203], v[64:67]
    v_add_u32 v4, v4, v8
    ds_read_b64_tr_b16 v[36:37], v2 offset:36992
    v_lshrrev_b32 v8, 6, v7
    v_mfma_f32_16x16x32_bf16 v[68:71], v[16:19], v[204:207], v[68:71]
    v_and_b32 v7, 31, v7
    ds_read_b64_tr_b16 v[38:39], v2 offset:40064
    v_lshl_add_u32 v7, v8, 5, v7
    s_waitcnt lgkmcnt(8)
    v_mfma_f32_16x16x32_bf16 v[72:75], v[20:23], v[200:203], v[72:75]
    v_mul_u32_u24 v7, 1152, v7
    ds_read_b64_tr_b16 v[16:17], v1 offset:49152
    v_add_u32 v4, v4, v7
    v_mfma_f32_16x16x32_bf16 v[76:79], v[20:23], v[204:207], v[76:79]
    v_add_u32 v5, s39, v0
    ds_read_b64_tr_b16 v[18:19], v1 offset:52224
    v_add_u32 v5, 1024, v5
    s_waitcnt lgkmcnt(8)
    v_mfma_f32_16x16x32_bf16 v[80:83], v[24:27], v[200:203], v[80:83]
    v_mul_u32_u24 v7, s40, v5
    ds_read_b64_tr_b16 v[20:21], v2 offset:49152
    v_lshrrev_b32 v7, 20, v7
    v_mfma_f32_16x16x32_bf16 v[84:87], v[24:27], v[204:207], v[84:87]
    v_mul_u32_u24 v8, 6, v7
    ds_read_b64_tr_b16 v[22:23], v2 offset:52224
    v_sub_u32 v5, v5, v8
    s_waitcnt lgkmcnt(8)
    v_mfma_f32_16x16x32_bf16 v[88:91], v[28:31], v[200:203], v[88:91]
    v_lshlrev_b32 v5, 4, v5
    ds_read_b64_tr_b16 v[24:25], v1 offset:49216
    v_bfe_u32 v8, v7, 5, 1
    v_mfma_f32_16x16x32_bf16 v[92:95], v[28:31], v[204:207], v[92:95]
    v_mul_u32_u24 v8, 663552, v8
    ds_read_b64_tr_b16 v[26:27], v1 offset:52288
    v_add_u32 v5, v5, v8
    s_waitcnt lgkmcnt(8)
    v_mfma_f32_16x16x32_bf16 v[96:99], v[32:35], v[200:203], v[96:99]
    v_lshrrev_b32 v8, 6, v7
    ds_read_b64_tr_b16 v[28:29], v2 offset:49216
    v_and_b32 v7, 31, v7
    v_mfma_f32_16x16x32_bf16 v[100:103], v[32:35], v[204:207], v[100:103]
    v_lshl_add_u32 v7, v8, 5, v7
    ds_read_b64_tr_b16 v[30:31], v2 offset:52288
    v_mul_u32_u24 v7, 1152, v7
    s_waitcnt lgkmcnt(8)
    v_mfma_f32_16x16x32_bf16 v[104:107], v[36:39], v[200:203], v[104:107]
    v_add_u32 v5, v5, v7
    ds_read_b64_tr_b16 v[32:33], v1 offset:49280
    s_add_u32 s51, s41, 0xc0
    s_add_u32 m0, s71, 0x0
    s_nop 0
    buffer_load_dwordx4 v3, s[32:35], s51 offen lds
    v_mfma_f32_16x16x32_bf16 v[108:111], v[36:39], v[204:207], v[108:111]
    s_add_u32 s50, s41, 0xc0
    s_add_u32 m0, s71, 0x2000
    s_nop 0
    buffer_load_dwordx4 v4, s[32:35], s50 offen lds
    ds_read_b64_tr_b16 v[34:35], v1 offset:52352
    s_add_u32 s51, s41, 0xc0
    s_add_u32 m0, s71, 0x4000
    s_nop 0
    buffer_load_dwordx4 v5, s[32:35], s51 offen lds
    s_waitcnt vmcnt(15)
    s_barrier
    s_waitcnt lgkmcnt(8)
    v_mfma_f32_16x16x32_bf16 v[64:67], v[16:19], v[208:211], v[64:67]
    ds_read_b64_tr_b16 v[36:37], v2 offset:49280
    v_mfma_f32_16x16x32_bf16 v[68:71], v[16:19], v[212:215], v[68:71]
    ds_read_b64_tr_b16 v[38:39], v2 offset:52352
    s_waitcnt lgkmcnt(8)
    v_mfma_f32_16x16x32_bf16 v[72:75], v[20:23], v[208:211], v[72:75]
    v_add_u32 v1, 0xf000, v1
    ds_read_b64_tr_b16 v[16:17], v1 offset:0
    v_mfma_f32_16x16x32_bf16 v[76:79], v[20:23], v[212:215], v[76:79]
    ds_read_b64_tr_b16 v[18:19], v1 offset:3072
    s_waitcnt lgkmcnt(8)
    v_mfma_f32_16x16x32_bf16 v[80:83], v[24:27], v[208:211], v[80:83]
    v_add_u32 v2, 0xf000, v2
    ds_read_b64_tr_b16 v[20:21], v2 offset:0
    v_mfma_f32_16x16x32_bf16 v[84:87], v[24:27], v[212:215], v[84:87]
    ds_read_b64_tr_b16 v[22:23], v2 offset:3072
    s_waitcnt lgkmcnt(8)
    v_mfma_f32_16x16x32_bf16 v[88:91], v[28:31], v[208:211], v[88:91]
    ds_read_b64_tr_b16 v[24:25], v1 offset:64
    v_mfma_f32_16x16x32_bf16 v[92:95], v[28:31], v[212:215], v[92:95]
    s_add_u32 s50, s41, 0x240c0
    s_add_u32 m0, s71, 0x6000
    s_nop 0
    buffer_load_dwordx4 v3, s[32:35], s50 offen lds
    ds_read_b64_tr_b16 v[26:27], v1 offset:3136
    s_waitcnt lgkmcnt(8)
    v_mfma_f32_16x16x32_bf16 v[96:99], v[32:35], v[208:211], v[96:99]
    ds_read_b64_tr_b16 v[28:29], v2 offset:64
    v_mfma_f32_16x16x32_bf16 v[100:103], v[32:35], v[212:215], v[100:103]
    ds_read_b64_tr_b16 v[30:31], v2 offset:3136
    s_waitcnt lgkmcnt(8)
    v_mfma_f32_16x16x32_bf16 v[104:107], v[36:39], v[208:211], v[104:107]
    ds_read_b64_tr_b16 v[32:33], v1 offset:128
    v_mfma_f32_16x16x32_bf16 v[108:111], v[36:39], v[212:215], v[108:111]
    ds_read_b64_tr_b16 v[34:35], v1 offset:3200
    s_waitcnt lgkmcnt(8)
    v_mfma_f32_16x16x32_bf16 v[64:67], v[16:19], v[216:219], v[64:67]
    ds_read_b64_tr_b16 v[36:37], v2 offset:128
    v_mfma_f32_16x16x32_bf16 v[68:71], v[16:19], v[220:223], v[68:71]
    ds_read_b64_tr_b16 v[38:39], v2 offset:3200
    s_waitcnt lgkmcnt(8)
    v_mfma_f32_16x16x32_bf16 v[72:75], v[20:23], v[216:219], v[72:75]
    ds_read_b64_tr_b16 v[16:17], v1 offset:12288
    v_mfma_f32_16x16x32_bf16 v[76:79], v[20:23], v[220:223], v[76:79]
    ds_read_b64_tr_b16 v[18:19], v1 offset:15360
    s_add_u32 s51, s41, 0x240c0
    s_add_u32 m0, s71, 0x8000
    s_nop 0
    buffer_load_dwordx4 v4, s[32:35], s51 offen lds
    s_waitcnt lgkmcnt(8)
    v_mfma_f32_16x16x32_bf16 v[80:83], v[24:27], v[216:219], v[80:83]
    ds_read_b64_tr_b16 v[20:21], v2 offset:12288
    v_mfma_f32_16x16x32_bf16 v[84:87], v[24:27], v[220:223], v[84:87]
    ds_read_b64_tr_b16 v[22:23], v2 offset:15360
    s_waitcnt lgkmcnt(8)
    v_mfma_f32_16x16x32_bf16 v[88:91], v[28:31], v[216:219], v[88:91]
    ds_read_b64_tr_b16 v[24:25], v1 offset:12352
    v_mfma_f32_16x16x32_bf16 v[92:95], v[28:31], v[220:223], v[92:95]
    ds_read_b64_tr_b16 v[26:27], v1 offset:15424
    s_waitcnt lgkmcnt(8)
    v_mfma_f32_16x16x32_bf16 v[96:99], v[32:35], v[216:219], v[96:99]
    ds_read_b64_tr_b16 v[28:29], v2 offset:12352
    v_mfma_f32_16x16x32_bf16 v[100:103], v[32:35], v[220:223], v[100:103]
    ds_read_b64_tr_b16 v[30:31], v2 offset:15424
    s_waitcnt lgkmcnt(8)
    v_mfma_f32_16x16x32_bf16 v[104:107], v[36:39], v[216:219], v[104:107]
    ds_read_b64_tr_b16 v[32:33], v1 offset:12416
    v_mfma_f32_16x16x32_bf16 v[108:111], v[36:39], v[220:223], v[108:111]
    ds_read_b64_tr_b16 v[34:35], v1 offset:15488
    s_add_u32 s50, s41, 0x240c0
    s_add_u32 m0, s71, 0xa000
    s_nop 0
    buffer_load_dwordx4 v5, s[32:35], s50 offen lds
    s_waitcnt vmcnt(9)
    s_barrier
    s_waitcnt lgkmcnt(8)
    v_mfma_f32_16x16x32_bf16 v[64:67], v[16:19], v[224:227], v[64:67]
    ds_read_b64_tr_b16 v[36:37], v2 offset:12416
    v_mfma_f32_16x16x32_bf16 v[68:71], v[16:19], v[228:231], v[68:71]
    ds_read_b64_tr_b16 v[38:39], v2 offset:15488
    s_waitcnt lgkmcnt(8)
    v_mfma_f32_16x16x32_bf16 v[72:75], v[20:23], v[224:227], v[72:75]
    ds_read_b64_tr_b16 v[16:17], v1 offset:24576
    v_mfma_f32_16x16x32_bf16 v[76:79], v[20:23], v[228:231], v[76:79]
    ds_read_b64_tr_b16 v[18:19], v1 offset:27648
    s_waitcnt lgkmcnt(8)
    v_mfma_f32_16x16x32_bf16 v[80:83], v[24:27], v[224:227], v[80:83]
    ds_read_b64_tr_b16 v[20:21], v2 offset:24576
    v_mfma_f32_16x16x32_bf16 v[84:87], v[24:27], v[228:231], v[84:87]
    ds_read_b64_tr_b16 v[22:23], v2 offset:27648
    s_waitcnt lgkmcnt(8)
    v_mfma_f32_16x16x32_bf16 v[88:91], v[28:31], v[224:227], v[88:91]
    ds_read_b64_tr_b16 v[24:25], v1 offset:24640
    v_mfma_f32_16x16x32_bf16 v[92:95], v[28:31], v[228:231], v[92:95]
    ds_read_b64_tr_b16 v[26:27], v1 offset:27712
    s_add_u32 s51, s41, 0x480c0
    s_add_u32 m0, s71, 0xc000
    s_nop 0
    buffer_load_dwordx4 v3, s[32:35], s51 offen lds
    s_waitcnt lgkmcnt(8)
    v_mfma_f32_16x16x32_bf16 v[96:99], v[32:35], v[224:227], v[96:99]
    ds_read_b64_tr_b16 v[28:29], v2 offset:24640
    v_mfma_f32_16x16x32_bf16 v[100:103], v[32:35], v[228:231], v[100:103]
    ds_read_b64_tr_b16 v[30:31], v2 offset:27712
    s_waitcnt lgkmcnt(8)
    v_mfma_f32_16x16x32_bf16 v[104:107], v[36:39], v[224:227], v[104:107]
    ds_read_b64_tr_b16 v[32:33], v1 offset:24704
    v_mfma_f32_16x16x32_bf16 v[108:111], v[36:39], v[228:231], v[108:111]
    ds_read_b64_tr_b16 v[34:35], v1 offset:27776
    s_waitcnt lgkmcnt(8)
    v_mfma_f32_16x16x32_bf16 v[64:67], v[16:19], v[232:235], v[64:67]
    ds_read_b64_tr_b16 v[36:37], v2 offset:24704
    v_mfma_f32_16x16x32_bf16 v[68:71], v[16:19], v[236:239], v[68:71]
    ds_read_b64_tr_b16 v[38:39], v2 offset:27776
    s_waitcnt lgkmcnt(8)
    v_mfma_f32_16x16x32_bf16 v[72:75], v[20:23], v[232:235], v[72:75]
    ds_read_b64_tr_b16 v[16:17], v1 offset:36864
    v_mfma_f32_16x16x32_bf16 v[76:79], v[20:23], v[236:239], v[76:79]
    ds_read_b64_tr_b16 v[18:19], v1 offset:39936
    s_add_u32 s50, s41, 0x480c0
    s_add_u32 m0, s71, 0xe000
    s_nop 0
    buffer_load_dwordx4 v4, s[32:35], s50 offen lds
    s_waitcnt lgkmcnt(8)
    v_mfma_f32_16x16x32_bf16 v[80:83], v[24:27], v[232:235], v[80:83]
    ds_read_b64_tr_b16 v[20:21], v2 offset:36864
    v_mfma_f32_16x16x32_bf16 v[84:87], v[24:27], v[236:239], v[84:87]
    ds_read_b64_tr_b16 v[22:23], v2 offset:39936
    s_waitcnt lgkmcnt(8)
    v_mfma_f32_16x16x32_bf16 v[88:91], v[28:31], v[232:235], v[88:91]
    ds_read_b64_tr_b16 v[24:25], v1 offset:36928
    v_mfma_f32_16x16x32_bf16 v[92:95], v[28:31], v[236:239], v[92:95]
    ds_read_b64_tr_b16 v[26:27], v1 offset:40000
    s_waitcnt lgkmcnt(8)
    v_mfma_f32_16x16x32_bf16 v[96:99], v[32:35], v[232:235], v[96:99]
    ds_read_b64_tr_b16 v[28:29], v2 offset:36928
    v_mfma_f32_16x16x32_bf16 v[100:103], v[32:35], v[236:239], v[100:103]
    ds_read_b64_tr_b16 v[30:31], v2 offset:40000
    s_waitcnt lgkmcnt(8)
    v_mfma_f32_16x16x32_bf16 v[104:107], v[36:39], v[232:235], v[104:107]
    ds_read_b64_tr_b16 v[32:33], v1 offset:36992
    v_mfma_f32_16x16x32_bf16 v[108:111], v[36:39], v[236:239], v[108:111]
    ds_read_b64_tr_b16 v[34:35], v1 offset:40064
    s_add_u32 s51, s41, 0x480c0
    s_add_u32 m0, s71, 0x10000
    s_nop 0
    buffer_load_dwordx4 v5, s[32:35], s51 offen lds
    s_waitcnt vmcnt(7)
    s_barrier
    s_waitcnt lgkmcnt(8)
    v_mfma_f32_16x16x32_bf16 v[64:67], v[16:19], v[240:243], v[64:67]
    ds_read_b64_tr_b16 v[36:37], v2 offset:36992
    v_mfma_f32_16x16x32_bf16 v[68:71], v[16:19], v[244:247], v[68:71]
    ds_read_b64_tr_b16 v[38:39], v2 offset:40064
    s_waitcnt lgkmcnt(8)
    v_mfma_f32_16x16x32_bf16 v[72:75], v[20:23], v[240:243], v[72:75]
    ds_read_b64_tr_b16 v[16:17], v1 offset:49152
    v_mfma_f32_16x16x32_bf16 v[76:79], v[20:23], v[244:247], v[76:79]
    ds_read_b64_tr_b16 v[18:19], v1 offset:52224
    s_waitcnt lgkmcnt(8)
    v_mfma_f32_16x16x32_bf16 v[80:83], v[24:27], v[240:243], v[80:83]
    ds_read_b64_tr_b16 v[20:21], v2 offset:49152
    v_mfma_f32_16x16x32_bf16 v[84:87], v[24:27], v[244:247], v[84:87]
    ds_read_b64_tr_b16 v[22:23], v2 offset:52224
    s_waitcnt lgkmcnt(8)
    v_mfma_f32_16x16x32_bf16 v[88:91], v[28:31], v[240:243], v[88:91]
    ds_read_b64_tr_b16 v[24:25], v1 offset:49216
    v_mfma_f32_16x16x32_bf16 v[92:95], v[28:31], v[244:247], v[92:95]
    ds_read_b64_tr_b16 v[26:27], v1 offset:52288
    s_add_u32 s50, s41, 0x6c0c0
    s_add_u32 m0, s71, 0x12000
    s_nop 0
    buffer_load_dwordx4 v3, s[32:35], s50 offen lds
    s_waitcnt lgkmcnt(8)
    v_mfma_f32_16x16x32_bf16 v[96:99], v[32:35], v[240:243], v[96:99]
    ds_read_b64_tr_b16 v[28:29], v2 offset:49216
    v_mfma_f32_16x16x32_bf16 v[100:103], v[32:35], v[244:247], v[100:103]
    ds_read_b64_tr_b16 v[30:31], v2 offset:52288
    s_waitcnt lgkmcnt(8)
    v_mfma_f32_16x16x32_bf16 v[104:107], v[36:39], v[240:243], v[104:107]
    ds_read_b64_tr_b16 v[32:33], v1 offset:49280
    v_mfma_f32_16x16x32_bf16 v[108:111], v[36:39], v[244:247], v[108:111]
    ds_read_b64_tr_b16 v[34:35], v1 offset:52352
    s_waitcnt lgkmcnt(8)
    v_mfma_f32_16x16x32_bf16 v[64:67], v[16:19], v[248:251], v[64:67]
    ds_read_b64_tr_b16 v[36:37], v2 offset:49280
    v_mfma_f32_16x16x32_bf16 v[68:71], v[16:19], v[252:255], v[68:71]
    ds_read_b64_tr_b16 v[38:39], v2 offset:52352
    s_waitcnt lgkmcnt(8)
    v_mfma_f32_16x16x32_bf16 v[72:75], v[20:23], v[248:251], v[72:75]
    ds_read_b64_tr_b16 v[16:17], v9 offset:0
    v_mfma_f32_16x16x32_bf16 v[76:79], v[20:23], v[252:255], v[76:79]
    ds_read_b64_tr_b16 v[18:19], v9 offset:1536
    s_add_u32 s51, s41, 0x6c0c0
    s_add_u32 m0, s71, 0x14000
    s_nop 0
    buffer_load_dwordx4 v4, s[32:35], s51 offen lds
    s_waitcnt lgkmcnt(8)
    v_mfma_f32_16x16x32_bf16 v[80:83], v[24:27], v[248:251], v[80:83]
    ds_read_b64_tr_b16 v[20:21], v9 offset:32
    v_mfma_f32_16x16x32_bf16 v[84:87], v[24:27], v[252:255], v[84:87]
    ds_read_b64_tr_b16 v[22:23], v9 offset:1568
    s_waitcnt lgkmcnt(8)
    v_mfma_f32_16x16x32_bf16 v[88:91], v[28:31], v[248:251], v[88:91]
    ds_read_b64_tr_b16 v[24:25], v9 offset:64
    v_mfma_f32_16x16x32_bf16 v[92:95], v[28:31], v[252:255], v[92:95]
    ds_read_b64_tr_b16 v[26:27], v9 offset:1600
    s_waitcnt lgkmcnt(8)
    v_mfma_f32_16x16x32_bf16 v[96:99], v[32:35], v[248:251], v[96:99]
    ds_read_b64_tr_b16 v[28:29], v9 offset:6144
    v_mfma_f32_16x16x32_bf16 v[100:103], v[32:35], v[252:255], v[100:103]
    ds_read_b64_tr_b16 v[30:31], v9 offset:7680
    s_waitcnt lgkmcnt(8)
    v_mfma_f32_16x16x32_bf16 v[104:107], v[36:39], v[248:251], v[104:107]
    ds_read_b64_tr_b16 v[32:33], v9 offset:6176
    v_mfma_f32_16x16x32_bf16 v[108:111], v[36:39], v[252:255], v[108:111]
    ds_read_b64_tr_b16 v[34:35], v9 offset:7712
    s_add_u32 s50, s41, 0x6c0c0
    s_add_u32 m0, s71, 0x16000
    s_nop 0
    buffer_load_dwordx4 v5, s[32:35], s50 offen lds
    s_waitcnt vmcnt(7)
    s_barrier
    s_waitcnt lgkmcnt(8)
    v_mfma_f32_16x16x32_bf16 v[40:43], v[16:19], v[112:115], 0
    ds_read_b64_tr_b16 v[36:37], v9 offset:6208
    v_mfma_f32_16x16x32_bf16 v[44:47], v[16:19], v[116:119], 0
    ds_read_b64_tr_b16 v[38:39], v9 offset:7744
    s_waitcnt lgkmcnt(8)
    v_mfma_f32_16x16x32_bf16 v[48:51], v[20:23], v[112:115], 0
    ds_read_b64_tr_b16 v[16:17], v9 offset:12288
    v_mfma_f32_16x16x32_bf16 v[52:55], v[20:23], v[116:119], 0
    ds_read_b64_tr_b16 v[18:19], v9 offset:13824
    s_waitcnt lgkmcnt(8)
    v_mfma_f32_16x16x32_bf16 v[56:59], v[24:27], v[112:115], 0
    ds_read_b64_tr_b16 v[20:21], v9 offset:12320
    s_add_u32 s51, s41, 0x900c0
    s_add_u32 m0, s71, 0x18000
    s_nop 0
    buffer_load_dwordx4 v3, s[32:35], s51 offen lds
    v_mfma_f32_16x16x32_bf16 v[60:63], v[24:27], v[116:119], 0
    ds_read_b64_tr_b16 v[22:23], v9 offset:13856
    s_waitcnt lgkmcnt(8)
    v_mfma_f32_16x16x32_bf16 v[40:43], v[28:31], v[120:123], v[40:43]
    ds_read_b64_tr_b16 v[24:25], v9 offset:12352
    v_mfma_f32_16x16x32_bf16 v[44:47], v[28:31], v[124:127], v[44:47]
    ds_read_b64_tr_b16 v[26:27], v9 offset:13888
    s_waitcnt lgkmcnt(8)
    v_mfma_f32_16x16x32_bf16 v[48:51], v[32:35], v[120:123], v[48:51]
    ds_read_b64_tr_b16 v[28:29], v9 offset:18432
    v_mfma_f32_16x16x32_bf16 v[52:55], v[32:35], v[124:127], v[52:55]
    ds_read_b64_tr_b16 v[30:31], v9 offset:19968
    s_cmp_ge_u32 s88, 4
    s_cbranch_scc1 .Lk2_dma40
    s_add_u32 s50, s41, 0x900c0
    s_add_u32 m0, s71, 0x1a000
    s_nop 0
    buffer_load_dwordx4 v4, s[32:35], s50 offen lds
.Lk2_dma40:
    s_waitcnt lgkmcnt(8)
    v_mfma_f32_16x16x32_bf16 v[56:59], v[36:39], v[120:123], v[56:59]
    ds_read_b64_tr_b16 v[32:33], v9 offset:18464
    v_mfma_f32_16x16x32_bf16 v[60:63], v[36:39], v[124:127], v[60:63]
    ds_read_b64_tr_b16 v[34:35], v9 offset:20000
    s_waitcnt lgkmcnt(8)
    v_mfma_f32_16x16x32_bf16 v[40:43], v[16:19], v[176:179], v[40:43]
    ds_read_b64_tr_b16 v[36:37], v9 offset:18496
    v_mfma_f32_16x16x32_bf16 v[44:47], v[16:19], v[180:183], v[44:47]
    ds_read_b64_tr_b16 v[38:39], v9 offset:20032
    s_waitcnt lgkmcnt(8)
    v_mfma_f32_16x16x32_bf16 v[48:51], v[20:23], v[176:179], v[48:51]
    ds_write_b128 v10, v[68:71] offset:0
    ds_read_b64_tr_b16 v[16:17], v9 offset:24576
    v_mfma_f32_16x16x32_bf16 v[52:55], v[20:23], v[180:183], v[52:55]
    ds_read_b64_tr_b16 v[18:19], v9 offset:26112
    s_waitcnt lgkmcnt(9)
    v_mfma_f32_16x16x32_bf16 v[56:59], v[24:27], v[176:179], v[56:59]
    ds_read_b64_tr_b16 v[20:21], v9 offset:24608
    v_mfma_f32_16x16x32_bf16 v[60:63], v[24:27], v[180:183], v[60:63]
    ds_read_b64_tr_b16 v[22:23], v9 offset:26144
    s_waitcnt lgkmcnt(9)
    v_mfma_f32_16x16x32_bf16 v[40:43], v[28:31], v[208:211], v[40:43]
    ds_read_b64_tr_b16 v[24:25], v9 offset:24640
    v_mfma_f32_16x16x32_bf16 v[44:47], v[28:31], v[212:215], v[44:47]
    ds_write_b128 v10, v[76:79] offset:1024
    ds_read_b64_tr_b16 v[26:27], v9 offset:26176
    s_waitcnt lgkmcnt(10)
    v_mfma_f32_16x16x32_bf16 v[48:51], v[32:35], v[208:211], v[48:51]
    ds_read_b64_tr_b16 v[28:29], v9 offset:30720
    v_mfma_f32_16x16x32_bf16 v[52:55], v[32:35], v[212:215], v[52:55]
    ds_read_b64_tr_b16 v[30:31], v9 offset:32256
    s_waitcnt lgkmcnt(10)
    v_mfma_f32_16x16x32_bf16 v[56:59], v[36:39], v[208:211], v[56:59]
    ds_read_b64_tr_b16 v[32:33], v9 offset:30752
    v_mfma_f32_16x16x32_bf16 v[60:63], v[36:39], v[212:215], v[60:63]
    ds_read_b64_tr_b16 v[34:35], v9 offset:32288
    ds_write_b128 v10, v[84:87] offset:2048
    s_waitcnt vmcnt(5) lgkmcnt(0)
    s_nop 0
    s_cmp_lg_u32 s88, 7
    s_cbranch_scc1 .Lwf10_done
    v_and_b32 v112, 63, v0
    v_lshlrev_b32 v112, 3, v112
    s_mov_b32 s87, 0
.Lwf10_loop:
    s_mov_b32 s86, 0x3302000
    buffer_load_dwordx2 v[116:117], v112, s[92:95], s86 offen sc1
    s_mov_b32 s86, 0x3302200
    buffer_load_dwordx2 v[118:119], v112, s[92:95], s86 offen sc1
    s_mov_b32 s86, 0x3302400
    buffer_load_dwordx2 v[120:121], v112, s[92:95], s86 offen sc1
    s_mov_b32 s86, 0x3302600
    buffer_load_dwordx2 v[122:123], v112, s[92:95], s86 offen sc1
    s_waitcnt vmcnt(0)
    v_xor_b32 v116, s90, v116
    v_xor_b32 v117, s91, v117
    v_lshrrev_b32 v115, 4, v117
    v_or_b32 v114, v116, v115
    v_xor_b32 v118, s90, v118
    v_xor_b32 v119, s91, v119
    v_lshrrev_b32 v115, 4, v119
    v_or3_b32 v114, v118, v115, v114
    v_xor_b32 v120, s90, v120
    v_xor_b32 v121, s91, v121
    v_lshrrev_b32 v115, 4, v121
    v_or3_b32 v114, v120, v115, v114
    v_xor_b32 v122, s90, v122
    v_xor_b32 v123, s91, v123
    v_lshrrev_b32 v115, 4, v123
    v_or3_b32 v114, v122, v115, v114
    v_cmp_ne_u32 vcc, 0, v114
    s_nop 4
    s_cbranch_vccz .Lwf10_ok
    s_sleep 1
    s_add_u32 s87, s87, 1
    s_cmp_lt_u32 s87, 0x40000
    s_cbranch_scc1 .Lwf10_loop
.Lwf10_ok:
.Lwf10_done:
    s_barrier
    v_mfma_f32_16x16x32_bf16 v[40:43], v[16:19], v[216:219], v[40:43]
    ds_read_b64_tr_b16 v[36:37], v9 offset:30784
    v_mfma_f32_16x16x32_bf16 v[44:47], v[16:19], v[220:223], v[44:47]
    ds_read_b128 v[68:71], v11 offset:0
    ds_read_b64_tr_b16 v[38:39], v9 offset:32320
    v_mfma_f32_16x16x32_bf16 v[48:51], v[20:23], v[216:219], v[48:51]
    ds_read_b64_tr_b16 v[16:17], v9 offset:36864
    ds_read_b128 v[76:79], v11 offset:1024
    v_mfma_f32_16x16x32_bf16 v[52:55], v[20:23], v[220:223], v[52:55]
    ds_read_b64_tr_b16 v[18:19], v9 offset:38400
    ds_read_b128 v[84:87], v11 offset:2048
    v_mfma_f32_16x16x32_bf16 v[56:59], v[24:27], v[216:219], v[56:59]
    ds_read_b64_tr_b16 v[20:21], v9 offset:36896
    v_mfma_f32_16x16x32_bf16 v[60:63], v[24:27], v[220:223], v[60:63]
    s_waitcnt lgkmcnt(6)
    v_add_f32 v64, v64, v68
    ds_read_b64_tr_b16 v[22:23], v9 offset:38432
    v_mfma_f32_16x16x32_bf16 v[40:43], v[28:31], v[128:131], v[40:43]
    ds_read_b64_tr_b16 v[24:25], v9 offset:36928
    v_add_f32 v65, v65, v69
    v_mfma_f32_16x16x32_bf16 v[44:47], v[28:31], v[132:135], v[44:47]
    ds_read_b64_tr_b16 v[26:27], v9 offset:38464
    v_add_f32 v66, v66, v70
    v_mfma_f32_16x16x32_bf16 v[48:51], v[32:35], v[128:131], v[48:51]
    ds_read_b64_tr_b16 v[28:29], v9 offset:43008
    v_mfma_f32_16x16x32_bf16 v[52:55], v[32:35], v[132:135], v[52:55]
    v_add_f32 v67, v67, v71
    ds_read_b64_tr_b16 v[30:31], v9 offset:44544
    s_waitcnt lgkmcnt(10)
    v_mfma_f32_16x16x32_bf16 v[56:59], v[36:39], v[128:131], v[56:59]
    ds_read_b64_tr_b16 v[32:33], v9 offset:43040
    buffer_store_dwordx4 v[64:67], v6, s[92:95], s44 offen offset:0 sc1
    v_mfma_f32_16x16x32_bf16 v[60:63], v[36:39], v[132:135], v[60:63]
    ds_read_b64_tr_b16 v[34:35], v9 offset:44576
    s_waitcnt lgkmcnt(10)
    v_add_f32 v72, v72, v76
    s_waitcnt lgkmcnt(9)
    v_mfma_f32_16x16x32_bf16 v[40:43], v[16:19], v[136:139], v[40:43]
    ds_read_b64_tr_b16 v[36:37], v9 offset:43072
    v_mfma_f32_16x16x32_bf16 v[44:47], v[16:19], v[140:143], v[44:47]
    v_add_f32 v73, v73, v77
    ds_read_b64_tr_b16 v[38:39], v9 offset:44608
    s_waitcnt lgkmcnt(8)
    v_mfma_f32_16x16x32_bf16 v[48:51], v[20:23], v[136:139], v[48:51]
    ds_read_b64_tr_b16 v[16:17], v9 offset:49152
    v_add_f32 v74, v74, v78
    v_mfma_f32_16x16x32_bf16 v[52:55], v[20:23], v[140:143], v[52:55]
    ds_read_b64_tr_b16 v[18:19], v9 offset:50688
    v_add_f32 v75, v75, v79
    s_waitcnt lgkmcnt(8)
    v_mfma_f32_16x16x32_bf16 v[56:59], v[24:27], v[136:139], v[56:59]
    ds_read_b64_tr_b16 v[20:21], v9 offset:49184
    v_mfma_f32_16x16x32_bf16 v[60:63], v[24:27], v[140:143], v[60:63]
    buffer_store_dwordx4 v[72:75], v6, s[92:95], s44 offen offset:1024 sc1
    ds_read_b64_tr_b16 v[22:23], v9 offset:50720
    s_waitcnt lgkmcnt(8)
    v_mfma_f32_16x16x32_bf16 v[40:43], v[28:31], v[184:187], v[40:43]
    ds_read_b64_tr_b16 v[24:25], v9 offset:49216
    v_add_f32 v80, v80, v84
    v_mfma_f32_16x16x32_bf16 v[44:47], v[28:31], v[188:191], v[44:47]
    ds_read_b64_tr_b16 v[26:27], v9 offset:50752
    v_add_f32 v81, v81, v85
    s_waitcnt lgkmcnt(8)
    v_mfma_f32_16x16x32_bf16 v[48:51], v[32:35], v[184:187], v[48:51]
    ds_read_b64_tr_b16 v[28:29], v9 offset:55296
    v_mfma_f32_16x16x32_bf16 v[52:55], v[32:35], v[188:191], v[52:55]
    v_add_f32 v82, v82, v86
    ds_read_b64_tr_b16 v[30:31], v9 offset:56832
    s_waitcnt lgkmcnt(8)
    v_mfma_f32_16x16x32_bf16 v[56:59], v[36:39], v[184:187], v[56:59]
    ds_read_b64_tr_b16 v[32:33], v9 offset:55328
    v_add_f32 v83, v83, v87
    v_mfma_f32_16x16x32_bf16 v[60:63], v[36:39], v[188:191], v[60:63]
    ds_read_b64_tr_b16 v[34:35], v9 offset:56864
    buffer_store_dwordx4 v[80:83], v6, s[92:95], s44 offen offset:2048 sc1
    s_waitcnt vmcnt(5)
    s_barrier
    s_waitcnt lgkmcnt(8)
    v_mfma_f32_16x16x32_bf16 v[40:43], v[16:19], v[224:227], v[40:43]
    ds_read_b64_tr_b16 v[36:37], v9 offset:55360
    v_mfma_f32_16x16x32_bf16 v[44:47], v[16:19], v[228:231], v[44:47]
    ds_read_b64_tr_b16 v[38:39], v9 offset:56896
    s_waitcnt lgkmcnt(8)
    v_mfma_f32_16x16x32_bf16 v[48:51], v[20:23], v[224:227], v[48:51]
    ds_read_b64_tr_b16 v[16:17], v9 offset:61440
    ds_write_b128 v10, v[92:95] offset:0
    v_mfma_f32_16x16x32_bf16 v[52:55], v[20:23], v[228:231], v[52:55]
    ds_read_b64_tr_b16 v[18:19], v9 offset:62976
    s_waitcnt lgkmcnt(9)
    v_mfma_f32_16x16x32_bf16 v[56:59], v[24:27], v[224:227], v[56:59]
    ds_read_b64_tr_b16 v[20:21], v9 offset:61472
    v_mfma_f32_16x16x32_bf16 v[60:63], v[24:27], v[228:231], v[60:63]
    ds_write_b128 v10, v[100:103] offset:1024
    ds_read_b64_tr_b16 v[22:23], v9 offset:63008
    s_waitcnt lgkmcnt(10)
    v_mfma_f32_16x16x32_bf16 v[40:43], v[28:31], v[144:147], v[40:43]
    ds_read_b64_tr_b16 v[24:25], v9 offset:61504
    v_mfma_f32_16x16x32_bf16 v[44:47], v[28:31], v[148:151], v[44:47]
    ds_read_b64_tr_b16 v[26:27], v9 offset:63040
    s_waitcnt lgkmcnt(10)
    v_mfma_f32_16x16x32_bf16 v[48:51], v[32:35], v[144:147], v[48:51]
    ds_write_b128 v10, v[108:111] offset:2048
    v_add_u32 v9, 0x10800, v9
    ds_read_b64_tr_b16 v[28:29], v9 offset:0
    v_mfma_f32_16x16x32_bf16 v[52:55], v[32:35], v[148:151], v[52:55]
    ds_read_b64_tr_b16 v[30:31], v9 offset:1536
    s_waitcnt lgkmcnt(11)
    v_mfma_f32_16x16x32_bf16 v[56:59], v[36:39], v[144:147], v[56:59]
    s_load_dwordx2 s[56:57], s[0:1], 0
    ds_read_b64_tr_b16 v[32:33], v9 offset:32
    v_mfma_f32_16x16x32_bf16 v[60:63], v[36:39], v[148:151], v[60:63]
    ds_read_b64_tr_b16 v[34:35], v9 offset:1568
    s_waitcnt lgkmcnt(0)
    v_mfma_f32_16x16x32_bf16 v[40:43], v[16:19], v[152:155], v[40:43]
    ds_read_b64_tr_b16 v[36:37], v9 offset:64
    v_mfma_f32_16x16x32_bf16 v[44:47], v[16:19], v[156:159], v[44:47]
    s_load_dwordx2 s[60:61], s[0:1], 56
    ds_read_b64_tr_b16 v[38:39], v9 offset:1600
    v_mfma_f32_16x16x32_bf16 v[48:51], v[20:23], v[152:155], v[48:51]
    ds_read_b64_tr_b16 v[16:17], v9 offset:6144
    v_mfma_f32_16x16x32_bf16 v[52:55], v[20:23], v[156:159], v[52:55]
    ds_read_b64_tr_b16 v[18:19], v9 offset:7680
    s_load_dwordx2 s[64:65], s[0:1], 64
    v_mfma_f32_16x16x32_bf16 v[56:59], v[24:27], v[152:155], v[56:59]
    ds_read_b64_tr_b16 v[20:21], v9 offset:6176
    v_mfma_f32_16x16x32_bf16 v[60:63], v[24:27], v[156:159], v[60:63]
    ds_read_b64_tr_b16 v[22:23], v9 offset:7712
    v_mfma_f32_16x16x32_bf16 v[40:43], v[28:31], v[192:195], v[40:43]
    ds_read_b64_tr_b16 v[24:25], v9 offset:6208
    s_mov_b32 s58, 0x240000
    s_mov_b32 s59, 0x20000
    s_mov_b32 s62, 0x480
    s_mov_b32 s63, 0x20000
    s_mov_b32 s66, 0x240000
    s_mov_b32 s67, 0x20000
    s_lshl_b32 s68, s76, 6
    s_add_u32 s68, s68, 0x7c00
    s_add_u32 s78, s96, s68
    s_addc_u32 s79, s97, 0
    s_load_dwordx16 s[16:31], s[78:79], 0
    v_mfma_f32_16x16x32_bf16 v[44:47], v[28:31], v[196:199], v[44:47]
    ds_read_b64_tr_b16 v[26:27], v9 offset:7744
    v_mfma_f32_16x16x32_bf16 v[48:51], v[32:35], v[192:195], v[48:51]
    ds_read_b64_tr_b16 v[28:29], v9 offset:12288
    v_mfma_f32_16x16x32_bf16 v[52:55], v[32:35], v[196:199], v[52:55]
    s_add_u32 m0, s71, 0x24000
    s_add_u32 s69, s71, 0x4400
    buffer_load_dwordx4 v6, s[96:99], s69 offen lds
    ds_read_b64_tr_b16 v[30:31], v9 offset:13824
    s_waitcnt lgkmcnt(0)
    v_mfma_f32_16x16x32_bf16 v[56:59], v[36:39], v[192:195], v[56:59]
    ds_read_b64_tr_b16 v[32:33], v9 offset:12320
    v_mfma_f32_16x16x32_bf16 v[60:63], v[36:39], v[196:199], v[60:63]
    ds_read_b64_tr_b16 v[34:35], v9 offset:13856
    s_add_u32 m0, s71, 0x26000
    s_add_u32 s69, s71, 0x6400
    buffer_load_dwordx4 v6, s[96:99], s69 offen lds
    s_waitcnt vmcnt(5)
    s_barrier
    v_mfma_f32_16x16x32_bf16 v[40:43], v[16:19], v[232:235], v[40:43]
    ds_read_b64_tr_b16 v[36:37], v9 offset:12352
    s_lshl_b32 s39, s88, 6
    v_add_u32 v13, s39, v0
    v_mfma_f32_16x16x32_bf16 v[44:47], v[16:19], v[236:239], v[44:47]
    ds_read_b64_tr_b16 v[38:39], v9 offset:13888
    v_cmp_gt_u32 vcc, 289, v13
    v_mfma_f32_16x16x32_bf16 v[48:51], v[20:23], v[232:235], v[48:51]
    ds_read_b64_tr_b16 v[16:17], v9 offset:18432
    v_lshlrev_b32 v13, 7, v13
    v_mfma_f32_16x16x32_bf16 v[52:55], v[20:23], v[236:239], v[52:55]
    ds_read_b64_tr_b16 v[18:19], v9 offset:19968
    v_mov_b32 v14, 0x7ffffff0
    v_mfma_f32_16x16x32_bf16 v[56:59], v[24:27], v[232:235], v[56:59]
    ds_read_b64_tr_b16 v[20:21], v9 offset:18464
    v_cndmask_b32 v13, v14, v13, vcc
    v_mfma_f32_16x16x32_bf16 v[60:63], v[24:27], v[236:239], v[60:63]
    ds_read_b64_tr_b16 v[22:23], v9 offset:20000
    s_lshr_b32 s39, s76, 2
    s_mul_i32 s39, s39, 36992
    s_and_b32 s40, s76, 3
    s_lshl_b32 s40, s40, 5
    s_add_u32 s39, s39, s40
    s_add_u32 s39, s39, 0x2a00000
    buffer_load_dwordx4 v[144:147], v13, s[92:95], s39 offen sc1
    v_mfma_f32_16x16x32_bf16 v[40:43], v[28:31], v[240:243], v[40:43]
    ds_read_b64_tr_b16 v[24:25], v9 offset:18496
    buffer_load_dwordx4 v[148:151], v13, s[92:95], s39 offen offset:16 sc1
    v_mfma_f32_16x16x32_bf16 v[44:47], v[28:31], v[244:247], v[44:47]
    ds_read_b64_tr_b16 v[26:27], v9 offset:20032
    ds_read_b128 v[92:95], v11 offset:0
    s_waitcnt lgkmcnt(9)
    v_mfma_f32_16x16x32_bf16 v[48:51], v[32:35], v[240:243], v[48:51]
    ds_read_b64_tr_b16 v[28:29], v9 offset:24576
    ds_read_b128 v[100:103], v11 offset:1024
    v_mfma_f32_16x16x32_bf16 v[52:55], v[32:35], v[244:247], v[52:55]
    ds_read_b64_tr_b16 v[30:31], v9 offset:26112
    ds_read_b128 v[108:111], v11 offset:2048
    s_waitcnt lgkmcnt(11)
    v_mfma_f32_16x16x32_bf16 v[56:59], v[36:39], v[240:243], v[56:59]
    ds_read_b64_tr_b16 v[32:33], v9 offset:24608
    s_waitcnt lgkmcnt(5)
    v_add_f32 v88, v88, v92
    v_mfma_f32_16x16x32_bf16 v[60:63], v[36:39], v[244:247], v[60:63]
    ds_read_b64_tr_b16 v[34:35], v9 offset:26144
    v_add_f32 v89, v89, v93
    v_mfma_f32_16x16x32_bf16 v[40:43], v[16:19], v[160:163], v[40:43]
    v_add_f32 v90, v90, v94
    ds_read_b64_tr_b16 v[36:37], v9 offset:24640
    v_mfma_f32_16x16x32_bf16 v[44:47], v[16:19], v[164:167], v[44:47]
    v_add_f32 v91, v91, v95
    ds_read_b64_tr_b16 v[38:39], v9 offset:26176
    v_mfma_f32_16x16x32_bf16 v[48:51], v[20:23], v[160:163], v[48:51]
    s_add_u32 s44, s44, 3072
    buffer_store_dwordx4 v[88:91], v6, s[92:95], s44 offen offset:0 sc1
    ds_read_b64_tr_b16 v[16:17], v9 offset:30720
    v_mfma_f32_16x16x32_bf16 v[52:55], v[20:23], v[164:167], v[52:55]
    s_waitcnt lgkmcnt(7)
    v_add_f32 v96, v96, v100
    ds_read_b64_tr_b16 v[18:19], v9 offset:32256
    v_mfma_f32_16x16x32_bf16 v[56:59], v[24:27], v[160:163], v[56:59]
    v_add_f32 v97, v97, v101
    ds_read_b64_tr_b16 v[20:21], v9 offset:30752
    v_mfma_f32_16x16x32_bf16 v[60:63], v[24:27], v[164:167], v[60:63]
    v_add_f32 v98, v98, v102
    ds_read_b64_tr_b16 v[22:23], v9 offset:32288
    s_waitcnt lgkmcnt(9)
    v_mfma_f32_16x16x32_bf16 v[40:43], v[28:31], v[168:171], v[40:43]
    v_add_f32 v99, v99, v103
    ds_read_b64_tr_b16 v[24:25], v9 offset:30784
    v_mfma_f32_16x16x32_bf16 v[44:47], v[28:31], v[172:175], v[44:47]
    buffer_store_dwordx4 v[96:99], v6, s[92:95], s44 offen offset:1024 sc1
    ds_read_b64_tr_b16 v[26:27], v9 offset:32320
    s_waitcnt lgkmcnt(8)
    v_mfma_f32_16x16x32_bf16 v[48:51], v[32:35], v[168:171], v[48:51]
    v_add_f32 v104, v104, v108
    ds_read_b64_tr_b16 v[28:29], v9 offset:36864
    v_mfma_f32_16x16x32_bf16 v[52:55], v[32:35], v[172:175], v[52:55]
    v_add_f32 v105, v105, v109
    ds_read_b64_tr_b16 v[30:31], v9 offset:38400
    s_waitcnt lgkmcnt(8)
    v_mfma_f32_16x16x32_bf16 v[56:59], v[36:39], v[168:171], v[56:59]
    v_add_f32 v106, v106, v110
    ds_read_b64_tr_b16 v[32:33], v9 offset:36896
    v_mfma_f32_16x16x32_bf16 v[60:63], v[36:39], v[172:175], v[60:63]
    v_add_f32 v107, v107, v111
    ds_read_b64_tr_b16 v[34:35], v9 offset:38432
    buffer_store_dwordx4 v[104:107], v6, s[92:95], s44 offen offset:2048 sc1
    s_barrier
    s_waitcnt lgkmcnt(8)
    v_mfma_f32_16x16x32_bf16 v[40:43], v[16:19], v[200:203], v[40:43]
    ds_read_b64_tr_b16 v[36:37], v9 offset:36928
    v_lshlrev_b32 v5, 3, v0
    v_mfma_f32_16x16x32_bf16 v[44:47], v[16:19], v[204:207], v[44:47]
    v_cmp_gt_u32 vcc, 16, v0
    ds_read_b64_tr_b16 v[38:39], v9 offset:38464
    v_mov_b32 v4, 0x7ffffff0
    s_waitcnt lgkmcnt(8)
    v_mfma_f32_16x16x32_bf16 v[48:51], v[20:23], v[200:203], v[48:51]
    v_mfma_f32_16x16x32_bf16 v[52:55], v[20:23], v[204:207], v[52:55]
    v_cndmask_b32 v7, v4, v5, vcc
    s_waitcnt lgkmcnt(6)
    v_mfma_f32_16x16x32_bf16 v[56:59], v[24:27], v[200:203], v[56:59]
    s_mov_b32 s69, 0x2d00000
    buffer_load_dwordx4 v[108:111], v6, s[92:95], s69 offen sc1
    v_mfma_f32_16x16x32_bf16 v[60:63], v[24:27], v[204:207], v[60:63]
    s_lshl_b32 s70, s88, 8
    s_add_u32 s70, s70, s76
    s_mul_i32 s70, s70, 1152
    buffer_load_dwordx2 v[156:157], v5, s[56:59], s70 offen offset:0
    s_waitcnt lgkmcnt(4)
    v_mfma_f32_16x16x32_bf16 v[40:43], v[28:31], v[248:251], v[40:43]
    buffer_load_dwordx2 v[162:163], v5, s[60:63], 0 offen offset:0
    v_mfma_f32_16x16x32_bf16 v[44:47], v[28:31], v[252:255], v[44:47]
    s_waitcnt lgkmcnt(2)
    v_mfma_f32_16x16x32_bf16 v[48:51], v[32:35], v[248:251], v[48:51]
    buffer_load_dwordx2 v[158:159], v5, s[56:59], s70 offen offset:512
    v_mfma_f32_16x16x32_bf16 v[52:55], v[32:35], v[252:255], v[52:55]
    buffer_load_dwordx2 v[164:165], v5, s[60:63], 0 offen offset:512
    s_waitcnt lgkmcnt(0)
    v_mfma_f32_16x16x32_bf16 v[56:59], v[36:39], v[248:251], v[56:59]
    buffer_load_dwordx2 v[160:161], v7, s[56:59], s70 offen offset:1024
    v_mfma_f32_16x16x32_bf16 v[60:63], v[36:39], v[252:255], v[60:63]
    buffer_load_dwordx2 v[166:167], v7, s[60:63], 0 offen offset:1024
    ds_write_b128 v10, v[44:47] offset:0
    s_nop 0
    ds_write_b128 v10, v[52:55] offset:1024
    s_nop 3
    ds_write_b128 v10, v[60:63] offset:2048
    s_lshl_b32 s39, s37, 4
    s_lshl_b32 s40, s36, 2
    s_add_u32 s39, s39, s40
    s_add_u32 s77, s39, s38
    s_waitcnt lgkmcnt(0)
    s_waitcnt vmcnt(7)
    s_barrier
    s_cmp_lg_u32 s88, 7
    s_cbranch_scc1 .Lpub11
    s_lshl_b32 s86, s77, 3
    s_add_u32 s86, s86, 0x3303000
    v_mov_b32 v16, s90
    v_mov_b32 v17, s91
    v_mov_b32 v18, 0
    s_mov_b64 exec, 1
    buffer_store_dwordx2 v[16:17], v18, s[92:95], s86 offen sc1
    s_mov_b64 exec, -1
.Lpub11:
    ds_read_b128 v[44:47], v11 offset:0
    ds_read_b128 v[52:55], v11 offset:1024
    ds_read_b128 v[60:63], v11 offset:2048
    s_waitcnt lgkmcnt(2)
    v_add_f32 v40, v40, v44
    v_add_f32 v41, v41, v45
    v_add_f32 v42, v42, v46
    v_add_f32 v43, v43, v47
    buffer_store_dwordx4 v[40:43], v6, s[92:95], s54 offen offset:0 sc1
    s_waitcnt lgkmcnt(1)
    v_add_f32 v48, v48, v52
    v_add_f32 v49, v49, v53
    v_add_f32 v50, v50, v54
    v_add_f32 v51, v51, v55
    buffer_store_dwordx4 v[48:51], v6, s[92:95], s54 offen offset:1024 sc1
    s_waitcnt lgkmcnt(0)
    v_add_f32 v56, v56, v60
    v_add_f32 v57, v57, v61
    v_add_f32 v58, v58, v62
    v_add_f32 v59, v59, v63
    buffer_store_dwordx4 v[56:59], v6, s[92:95], s54 offen offset:2048 sc1
    s_lshl_b32 s68, s88, 6
    v_add_u32 v1, s68, v0
    v_add_u32 v168, 0x24000, v6
    v_lshrrev_b32 v169, 3, v1
    v_lshlrev_b32 v169, 8, v169
    v_and_b32 v3, 7, v1
    v_lshl_add_u32 v169, v3, 4, v169
    v_mov_b32 v4, 0x7ffffff0
    v_cmp_gt_u32 vcc, 256, v1
    s_nop 1
    v_cndmask_b32 v170, v4, v169, vcc
    v_cmp_gt_u32 vcc, 384, v1
    s_nop 1
    v_cndmask_b32 v171, v4, v169, vcc
    v_mul_u32_u24 v3, 2320, v3
    v_bfe_u32 v4, v1, 3, 2
    v_lshl_add_u32 v3, v4, 4, v3
    v_lshrrev_b32 v4, 5, v1
    v_add_u32 v172, 0, v4
    v_mul_u32_u24 v2, 43, v172
    v_lshrrev_b32 v2, 8, v2
    v_mul_u32_u24 v2, 3, v2
    v_add3_u32 v172, v172, v2, 0
    v_lshl_add_u32 v172, v172, 6, v3
    v_add_u32 v173, 16, v4
    v_mul_u32_u24 v2, 43, v173
    v_lshrrev_b32 v2, 8, v2
    v_mul_u32_u24 v2, 3, v2
    v_add3_u32 v173, v173, v2, 0
    v_lshl_add_u32 v173, v173, 6, v3
    v_add_u32 v174, 0, v4
    v_mul_u32_u24 v2, 86, v174
    v_lshrrev_b32 v2, 8, v2
    v_mul_u32_u24 v2, 6, v2
    v_add3_u32 v174, v174, v2, 6
    v_lshl_add_u32 v174, v174, 6, v3
    s_lshr_b32 s72, s76, 1
    s_mul_i32 s72, s72, 36864
    s_and_b32 s69, s76, 1
    s_lshl_b32 s69, s69, 7
    s_add_u32 s72, s72, s69
    s_add_u32 s72, s72, 0x1200000
    s_cmp_ge_u32 s88, 5
    s_cbranch_scc1 .Lk3_nor8
    v_cvt_f32_f16 v3, v144
    v_cvt_f32_f16_sdwa v4, v144 dst_sel:DWORD dst_unused:UNUSED_PAD src0_sel:WORD_1
    v_mul_f32 v72, s16, v3
    v_mul_f32 v73, s16, v4
    v_mul_f32 v4, s17, v4
    v_mul_f32 v3, s17, v3
    v_add_f32 v72, v72, v4
    v_sub_f32 v73, v73, v3
    v_cvt_f32_f16 v3, v145
    v_cvt_f32_f16_sdwa v4, v145 dst_sel:DWORD dst_unused:UNUSED_PAD src0_sel:WORD_1
    v_mul_f32 v74, s18, v3
    v_mul_f32 v75, s18, v4
    v_mul_f32 v4, s19, v4
    v_mul_f32 v3, s19, v3
    v_add_f32 v74, v74, v4
    v_sub_f32 v75, v75, v3
    v_cvt_f32_f16 v3, v146
    v_cvt_f32_f16_sdwa v4, v146 dst_sel:DWORD dst_unused:UNUSED_PAD src0_sel:WORD_1
    v_mul_f32 v76, s20, v3
    v_mul_f32 v77, s20, v4
    v_mul_f32 v4, s21, v4
    v_mul_f32 v3, s21, v3
    v_add_f32 v76, v76, v4
    v_sub_f32 v77, v77, v3
    v_cvt_f32_f16 v3, v147
    v_cvt_f32_f16_sdwa v4, v147 dst_sel:DWORD dst_unused:UNUSED_PAD src0_sel:WORD_1
    v_mul_f32 v78, s22, v3
    v_mul_f32 v79, s22, v4
    v_mul_f32 v4, s23, v4
    v_mul_f32 v3, s23, v3
    v_add_f32 v78, v78, v4
    v_sub_f32 v79, v79, v3
    v_cvt_f32_f16 v3, v148
    v_cvt_f32_f16_sdwa v4, v148 dst_sel:DWORD dst_unused:UNUSED_PAD src0_sel:WORD_1
    v_mul_f32 v80, s24, v3
    v_mul_f32 v81, s24, v4
    v_mul_f32 v4, s25, v4
    v_mul_f32 v3, s25, v3
    v_add_f32 v80, v80, v4
    v_sub_f32 v81, v81, v3
    v_cvt_f32_f16 v3, v149
    v_cvt_f32_f16_sdwa v4, v149 dst_sel:DWORD dst_unused:UNUSED_PAD src0_sel:WORD_1
    v_mul_f32 v82, s26, v3
    v_mul_f32 v83, s26, v4
    v_mul_f32 v4, s27, v4
    v_mul_f32 v3, s27, v3
    v_add_f32 v82, v82, v4
    v_sub_f32 v83, v83, v3
    v_cvt_f32_f16 v3, v150
    v_cvt_f32_f16_sdwa v4, v150 dst_sel:DWORD dst_unused:UNUSED_PAD src0_sel:WORD_1
    v_mul_f32 v84, s28, v3
    v_mul_f32 v85, s28, v4
    v_mul_f32 v4, s29, v4
    v_mul_f32 v3, s29, v3
    v_add_f32 v84, v84, v4
    v_sub_f32 v85, v85, v3
    v_cvt_f32_f16 v3, v151
    v_cvt_f32_f16_sdwa v4, v151 dst_sel:DWORD dst_unused:UNUSED_PAD src0_sel:WORD_1
    v_mul_f32 v86, s30, v3
    v_mul_f32 v87, s30, v4
    v_mul_f32 v4, s31, v4
    v_mul_f32 v3, s31, v3
    v_add_f32 v86, v86, v4
    v_sub_f32 v87, v87, v3
    v_add_f32 v88, v72, v80
    v_add_f32 v89, v73, v81
    v_sub_f32 v96, v72, v80
    v_sub_f32 v97, v73, v81
    v_add_f32 v90, v74, v82
    v_add_f32 v91, v75, v83
    v_sub_f32 v98, v74, v82
    v_sub_f32 v99, v75, v83
    v_add_f32 v92, v76, v84
    v_add_f32 v93, v77, v85
    v_sub_f32 v100, v76, v84
    v_sub_f32 v101, v77, v85
    v_add_f32 v94, v78, v86
    v_add_f32 v95, v79, v87
    v_sub_f32 v102, v78, v86
    v_sub_f32 v103, v79, v87
    v_sub_f32 v80, v98, v99
    v_add_f32 v81, v99, v98
    v_add_f32 v82, v102, v103
    v_sub_f32 v83, v103, v102
    v_mul_f32 v98, 0x3f3504f3, v80
    v_mul_f32 v99, 0x3f3504f3, v81
    v_mul_f32 v102, 0xbf3504f3, v82
    v_mul_f32 v103, 0xbf3504f3, v83
    v_add_f32 v72, v88, v92
    v_add_f32 v73, v89, v93
    v_sub_f32 v74, v88, v92
    v_sub_f32 v75, v89, v93
    v_add_f32 v76, v90, v94
    v_add_f32 v77, v91, v95
    v_sub_f32 v78, v90, v94
    v_sub_f32 v79, v91, v95
    v_add_f32 v88, v72, v76
    v_add_f32 v89, v73, v77
    v_sub_f32 v92, v72, v76
    v_sub_f32 v93, v73, v77
    v_sub_f32 v90, v74, v79
    v_add_f32 v91, v75, v78
    v_add_f32 v94, v74, v79
    v_sub_f32 v95, v75, v78
    v_sub_f32 v80, v96, v101
    v_add_f32 v81, v97, v100
    v_add_f32 v82, v96, v101
    v_sub_f32 v83, v97, v100
    v_add_f32 v84, v98, v102
    v_add_f32 v85, v99, v103
    v_sub_f32 v86, v98, v102
    v_sub_f32 v87, v99, v103
    v_add_f32 v96, v80, v84
    v_add_f32 v97, v81, v85
    v_sub_f32 v100, v80, v84
    v_sub_f32 v101, v81, v85
    v_sub_f32 v98, v82, v87
    v_add_f32 v99, v83, v86
    v_add_f32 v102, v82, v87
    v_sub_f32 v103, v83, v86
    v_cmp_ne_u32 vcc, 0, v1
    v_mov_b32 v3, 0x120
    v_cmp_ne_u32 s[100:101], v3, v1
    s_nop 0
    s_and_b64 vcc, vcc, s[100:101]
    v_lshlrev_b32 v3, 2, v1
    v_min_u32 v3, 1180, v3
    v_cndmask_b32 v89, 0, v89, vcc
    v_cvt_pk_f16_f32 v64, v88, v89
    ds_write_b32 v3, v64 offset:0
    v_cndmask_b32 v97, 0, v97, vcc
    v_cvt_pk_f16_f32 v65, v96, v97
    ds_write_b32 v3, v65 offset:1184
    v_cndmask_b32 v91, 0, v91, vcc
    v_cvt_pk_f16_f32 v66, v90, v91
    ds_write_b32 v3, v66 offset:2368
    v_cndmask_b32 v99, 0, v99, vcc
    v_cvt_pk_f16_f32 v67, v98, v99
    ds_write_b32 v3, v67 offset:3552
    v_cndmask_b32 v93, 0, v93, vcc
    v_cvt_pk_f16_f32 v68, v92, v93
    ds_write_b32 v3, v68 offset:4736
    v_cndmask_b32 v101, 0, v101, vcc
    v_cvt_pk_f16_f32 v69, v100, v101
    ds_write_b32 v3, v69 offset:5920
    v_cndmask_b32 v95, 0, v95, vcc
    v_cvt_pk_f16_f32 v70, v94, v95
    ds_write_b32 v3, v70 offset:7104
    v_cndmask_b32 v103, 0, v103, vcc
    v_cvt_pk_f16_f32 v71, v102, v103
    ds_write_b32 v3, v71 offset:8288
.Lk3_nor8:
    s_waitcnt lgkmcnt(0)
    s_waitcnt vmcnt(0)
    s_barrier
    s_cmp_lg_u32 s88, 7
    s_cbranch_scc1 .Lpub12
    s_lshl_b32 s86, s77, 3
    s_add_u32 s86, s86, 0x3301000
    v_mov_b32 v120, s90
    v_mov_b32 v121, s91
    v_mov_b32 v122, 0
    s_mov_b64 exec, 1
    buffer_store_dwordx2 v[120:121], v122, s[92:95], s86 offen sc1
    s_mov_b64 exec, -1
.Lpub12:
    ds_read_b128 v[56:59], v168 offset:12288
    ds_read_b128 v[60:63], v168 offset:13312
    ds_read_b128 v[8:11], v168 offset:0
    ds_read_b128 v[12:15], v168 offset:1024
    ds_read_b128 v[16:19], v168 offset:2048
    ds_read_b128 v[20:23], v168 offset:3072
    ds_read_b128 v[24:27], v168 offset:4096
    ds_read_b128 v[28:31], v168 offset:5120
    ds_read_b128 v[32:35], v168 offset:6144
    ds_read_b128 v[36:39], v168 offset:7168
    ds_read_b128 v[40:43], v168 offset:8192
    ds_read_b128 v[44:47], v168 offset:9216
    ds_read_b128 v[48:51], v168 offset:10240
    ds_read_b128 v[52:55], v168 offset:11264
    s_mul_i32 s68, s88, 1184
    s_waitcnt lgkmcnt(13)
    v_add_u32 v56, s68, v56
    v_add_u32 v57, s68, v57
    v_add_u32 v58, s68, v58
    v_add_u32 v59, s68, v59
    s_waitcnt lgkmcnt(12)
    v_add_u32 v60, s68, v60
    v_add_u32 v61, s68, v61
    v_add_u32 v62, s68, v62
    v_add_u32 v63, s68, v63
    ds_read_b32 v64, v56 offset:0
    ds_read_b32 v65, v57 offset:0
    ds_read_b32 v66, v58 offset:0
    ds_read_b32 v67, v59 offset:0
    ds_read_b32 v68, v60 offset:0
    ds_read_b32 v69, v61 offset:0
    ds_read_b32 v70, v62 offset:0
    ds_read_b32 v71, v63 offset:0
    s_lshr_b32 s69, s76, 4
    s_lshl_b32 s69, s69, 4
    s_cmp_lg_u32 s88, 7
    s_cbranch_scc1 .Lwf13_done
    v_and_b32 v124, 15, v0
    v_add_u32 v124, s69, v124
    v_lshlrev_b32 v124, 3, v124
    s_mov_b32 s87, 0
.Lwf13_loop:
    s_mov_b32 s86, 0x3303000
    buffer_load_dwordx2 v[128:129], v124, s[92:95], s86 offen sc1
    s_waitcnt vmcnt(0)
    v_xor_b32 v128, s90, v128
    v_xor_b32 v129, s91, v129
    v_lshrrev_b32 v127, 4, v129
    v_or_b32 v126, v128, v127
    v_cmp_ne_u32 vcc, 0, v126
    s_nop 4
    s_cbranch_vccz .Lwf13_ok
    s_sleep 1
    s_add_u32 s87, s87, 1
    s_cmp_lt_u32 s87, 0x40000
    s_cbranch_scc1 .Lwf13_loop
.Lwf13_ok:
.Lwf13_done:
    s_barrier
    s_add_u32 s73, s72, 0x0
    buffer_load_dwordx4 v[176:179], v169, s[92:95], s73 offen sc1
    s_add_u32 s73, s72, 0x4000
    buffer_load_dwordx4 v[180:183], v170, s[92:95], s73 offen sc1
    s_add_u32 s73, s72, 0x480000
    buffer_load_dwordx4 v[188:191], v169, s[92:95], s73 offen sc1
    s_add_u32 s73, s72, 0x484000
    buffer_load_dwordx4 v[192:195], v170, s[92:95], s73 offen sc1
    s_add_u32 s73, s72, 0x900000
    buffer_load_dwordx4 v[200:203], v169, s[92:95], s73 offen sc1
    s_add_u32 s73, s72, 0x904000
    buffer_load_dwordx4 v[204:207], v170, s[92:95], s73 offen sc1
    s_add_u32 s73, s72, 0xd80000
    buffer_load_dwordx4 v[212:215], v169, s[92:95], s73 offen sc1
    s_add_u32 s73, s72, 0xd84000
    buffer_load_dwordx4 v[216:219], v170, s[92:95], s73 offen sc1
    v_max_u32 v108, v108, v109
    v_max_u32 v110, v110, v111
    v_max_u32 v108, v108, v110
    s_nop 1
    v_max_u32_dpp v108, v108, v108 row_ror:8 row_mask:0xf bank_mask:0xf
    s_nop 1
    v_max_u32_dpp v108, v108, v108 row_ror:4 row_mask:0xf bank_mask:0xf
    s_nop 1
    v_max_u32_dpp v108, v108, v108 row_ror:2 row_mask:0xf bank_mask:0xf
    s_nop 1
    v_max_u32_dpp v108, v108, v108 row_ror:1 row_mask:0xf bank_mask:0xf
    v_mov_b32 v3, v108
    s_nop 1
    v_permlane16_swap_b32 v108, v3
    v_max_u32 v108, v108, v3
    v_mov_b32 v3, v108
    s_nop 1
    v_permlane32_swap_b32 v108, v3
    v_max_u32 v108, v108, v3
    v_lshlrev_b32 v108, 16, v108
    v_frexp_exp_i32_f32 v108, v108
    v_ldexp_f32 v108, 1.0, v108
    s_waitcnt lgkmcnt(4)
    v_mfma_f32_16x16x32_f16 v[72:75], v[64:67], v[8:11], 0
    v_mfma_f32_16x16x32_f16 v[76:79], v[64:67], v[12:15], 0
    s_waitcnt lgkmcnt(0)
    v_mfma_f32_16x16x32_f16 v[80:83], v[68:71], v[8:11], 0
    v_mfma_f32_16x16x32_f16 v[84:87], v[68:71], v[12:15], 0
    s_nop 3
    v_mul_f32 v88, v72, v16
    v_mul_f32 v92, v72, v20
    v_mul_f32 v89, v73, v17
    v_mul_f32 v93, v73, v21
    v_mul_f32 v90, v74, v18
    v_mul_f32 v94, v74, v22
    v_mul_f32 v91, v75, v19
    v_mul_f32 v95, v75, v23
    v_fma_f32 v88, -v76, v20, v88
    v_fmac_f32 v92, v76, v16
    v_fma_f32 v89, -v77, v21, v89
    v_fmac_f32 v93, v77, v17
    v_fma_f32 v90, -v78, v22, v90
    v_fmac_f32 v94, v78, v18
    v_fma_f32 v91, -v79, v23, v91
    v_fmac_f32 v95, v79, v19
    v_cvt_pk_f16_f32 v64, v88, v92
    v_cvt_pk_f16_f32 v65, v89, v93
    v_cvt_pk_f16_f32 v66, v90, v94
    v_cvt_pk_f16_f32 v67, v91, v95
    v_mul_f32 v88, v80, v24
    v_mul_f32 v92, v80, v28
    v_mul_f32 v89, v81, v25
    v_mul_f32 v93, v81, v29
    v_mul_f32 v90, v82, v26
    v_mul_f32 v94, v82, v30
    v_mul_f32 v91, v83, v27
    v_mul_f32 v95, v83, v31
    v_fma_f32 v88, -v84, v28, v88
    v_fmac_f32 v92, v84, v24
    v_fma_f32 v89, -v85, v29, v89
    v_fmac_f32 v93, v85, v25
    v_fma_f32 v90, -v86, v30, v90
    v_fmac_f32 v94, v86, v26
    v_fma_f32 v91, -v87, v31, v91
    v_fmac_f32 v95, v87, v27
    v_cvt_pk_f16_f32 v68, v88, v92
    v_cvt_pk_f16_f32 v69, v89, v93
    v_cvt_pk_f16_f32 v70, v90, v94
    v_cvt_pk_f16_f32 v71, v91, v95
    v_mfma_f32_16x16x32_f16 v[72:75], v[64:67], v[32:35], 0
    v_mfma_f32_16x16x32_f16 v[76:79], v[64:67], v[40:43], 0
    v_mfma_f32_16x16x32_f16 v[80:83], v[64:67], v[48:51], 0
    v_mfma_f32_16x16x32_f16 v[72:75], v[68:71], v[36:39], v[72:75]
    v_mfma_f32_16x16x32_f16 v[76:79], v[68:71], v[44:47], v[76:79]
    v_mfma_f32_16x16x32_f16 v[80:83], v[68:71], v[52:55], v[80:83]
    v_and_b32 v3, 15, v0
    v_lshrrev_b32 v4, 4, v0
    v_lshl_add_u32 v3, v3, 2, v4
    v_lshlrev_b32 v3, 4, v3
    s_mul_i32 s68, s88, 3072
    s_add_u32 s68, s68, 9600
    v_add_u32 v3, s68, v3
    v_add_u32 v4, s68, v6
    ds_write_b128 v3, v[72:75] offset:0
    ds_write_b128 v3, v[76:79] offset:1024
    ds_write_b128 v3, v[80:83] offset:2048
    s_waitcnt lgkmcnt(0)
    ds_read_b128 v[84:87], v4 offset:0
    ds_read_b128 v[88:91], v4 offset:1024
    ds_read_b128 v[92:95], v4 offset:2048
    v_lshlrev_b32 v8, 16, v162
    v_and_b32 v9, 0xffff0000, v162
    v_lshlrev_b32 v20, 16, v156
    v_and_b32 v21, 0xffff0000, v156
    v_lshlrev_b32 v10, 16, v163
    v_and_b32 v11, 0xffff0000, v163
    v_lshlrev_b32 v22, 16, v157
    v_and_b32 v23, 0xffff0000, v157
    v_lshlrev_b32 v12, 16, v164
    v_and_b32 v13, 0xffff0000, v164
    v_lshlrev_b32 v24, 16, v158
    v_and_b32 v25, 0xffff0000, v158
    v_lshlrev_b32 v14, 16, v165
    v_and_b32 v15, 0xffff0000, v165
    v_lshlrev_b32 v26, 16, v159
    v_and_b32 v27, 0xffff0000, v159
    v_lshlrev_b32 v16, 16, v166
    v_and_b32 v17, 0xffff0000, v166
    v_lshlrev_b32 v28, 16, v160
    v_and_b32 v29, 0xffff0000, v160
    v_lshlrev_b32 v18, 16, v167
    v_and_b32 v19, 0xffff0000, v167
    v_lshlrev_b32 v30, 16, v161
    v_and_b32 v31, 0xffff0000, v161
    s_waitcnt lgkmcnt(2)
    v_mul_f32 v84, v108, v84
    v_mul_f32 v85, v108, v85
    v_mul_f32 v86, v108, v86
    v_mul_f32 v87, v108, v87
    s_waitcnt lgkmcnt(1)
    v_mul_f32 v88, v108, v88
    v_mul_f32 v89, v108, v89
    v_mul_f32 v90, v108, v90
    v_mul_f32 v91, v108, v91
    s_waitcnt lgkmcnt(0)
    v_mul_f32 v92, v108, v92
    v_mul_f32 v93, v108, v93
    v_mul_f32 v94, v108, v94
    v_mul_f32 v95, v108, v95
    v_cvt_pk_bf16_f32 v85, v84, v85
    v_cvt_pk_bf16_f32 v87, v86, v87
    v_cvt_pk_bf16_f32 v89, v88, v89
    v_cvt_pk_bf16_f32 v91, v90, v91
    v_cvt_pk_bf16_f32 v93, v92, v93
    v_cvt_pk_bf16_f32 v95, v94, v95
    v_lshlrev_b32 v84, 16, v85
    v_and_b32 v85, 0xffff0000, v85
    v_lshlrev_b32 v86, 16, v87
    v_and_b32 v87, 0xffff0000, v87
    v_lshlrev_b32 v88, 16, v89
    v_and_b32 v89, 0xffff0000, v89
    v_lshlrev_b32 v90, 16, v91
    v_and_b32 v91, 0xffff0000, v91
    v_lshlrev_b32 v92, 16, v93
    v_and_b32 v93, 0xffff0000, v93
    v_lshlrev_b32 v94, 16, v95
    v_and_b32 v95, 0xffff0000, v95
    s_cmp_lg_u32 s88, 7
    s_cbranch_scc1 .Lwf14_done
    v_and_b32 v124, 15, v0
    v_add_u32 v124, s69, v124
    v_lshlrev_b32 v124, 3, v124
    s_mov_b32 s87, 0
.Lwf14_loop:
    s_mov_b32 s86, 0x3301000
    buffer_load_dwordx2 v[128:129], v124, s[92:95], s86 offen sc1
    s_waitcnt vmcnt(0)
    v_xor_b32 v128, s90, v128
    v_xor_b32 v129, s91, v129
    v_lshrrev_b32 v127, 4, v129
    v_or_b32 v126, v128, v127
    v_cmp_ne_u32 vcc, 0, v126
    s_nop 4
    s_cbranch_vccz .Lwf14_ok
    s_sleep 1
    s_add_u32 s87, s87, 1
    s_cmp_lt_u32 s87, 0x40000
    s_cbranch_scc1 .Lwf14_loop
.Lwf14_ok:
.Lwf14_done:
    s_barrier
    s_add_u32 s73, s72, 0x6000
    buffer_load_dwordx4 v[184:187], v171, s[92:95], s73 offen sc1
    s_add_u32 s73, s72, 0x486000
    buffer_load_dwordx4 v[196:199], v171, s[92:95], s73 offen sc1
    s_add_u32 s73, s72, 0x906000
    buffer_load_dwordx4 v[208:211], v171, s[92:95], s73 offen sc1
    s_add_u32 s73, s72, 0xd86000
    buffer_load_dwordx4 v[220:223], v171, s[92:95], s73 offen sc1
    s_waitcnt vmcnt(9)
    v_add_f32 v176, v176, v188
    s_waitcnt vmcnt(5)
    v_add_f32 v200, v200, v212
    v_add_f32 v177, v177, v189
    v_add_f32 v201, v201, v213
    v_add_f32 v178, v178, v190
    v_add_f32 v202, v202, v214
    v_add_f32 v179, v179, v191
    v_add_f32 v203, v203, v215
    v_add_f32 v176, v176, v200
    v_add_f32 v177, v177, v201
    v_add_f32 v178, v178, v202
    v_add_f32 v179, v179, v203
    v_add_f32 v180, v180, v192
    s_waitcnt vmcnt(4)
    v_add_f32 v204, v204, v216
    v_add_f32 v181, v181, v193
    v_add_f32 v205, v205, v217
    v_add_f32 v182, v182, v194
    v_add_f32 v206, v206, v218
    v_add_f32 v183, v183, v195
    v_add_f32 v207, v207, v219
    v_add_f32 v180, v180, v204
    v_add_f32 v181, v181, v205
    v_add_f32 v182, v182, v206
    v_add_f32 v183, v183, v207
    s_waitcnt vmcnt(2)
    v_add_f32 v184, v184, v196
    s_waitcnt vmcnt(0)
    v_add_f32 v208, v208, v220
    v_add_f32 v185, v185, v197
    v_add_f32 v209, v209, v221
    v_add_f32 v186, v186, v198
    v_add_f32 v210, v210, v222
    v_add_f32 v187, v187, v199
    v_add_f32 v211, v211, v223
    v_add_f32 v184, v184, v208
    v_add_f32 v185, v185, v209
    v_add_f32 v186, v186, v210
    v_add_f32 v187, v187, v211
    ds_write_b128 v172, v[176:179] offset:34176
    s_cmp_ge_u32 s88, 4
    s_cbranch_scc1 .Lk3_now1
    ds_write_b128 v173, v[180:183] offset:34176
.Lk3_now1:
    s_cmp_ge_u32 s88, 6
    s_cbranch_scc1 .Lk3_now2
    ds_write_b128 v174, v[184:187] offset:34176
.Lk3_now2:
    s_mul_i32 s68, s88, 2320
    v_add_u32 v4, s68, v6
    s_waitcnt lgkmcnt(0)
    s_barrier
    ds_read_b128 v[176:179], v4 offset:34176
    ds_read_b128 v[180:183], v4 offset:35200
    ds_read_b128 v[184:187], v4 offset:36224
    s_waitcnt lgkmcnt(2)
    v_cvt_pk_bf16_f32 v177, v176, v177
    v_cvt_pk_bf16_f32 v179, v178, v179
    s_waitcnt lgkmcnt(1)
    v_cvt_pk_bf16_f32 v181, v180, v181
    v_cvt_pk_bf16_f32 v183, v182, v183
    s_waitcnt lgkmcnt(0)
    v_cvt_pk_bf16_f32 v185, v184, v185
    v_cvt_pk_bf16_f32 v187, v186, v187
    v_lshlrev_b32 v176, 16, v177
    v_and_b32 v177, 0xffff0000, v177
    v_lshlrev_b32 v178, 16, v179
    v_and_b32 v179, 0xffff0000, v179
    v_lshlrev_b32 v180, 16, v181
    v_and_b32 v181, 0xffff0000, v181
    v_lshlrev_b32 v182, 16, v183
    v_and_b32 v183, 0xffff0000, v183
    v_lshlrev_b32 v184, 16, v185
    v_and_b32 v185, 0xffff0000, v185
    v_lshlrev_b32 v186, 16, v187
    v_and_b32 v187, 0xffff0000, v187
    v_add_f32 v176, v176, v8
    v_add_f32 v177, v177, v9
    v_add_f32 v178, v178, v10
    v_add_f32 v179, v179, v11
    v_add_f32 v180, v180, v12
    v_add_f32 v181, v181, v13
    v_add_f32 v182, v182, v14
    v_add_f32 v183, v183, v15
    v_add_f32 v184, v184, v16
    v_add_f32 v185, v185, v17
    v_add_f32 v186, v186, v18
    v_add_f32 v187, v187, v19
    v_cvt_pk_bf16_f32 v177, v176, v177
    v_cvt_pk_bf16_f32 v179, v178, v179
    v_cvt_pk_bf16_f32 v181, v180, v181
    v_cvt_pk_bf16_f32 v183, v182, v183
    v_cvt_pk_bf16_f32 v185, v184, v185
    v_cvt_pk_bf16_f32 v187, v186, v187
    v_lshlrev_b32 v176, 16, v177
    v_and_b32 v177, 0xffff0000, v177
    v_lshlrev_b32 v178, 16, v179
    v_and_b32 v179, 0xffff0000, v179
    v_lshlrev_b32 v180, 16, v181
    v_and_b32 v181, 0xffff0000, v181
    v_lshlrev_b32 v182, 16, v183
    v_and_b32 v183, 0xffff0000, v183
    v_lshlrev_b32 v184, 16, v185
    v_and_b32 v185, 0xffff0000, v185
    v_lshlrev_b32 v186, 16, v187
    v_and_b32 v187, 0xffff0000, v187
    v_mul_f32 v32, 0xbfb8aa3b, v176
    v_mul_f32 v33, 0xbfb8aa3b, v177
    v_mul_f32 v34, 0xbfb8aa3b, v178
    v_mul_f32 v35, 0xbfb8aa3b, v179
    v_mul_f32 v36, 0xbfb8aa3b, v180
    v_mul_f32 v37, 0xbfb8aa3b, v181
    v_mul_f32 v38, 0xbfb8aa3b, v182
    v_mul_f32 v39, 0xbfb8aa3b, v183
    v_mul_f32 v40, 0xbfb8aa3b, v184
    v_mul_f32 v41, 0xbfb8aa3b, v185
    v_mul_f32 v42, 0xbfb8aa3b, v186
    v_mul_f32 v43, 0xbfb8aa3b, v187
    v_exp_f32 v32, v32
    v_exp_f32 v33, v33
    v_exp_f32 v34, v34
    v_exp_f32 v35, v35
    v_exp_f32 v36, v36
    v_exp_f32 v37, v37
    v_exp_f32 v38, v38
    v_exp_f32 v39, v39
    v_exp_f32 v40, v40
    v_exp_f32 v41, v41
    v_exp_f32 v42, v42
    v_exp_f32 v43, v43
    v_add_f32 v32, 1.0, v32
    v_add_f32 v33, 1.0, v33
    v_add_f32 v34, 1.0, v34
    v_add_f32 v35, 1.0, v35
    v_add_f32 v36, 1.0, v36
    v_add_f32 v37, 1.0, v37
    v_add_f32 v38, 1.0, v38
    v_add_f32 v39, 1.0, v39
    v_add_f32 v40, 1.0, v40
    v_add_f32 v41, 1.0, v41
    v_add_f32 v42, 1.0, v42
    v_add_f32 v43, 1.0, v43
    v_rcp_f32 v32, v32
    v_rcp_f32 v33, v33
    v_rcp_f32 v34, v34
    v_rcp_f32 v35, v35
    v_rcp_f32 v36, v36
    v_rcp_f32 v37, v37
    v_rcp_f32 v38, v38
    v_rcp_f32 v39, v39
    v_rcp_f32 v40, v40
    v_rcp_f32 v41, v41
    v_rcp_f32 v42, v42
    v_rcp_f32 v43, v43
    v_mul_f32 v176, v176, v32
    v_mul_f32 v177, v177, v33
    v_mul_f32 v178, v178, v34
    v_mul_f32 v179, v179, v35
    v_mul_f32 v180, v180, v36
    v_mul_f32 v181, v181, v37
    v_mul_f32 v182, v182, v38
    v_mul_f32 v183, v183, v39
    v_mul_f32 v184, v184, v40
    v_mul_f32 v185, v185, v41
    v_mul_f32 v186, v186, v42
    v_mul_f32 v187, v187, v43
    v_cvt_pk_bf16_f32 v177, v176, v177
    v_cvt_pk_bf16_f32 v179, v178, v179
    v_cvt_pk_bf16_f32 v181, v180, v181
    v_cvt_pk_bf16_f32 v183, v182, v183
    v_cvt_pk_bf16_f32 v185, v184, v185
    v_cvt_pk_bf16_f32 v187, v186, v187
    v_lshlrev_b32 v176, 16, v177
    v_and_b32 v177, 0xffff0000, v177
    v_lshlrev_b32 v178, 16, v179
    v_and_b32 v179, 0xffff0000, v179
    v_lshlrev_b32 v180, 16, v181
    v_and_b32 v181, 0xffff0000, v181
    v_lshlrev_b32 v182, 16, v183
    v_and_b32 v183, 0xffff0000, v183
    v_lshlrev_b32 v184, 16, v185
    v_and_b32 v185, 0xffff0000, v185
    v_lshlrev_b32 v186, 16, v187
    v_and_b32 v187, 0xffff0000, v187
    v_mul_f32 v176, v176, v84
    v_mul_f32 v177, v177, v85
    v_mul_f32 v178, v178, v86
    v_mul_f32 v179, v179, v87
    v_mul_f32 v180, v180, v88
    v_mul_f32 v181, v181, v89
    v_mul_f32 v182, v182, v90
    v_mul_f32 v183, v183, v91
    v_mul_f32 v184, v184, v92
    v_mul_f32 v185, v185, v93
    v_mul_f32 v186, v186, v94
    v_mul_f32 v187, v187, v95
    v_cvt_pk_bf16_f32 v177, v176, v177
    v_cvt_pk_bf16_f32 v179, v178, v179
    v_cvt_pk_bf16_f32 v181, v180, v181
    v_cvt_pk_bf16_f32 v183, v182, v183
    v_cvt_pk_bf16_f32 v185, v184, v185
    v_cvt_pk_bf16_f32 v187, v186, v187
    v_lshlrev_b32 v176, 16, v177
    v_and_b32 v177, 0xffff0000, v177
    v_lshlrev_b32 v178, 16, v179
    v_and_b32 v179, 0xffff0000, v179
    v_lshlrev_b32 v180, 16, v181
    v_and_b32 v181, 0xffff0000, v181
    v_lshlrev_b32 v182, 16, v183
    v_and_b32 v183, 0xffff0000, v183
    v_lshlrev_b32 v184, 16, v185
    v_and_b32 v185, 0xffff0000, v185
    v_lshlrev_b32 v186, 16, v187
    v_and_b32 v187, 0xffff0000, v187
    v_add_f32 v176, v176, v20
    v_add_f32 v177, v177, v21
    v_add_f32 v178, v178, v22
    v_add_f32 v179, v179, v23
    v_add_f32 v180, v180, v24
    v_add_f32 v181, v181, v25
    v_add_f32 v182, v182, v26
    v_add_f32 v183, v183, v27
    v_add_f32 v184, v184, v28
    v_add_f32 v185, v185, v29
    v_add_f32 v186, v186, v30
    v_add_f32 v187, v187, v31
    v_cvt_pk_bf16_f32 v32, v176, v177
    v_cvt_pk_bf16_f32 v33, v178, v179
    v_cvt_pk_bf16_f32 v34, v180, v181
    v_cvt_pk_bf16_f32 v35, v182, v183
    v_cvt_pk_bf16_f32 v36, v184, v185
    v_cvt_pk_bf16_f32 v37, v186, v187
    buffer_store_dwordx2 v[32:33], v5, s[64:67], s70 offen offset:0
    buffer_store_dwordx2 v[34:35], v5, s[64:67], s70 offen offset:512
    buffer_store_dwordx2 v[36:37], v7, s[64:67], s70 offen offset:1024
.Lmega_end:
    s_endpgm
.p2align 8
.type const_tab,@object
const_tab:
.long 0x3c003c00,0x3c003c00,0x3c003c00,0x3c003c00,0x3be13c00,0x3aee3b84,0x39243a21,0x35793800
.long 0x3b843c00,0x38003a21,0xb18f318f,0xba21b800,0x3aee3c00,0x3800,0xbaeeb800,0xbaeebc00
.long 0x3a213c00,0xb800318f,0xbb84bb84,0x318fb800,0x39243c00,0xbaeeb18f,0xb579bb84,0x3be13800
.long 0x38003c00,0xbc00b800,0x3800b800,0x38003c00,0x35793c00,0xbaeeba21,0x3be1318f,0xb9243800
.long 0x318f3c00,0xb800bb84,0x3a213a21,0xbb84b800,0x3c00,0x8000bc00,0x3c00,0x8000bc00
.long 0xb18f3c00,0x3800bb84,0xba213a21,0x3b84b800,0xb5793c00,0x3aeeba21,0xbbe1318f,0x39243800
.long 0xb8003c00,0x3c00b800,0xb800b800,0xb8003c00,0xb9243c00,0x3aeeb18f,0x3579bb84,0xbbe13800
.long 0xba213c00,0x3800318f,0x3b84bb84,0xb18fb800,0xbaee3c00,0x3800,0x3aeeb800,0x3aeebc00
.long 0x3c003c00,0x3c003c00,0x3c003c00,0x3c003c00,0x318f,0xb579b18f,0xb924b800,0xbaeeba21
.long 0xbc00bb84,0xba21bb84,0xb18fb800,0x3800318f,0x8000b800,0x3aee3800,0x3aee3c00,0x3800
.long 0x3c003a21,0x318f3a21,0xbb84b800,0xb800bb84,0x3a21,0xbbe1ba21,0x3579b800,0x3aee3b84
.long 0xbc00b800,0x3800b800,0x38003c00,0xbc00b800,0x8000bb84,0x39243b84,0xbbe1b800,0x3aeeb18f
.long 0x3c00318f,0xbb84318f,0x3a21b800,0xb8003a21,0x3c00,0x8000bc00,0x3c00,0x8000bc00
.long 0xbc00318f,0x3b84318f,0xba21b800,0x38003a21,0x8000bb84,0xb9243b84,0x3be1b800,0xbaeeb18f
.long 0x3c00b800,0xb800b800,0xb8003c00,0x3c00b800,0x3a21,0x3be1ba21,0xb579b800,0xbaee3b84
.long 0xbc003a21,0xb18f3a21,0x3b84b800,0x3800bb84,0x8000b800,0xbaee3800,0xbaee3c00,0x3800
.long 0x3c003c00,0x3c003c00,0x3c003c00,0x3c003c00,0xbbe1bb84,0xbbe1bc00,0xbaeebb84,0xb924ba21
.long 0x3b843a21,0x3b843c00,0x38003a21,0xb18f318f,0xbaeeb800,0xbaeebc00,0x8000b800,0x3aee3800
.long 0x3a21318f,0x3a213c00,0xb800318f,0xbb84bb84,0xb924318f,0xb924bc00,0x3aee318f,0x35793b84
.long 0x3800b800,0x38003c00,0xbc00b800,0x3800b800,0xb5793a21,0xb579bc00,0x3aee3a21,0xbbe1b18f
.long 0x318fbb84,0x318f3c00,0xb800bb84,0x3a213a21,0x3c00,0x8000bc00,0x3c00,0x8000bc00
.long 0xb18fbb84,0xb18f3c00,0x3800bb84,0xba213a21,0x35793a21,0x3579bc00,0xbaee3a21,0x3be1b18f
.long 0xb800b800,0xb8003c00,0x3c00b800,0xb800b800,0x3924318f,0x3924bc00,0xbaee318f,0xb5793b84
.long 0xba21318f,0xba213c00,0x3800318f,0x3b84bb84,0x3aeeb800,0x3aeebc00,0x8000b800,0xbaee3800
.long 0x3c003c00,0x3c003c00,0x3c003c00,0x3c003c00,0xb579b800,0x8000b18f,0x3579318f,0x39243800
.long 0xba21b800,0xbc00bb84,0xba21bb84,0xb18fb800,0x3aee3c00,0x3800,0xbaeeb800,0xbaeebc00
.long 0x318fb800,0x3c003a21,0x318f3a21,0xbb84b800,0xbbe1b800,0x8000ba21,0x3be13a21,0xb5793800
.long 0x38003c00,0xbc00b800,0x3800b800,0x38003c00,0x3924b800,0x3b84,0xb924bb84,0x3be13800
.long 0xbb84b800,0x3c00318f,0xbb84318f,0x3a21b800,0x3c00,0x8000bc00,0x3c00,0x8000bc00
.long 0x3b84b800,0xbc00318f,0x3b84318f,0xba21b800,0xb924b800,0x3b84,0x3924bb84,0xbbe13800
.long 0xb8003c00,0x3c00b800,0xb800b800,0xb8003c00,0x3be1b800,0x8000ba21,0xbbe13a21,0x35793800
.long 0xb18fb800,0xbc003a21,0xb18f3a21,0x3b84b800,0xbaee3c00,0x3800,0x3aeeb800,0x3aeebc00
.long 0x80008000,0x80008000,0x80008000,0x80008000,0xb18f8000,0xb800b579,0xba21b924,0xbb84baee
.long 0xb5798000,0xbaeeb924,0xbbe1bbe1,0xb924baee,0xb8008000,0xbc00baee,0xb800baee,0x38008000
.long 0xb9248000,0xbaeebbe1,0x3579b579,0x3be13aee,0xba218000,0xb800bbe1,0x3b843579,0x318f3aee
.long 0xbaee8000,0x8000baee,0x3aee3aee,0xbaee8000,0xbb848000,0x3800b924,0x318f3be1,0xba21baee
.long 0xbbe18000,0x3aeeb579,0xb9243924,0x3579baee,0xbc008000,0x3c008000,0xbc008000,0x3c008000
.long 0xbbe18000,0x3aee3579,0xb924b924,0x35793aee,0xbb848000,0x38003924,0x318fbbe1,0xba213aee
.long 0xbaee8000,0x80003aee,0x3aeebaee,0xbaee8000,0xba218000,0xb8003be1,0x3b84b579,0x318fbaee
.long 0xb9248000,0xbaee3be1,0x35793579,0x3be1baee,0xb8008000,0xbc003aee,0xb8003aee,0x38008000
.long 0x80008000,0x80008000,0x80008000,0x80008000,0xbc00bbe1,0xbb84bbe1,0xba21baee,0xb800b924
.long 0x8000b579,0x39243579,0x3be13aee,0x3aee3be1,0x3c003aee,0x38003aee,0xb8008000,0xbc00baee
.long 0x80003924,0xbbe1b924,0xb579baee,0x3aee3579,0xbc00b924,0x318fb924,0x3b843aee,0xb8003579
.long 0x8000baee,0x3aee3aee,0xbaee8000,0x8000baee,0x3c003579,0xba213579,0x318fbaee,0x38003be1
.long 0x80003be1,0xb579bbe1,0x39243aee,0xbaeeb924,0xbc008000,0x3c008000,0xbc008000,0x3c008000
.long 0x8000bbe1,0xb5793be1,0x3924baee,0xbaee3924,0x3c00b579,0xba21b579,0x318f3aee,0x3800bbe1
.long 0x80003aee,0x3aeebaee,0xbaee8000,0x80003aee,0xbc003924,0x318f3924,0x3b84baee,0xb800b579
.long 0x8000b924,0xbbe13924,0xb5793aee,0x3aeeb579,0x3c00baee,0x3800baee,0xb8008000,0xbc003aee
.long 0x80008000,0x80008000,0x80008000,0x80008000,0xb18fb579,0x318f8000,0x38003579,0x3a213924
.long 0x35793924,0xb5798000,0xbaeeb924,0xbbe1bbe1,0xb800baee,0x38008000,0x3c003aee,0x38003aee
.long 0x39243be1,0xb9248000,0xbaeebbe1,0x3579b579,0xba21bbe1,0x3a218000,0x38003be1,0xbb84b579
.long 0x3aee3aee,0xbaee8000,0x8000baee,0x3aee3aee,0xbb84b924,0x3b848000,0xb8003924,0xb18fbbe1
.long 0x3be13579,0xbbe18000,0x3aeeb579,0xb9243924,0xbc008000,0x3c008000,0xbc008000,0x3c008000
.long 0x3be1b579,0xbbe18000,0x3aee3579,0xb924b924,0xbb843924,0x3b848000,0xb800b924,0xb18f3be1
.long 0x3aeebaee,0xbaee8000,0x80003aee,0x3aeebaee,0xba213be1,0x3a218000,0x3800bbe1,0xbb843579
.long 0x3924bbe1,0xb9248000,0xbaee3be1,0x35793579,0xb8003aee,0x38008000,0x3c00baee,0x3800baee
.long 0x80008000,0x80008000,0x80008000,0x80008000,0x3b843aee,0x3c003be1,0x3b843be1,0x3a213aee
.long 0xb924baee,0x8000b579,0x39243579,0x3be13aee,0xb8008000,0xbc00baee,0xb800baee,0x38008000
.long 0x3be13aee,0x80003924,0xbbe1b924,0xb579baee,0xb18fbaee,0x3c003924,0xb18f3924,0xbb84baee
.long 0xbaee8000,0x8000baee,0x3aee3aee,0xbaee8000,0x3a213aee,0xbc00b579,0x3a21b579,0xb18f3aee
.long 0x3579baee,0x80003be1,0xb579bbe1,0x39243aee,0xbc008000,0x3c008000,0xbc008000,0x3c008000
.long 0x35793aee,0x8000bbe1,0xb5793be1,0x3924baee,0x3a21baee,0xbc003579,0x3a213579,0xb18fbaee
.long 0xbaee8000,0x80003aee,0x3aeebaee,0xbaee8000,0xb18f3aee,0x3c00b924,0xb18fb924,0xbb843aee
.long 0x3be1baee,0x8000b924,0xbbe13924,0xb5793aee,0xb8008000,0xbc003aee,0xb8003aee,0x38008000
.long 0xbb843c00,0xb8003a21,0x318f318f,0x3a21b800,0xbbe13c00,0xbaee3b84,0xb9243a21,0xb5793800
.long 0xbc003c00,0xbc003c00,0xbc003c00,0xbc003c00,0x0,0x0,0x0,0x0
.long 0x0,0x0,0x0,0x0,0x0,0x0,0x0,0x0
.long 0x0,0x0,0x0,0x0,0x0,0x0,0x0,0x0
.long 0x0,0x0,0x0,0x0,0x0,0x0,0x0,0x0
.long 0x0,0x0,0x0,0x0,0x0,0x0,0x0,0x0
.long 0x0,0x0,0x0,0x0,0x0,0x0,0x0,0x0
.long 0x0,0x0,0x0,0x0,0x0,0x0,0x0,0x0
.long 0x3c00bb84,0x3a21bb84,0x318fb800,0xb800318f,0x318f,0x3579b18f,0x3924b800,0x3aeeba21
.long 0xbc003c00,0xbc003c00,0xbc003c00,0xbc003c00,0x0,0x0,0x0,0x0
.long 0x0,0x0,0x0,0x0,0x0,0x0,0x0,0x0
.long 0x0,0x0,0x0,0x0,0x0,0x0,0x0,0x0
.long 0x0,0x0,0x0,0x0,0x0,0x0,0x0,0x0
.long 0x0,0x0,0x0,0x0,0x0,0x0,0x0,0x0
.long 0x0,0x0,0x0,0x0,0x0,0x0,0x0,0x0
.long 0x0,0x0,0x0,0x0,0x0,0x0,0x0,0x0
.long 0xbb843a21,0xbb843c00,0xb8003a21,0x318f318f,0x3be1bb84,0x3be1bc00,0x3aeebb84,0x3924ba21
.long 0xbc003c00,0xbc003c00,0xbc003c00,0xbc003c00,0x0,0x0,0x0,0x0
.long 0x0,0x0,0x0,0x0,0x0,0x0,0x0,0x0
.long 0x0,0x0,0x0,0x0,0x0,0x0,0x0,0x0
.long 0x0,0x0,0x0,0x0,0x0,0x0,0x0,0x0
.long 0x0,0x0,0x0,0x0,0x0,0x0,0x0,0x0
.long 0x0,0x0,0x0,0x0,0x0,0x0,0x0,0x0
.long 0x0,0x0,0x0,0x0,0x0,0x0,0x0,0x0
.long 0x3a21b800,0x3c00bb84,0x3a21bb84,0x318fb800,0x3579b800,0x8000b18f,0xb579318f,0xb9243800
.long 0xbc003c00,0xbc003c00,0xbc003c00,0xbc003c00,0x0,0x0,0x0,0x0
.long 0x0,0x0,0x0,0x0,0x0,0x0,0x0,0x0
.long 0x0,0x0,0x0,0x0,0x0,0x0,0x0,0x0
.long 0x0,0x0,0x0,0x0,0x0,0x0,0x0,0x0
.long 0x0,0x0,0x0,0x0,0x0,0x0,0x0,0x0
.long 0x0,0x0,0x0,0x0,0x0,0x0,0x0,0x0
.long 0x0,0x0,0x0,0x0,0x0,0x0,0x0,0x0
.long 0xb5798000,0xbaee3924,0xbbe13be1,0xb9243aee,0xb18f8000,0xb8003579,0xba213924,0xbb843aee
.long 0x80008000,0x80008000,0x80008000,0x80008000,0x0,0x0,0x0,0x0
.long 0x0,0x0,0x0,0x0,0x0,0x0,0x0,0x0
.long 0x0,0x0,0x0,0x0,0x0,0x0,0x0,0x0
.long 0x0,0x0,0x0,0x0,0x0,0x0,0x0,0x0
.long 0x0,0x0,0x0,0x0,0x0,0x0,0x0,0x0
.long 0x0,0x0,0x0,0x0,0x0,0x0,0x0,0x0
.long 0x0,0x0,0x0,0x0,0x0,0x0,0x0,0x0
.long 0x80003579,0x3924b579,0x3be1baee,0x3aeebbe1,0xbc003be1,0xbb843be1,0xba213aee,0xb8003924
.long 0x80008000,0x80008000,0x80008000,0x80008000,0x0,0x0,0x0,0x0
.long 0x0,0x0,0x0,0x0,0x0,0x0,0x0,0x0
.long 0x0,0x0,0x0,0x0,0x0,0x0,0x0,0x0
.long 0x0,0x0,0x0,0x0,0x0,0x0,0x0,0x0
.long 0x0,0x0,0x0,0x0,0x0,0x0,0x0,0x0
.long 0x0,0x0,0x0,0x0,0x0,0x0,0x0,0x0
.long 0x0,0x0,0x0,0x0,0x0,0x0,0x0,0x0
.long 0x3579b924,0xb5798000,0xbaee3924,0xbbe13be1,0xb18f3579,0x318f8000,0x3800b579,0x3a21b924
.long 0x80008000,0x80008000,0x80008000,0x80008000,0x0,0x0,0x0,0x0
.long 0x0,0x0,0x0,0x0,0x0,0x0,0x0,0x0
.long 0x0,0x0,0x0,0x0,0x0,0x0,0x0,0x0
.long 0x0,0x0,0x0,0x0,0x0,0x0,0x0,0x0
.long 0x0,0x0,0x0,0x0,0x0,0x0,0x0,0x0
.long 0x0,0x0,0x0,0x0,0x0,0x0,0x0,0x0
.long 0x0,0x0,0x0,0x0,0x0,0x0,0x0,0x0
.long 0xb9243aee,0x80003579,0x3924b579,0x3be1baee,0x3b84baee,0x3c00bbe1,0x3b84bbe1,0x3a21baee
.long 0x80008000,0x80008000,0x80008000,0x80008000,0x0,0x0,0x0,0x0
.long 0x0,0x0,0x0,0x0,0x0,0x0,0x0,0x0
.long 0x0,0x0,0x0,0x0,0x0,0x0,0x0,0x0
.long 0x0,0x0,0x0,0x0,0x0,0x0,0x0,0x0
.long 0x0,0x0,0x0,0x0,0x0,0x0,0x0,0x0
.long 0x0,0x0,0x0,0x0,0x0,0x0,0x0,0x0
.long 0x0,0x0,0x0,0x0,0x0,0x0,0x0,0x0
.long 0x3c00,0x8000,0x318f,0xbbe1,0x3a21,0x3924,0x3a21,0xb924
.long 0x318f,0x3be1,0x3c00,0x8000,0xb800,0x3aee,0x0,0x0
.long 0xbb84,0x3579,0x0,0x0,0xbb84,0xb579,0x0,0x0
.long 0xb800,0xbaee,0x0,0x0,0x318f,0xbbe1,0x0,0x0
.long 0x3a21,0xb924,0x0,0x0,0x3c00,0x8000,0x0,0x0
.long 0x3a21,0x3924,0x0,0x0,0x318f,0x3be1,0x0,0x0
.long 0xb800,0x3aee,0x0,0x0,0xbb84,0x3579,0x0,0x0
.long 0xbb84,0xb579,0x0,0x0,0xb800,0xbaee,0x0,0x0
.long 0x3c00,0x8000,0xb800,0x3aee,0x3aee,0x3800,0xbaee,0x3800
.long 0x3800,0x3aee,0xbc00,0x8000,0x8000,0x3c00,0x0,0x0
.long 0xb800,0x3aee,0x0,0x0,0xbaee,0x3800,0x0,0x0
.long 0xbc00,0x8000,0x0,0x0,0xbaee,0xb800,0x0,0x0
.long 0xb800,0xbaee,0x0,0x0,0x0,0xbc00,0x0,0x0
.long 0x3800,0xbaee,0x0,0x0,0x3aee,0xb800,0x0,0x0
.long 0x3c00,0x8000,0x0,0x0,0x3aee,0x3800,0x0,0x0
.long 0x3800,0x3aee,0x0,0x0,0x8000,0x3c00,0x0,0x0
.long 0x3c00,0x8000,0x3a21,0xb924,0x3b84,0x3579,0x3b84,0xb579
.long 0x3a21,0x3924,0x3c00,0x8000,0x3800,0x3aee,0x0,0x0
.long 0x318f,0x3be1,0x0,0x0,0xb18f,0x3be1,0x0,0x0
.long 0xb800,0x3aee,0x0,0x0,0xba21,0x3924,0x0,0x0
.long 0xbb84,0x3579,0x0,0x0,0xbc00,0x8000,0x0,0x0
.long 0xbb84,0xb579,0x0,0x0,0xba21,0xb924,0x0,0x0
.long 0xb800,0xbaee,0x0,0x0,0xb18f,0xbbe1,0x0,0x0
.long 0x318f,0xbbe1,0x0,0x0,0x3800,0xbaee,0x0,0x0
.long 0x3c00,0x8000,0xbb84,0x3579,0x3be1,0x318f,0xbbe1,0x318f
.long 0x3b84,0x3579,0xbc00,0x8000,0x3aee,0x3800,0x0,0x0
.long 0x3a21,0x3924,0x0,0x0,0x3924,0x3a21,0x0,0x0
.long 0x3800,0x3aee,0x0,0x0,0x3579,0x3b84,0x0,0x0
.long 0x318f,0x3be1,0x0,0x0,0x8000,0x3c00,0x0,0x0
.long 0xb18f,0x3be1,0x0,0x0,0xb579,0x3b84,0x0,0x0
.long 0xb800,0x3aee,0x0,0x0,0xb924,0x3a21,0x0,0x0
.long 0xba21,0x3924,0x0,0x0,0xbaee,0x3800,0x0,0x0
.long 0x3e2aaaab,0x3e2aaaab,0x3e2aaaab,0x3e2aaaab,0x3e2aaaab,0x3e2aa811,0x3e2aa045,0x3e2a9346
.long 0x3e2aaaab,0x3e2aa045,0x3e2a8115,0x3e2a4d1f,0x3e2aaaab,0x3e2a9346,0x3e2a4d1f,0x3e29d849
.long 0x3e2aaaab,0x3e2a8115,0x3e2a0469,0x3e2934e3,0x3e2aaaab,0x3e2a69b3,0x3e29a6fc,0x3e28631b
.long 0x3e2aaaab,0x3e2a4d1f,0x3e2934e3,0x3e27632a,0x3e2aaaab,0x3e2a2b5c,0x3e28ae2c,0x3e263556
.long 0x3e2aaaab,0x3e2a0469,0x3e2812e8,0x3e24d9f1,0x3e2aaaab,0x3e29d849,0x3e27632a,0x3e23515c
.long 0x3e2aaaab,0x3e29a6fc,0x3e269f06,0x3e219c02,0x3e2aaaab,0x3e297084,0x3e25c695,0x3e1fba5b
.long 0x3e2aaaab,0x3e2934e3,0x3e24d9f1,0x3e1dacea,0x3e2aaaab,0x3e28f41a,0x3e23d938,0x3e1b743f
.long 0x3e2aaaab,0x3e28ae2c,0x3e22c488,0x3e1910f8,0x3e2aaaab,0x3e28631b,0x3e219c02,0x3e1683ba
.long 0x3e2aaaab,0x3e2aaaab,0x3e2aaaab,0x3e2aaaab,0x3e2a8115,0x3e2a69b3,0x3e2a4d1f,0x3e2a2b5c
.long 0x3e2a0469,0x3e29a6fc,0x3e2934e3,0x3e28ae2c,0x3e2934e3,0x3e28631b,0x3e27632a,0x3e263556
.long 0x3e2812e8,0x3e269f06,0x3e24d9f1,0x3e22c488,0x3e269f06,0x3e245c16,0x3e219c02,0x3e1e60e4
.long 0x3e24d9f1,0x3e219c02,0x3e1dacea,0x3e1910f8,0x3e22c488,0x3e1e60e4,0x3e1910f8,0x3e12dcaf
.long 0x3e205fcc,0x3e1aad31,0x3e13cd3a,0x3e0bcd4d,0x3e1dacea,0x3e1683ba,0x3e0de776,0x3e03ed58
.long 0x3e1aad31,0x3e11e7ab,0x3e076623,0x3df69120,0x3e176218,0x3e0cdc87,0x3e005062,0x3de3d7b7
.long 0x3e13cd3a,0x3e076623,0x3df15bef,0x3dcfca63,0x3e0ff056,0x3e0188a9,0x3de10e84,0x3dba870e
.long 0x3e0bcd4d,0x3df69120,0x3dcfca63,0x3da42d71,0x3e076623,0x3de95535,0x3dbda278,0x3d8cdee4
.long 0x3e2aaaab,0x3e2aaaab,0x3e2aaaab,0x3e2aaaab,0x3e2a0469,0x3e29d849,0x3e29a6fc,0x3e297084
.long 0x3e2812e8,0x3e27632a,0x3e269f06,0x3e25c695,0x3e24d9f1,0x3e23515c,0x3e219c02,0x3e1fba5b
.long 0x3e205fcc,0x3e1dacea,0x3e1aad31,0x3e176218,0x3e1aad31,0x3e1683ba,0x3e11e7ab,0x3e0cdc87
.long 0x3e13cd3a,0x3e0de776,0x3e076623,0x3e005062,0x3e0bcd4d,0x3e03ed58,0x3df69120,0x3de3d7b7
.long 0x3e02bcfe,0x3df15bef,0x3ddb67a3,0x3dc3c7e0,0x3df15bef,0x3dd88a22,0x3dbda278,0x3da0e747
.long 0x3ddb67a3,0x3dbda278,0x3d9d9c36,0x3d776ca3,0x3dc3c7e0,0x3da0e747,0x3d776ca3,0x3d297bd8
.long 0x3daaaaab,0x3d829f63,0x3d30afe8,0x3cb23636,0x3d9040f2,0x3d462aed,0x3ccfb2fa,0x3aee4a78
.long 0x3d697c5a,0x3d052e81,0x3bee3853,0xbc94a3bb,0x3d30afe8,0x3c85d379,0xbc32981a,0xbd1b0474
.long 0x3e2aaaab,0x3e2aaaab,0x3e2aaaab,0x3e2aaaab,0x3e2934e3,0x3e28f41a,0x3e28ae2c,0x3e28631b
.long 0x3e24d9f1,0x3e23d938,0x3e22c488,0x3e219c02,0x3e1dacea,0x3e1b743f,0x3e1910f8,0x3e1683ba
.long 0x3e13cd3a,0x3e0ff056,0x3e0bcd4d,0x3e076623,0x3e076623,0x3e0188a9,0x3df69120,0x3de95535
.long 0x3df15bef,0x3de10e84,0x3dcfca63,0x3dbda278,0x3dcfca63,0x3dba870e,0x3da42d71,0x3d8cdee4
.long 0x3daaaaab,0x3d9040f2,0x3d697c5a,0x3d30afe8,0x3d829f63,0x3d462aed,0x3d052e81,0x3c85d379
.long 0x3d30afe8,0x3ccfb2fa,0x3bee3853,0xbc32981a,0x3cb23636,0x3aee4a78,0xbc94a3bb,0xbd1b0474
.long 0x233c4197,0xbcb23636,0xbd30afe8,0xbd829f63,0xbcb23636,0xbd37de96,0xbd89788b,0xbdb43f46
.long 0xbd30afe8,0xbd89788b,0xbdb765f5,0xbde10e84,0xbd829f63,0xbdb43f46,0xbde10e84,0xbe03ed58
.long 0x80000000,0x80000000,0x80000000,0x80000000,0x80000000,0xbaee4a78,0xbb6e46d7,0xbbb2b098
.long 0x80000000,0xbb6e46d7,0xbbee3853,0xbc32981a,0x80000000,0xbbb2b098,0xbc32981a,0xbc85d379
.long 0x80000000,0xbbee3853,0xbc6dfe48,0xbcb23636,0x80000000,0xbc14dc66,0xbc94a3bb,0xbcde6818
.long 0x80000000,0xbc32981a,0xbcb23636,0xbd052e81,0x80000000,0xbc504e5d,0xbccfb2fa,0xbd1b0474
.long 0x80000000,0xbc6dfe48,0xbced1670,0xbd30afe8,0x80000000,0xbc85d379,0xbd052e81,0xbd462aed
.long 0x80000000,0xbc94a3bb,0xbd13c190,0xbd5b6f9e,0x80000000,0xbca36f76,0xbd22429f,0xbd707828
.long 0x80000000,0xbcb23636,0xbd30afe8,0xbd829f63,0x80000000,0xbcc0f788,0xbd3f07aa,0xbd8cdee4
.long 0x80000000,0xbccfb2fa,0xbd4d4826,0xbd96f7c7,0x80000000,0xbcde6818,0xbd5b6f9e,0xbda0e747
.long 0x80000000,0x80000000,0x80000000,0x80000000,0xbbee3853,0xbc14dc66,0xbc32981a,0xbc504e5d
.long 0xbc6dfe48,0xbc94a3bb,0xbcb23636,0xbccfb2fa,0xbcb23636,0xbcde6818,0xbd052e81,0xbd1b0474
.long 0xbced1670,0xbd13c190,0xbd30afe8,0xbd4d4826,0xbd13c190,0xbd37de96,0xbd5b6f9e,0xbd7e5995
.long 0xbd30afe8,0xbd5b6f9e,0xbd829f63,0xbd96f7c7,0xbd4d4826,0xbd7e5995,0xbd96f7c7,0xbdade188
.long 0xbd697c5a,0xbd9040f2,0xbdaaaaab,0xbdc3c7e0,0xbd829f63,0xbda0e747,0xbdbda278,0xbdd88a22
.long 0xbd9040f2,0xbdb11319,0xbdcfca63,0xbdec0955,0xbd9d9c36,0xbdc0b81b,0xbde10e84,0xbdfe2864
.long 0xbdaaaaab,0xbdcfca63,0xbdf15bef,0xbe076623,0xbdb765f5,0xbdde3e76,0xbe005062,0xbe0eee13
.long 0xbdc3c7e0,0xbdec0955,0xbe076623,0xbe15a0c7,0xbdcfca63,0xbdf9207f,0xbe0de776,0xbe1b743f
.long 0x80000000,0x80000000,0x80000000,0x80000000,0xbc6dfe48,0xbc85d379,0xbc94a3bb,0xbca36f76
.long 0xbced1670,0xbd052e81,0xbd13c190,0xbd22429f,0xbd30afe8,0xbd462aed,0xbd5b6f9e,0xbd707828
.long 0xbd697c5a,0xbd829f63,0xbd9040f2,0xbd9d9c36,0xbd9040f2,0xbda0e747,0xbdb11319,0xbdc0b81b
.long 0xbdaaaaab,0xbdbda278,0xbdcfca63,0xbde10e84,0xbdc3c7e0,0xbdd88a22,0xbdec0955,0xbdfe2864
.long 0xbddb67a3,0xbdf15bef,0xbe02bcfe,0xbe0bcd4d,0xbdf15bef,0xbe03ed58,0xbe0de776,0xbe1683ba
.long 0xbe02bcfe,0xbe0de776,0xbe176218,0xbe1f100c,0xbe0bcd4d,0xbe1683ba,0xbe1f100c,0xbe2552c8
.long 0xbe13cd3a,0xbe1dacea,0xbe24d9f1,0xbe2934e3,0xbe1aad31,0xbe23515c,0xbe28ae2c,0xbe2aa811
.long 0xbe205fcc,0xbe27632a,0xbe2a8115,0xbe29a6fc,0xbe24d9f1,0xbe29d849,0xbe2a4d1f,0xbe263556
.long 0x80000000,0x80000000,0x80000000,0x80000000,0xbcb23636,0xbcc0f788,0xbccfb2fa,0xbcde6818
.long 0xbd30afe8,0xbd3f07aa,0xbd4d4826,0xbd5b6f9e,0xbd829f63,0xbd8cdee4,0xbd96f7c7,0xbda0e747
.long 0xbdaaaaab,0xbdb765f5,0xbdc3c7e0,0xbdcfca63,0xbdcfca63,0xbdde3e76,0xbdec0955,0xbdf9207f
.long 0xbdf15bef,0xbe005062,0xbe076623,0xbe0de776,0xbe076623,0xbe0eee13,0xbe15a0c7,0xbe1b743f
.long 0xbe13cd3a,0xbe1aad31,0xbe205fcc,0xbe24d9f1,0xbe1dacea,0xbe23515c,0xbe27632a,0xbe29d849
.long 0xbe24d9f1,0xbe28ae2c,0xbe2a8115,0xbe2a4d1f,0xbe2934e3,0xbe2aa811,0xbe29a6fc,0xbe263556
.long 0xbe2aaaab,0xbe2934e3,0xbe24d9f1,0xbe1dacea,0xbe2934e3,0xbe245c16,0xbe1c3692,0xbe10ee36
.long 0xbe24d9f1,0xbe1c3692,0xbe0ff056,0xbe005062,0xbe1dacea,0xbe10ee36,0xbe005062,0xbdd88a22
.long 0x3e2aaaab,0x3e2812e8,0x3e205fcc,0x3e13cd3a,0x3e2aaaab,0x3e27bd97,0x3e1f100c,0x3e10ee36
.long 0x3e2aaaab,0x3e27632a,0x3e1dacea,0x3e0de776,0x3e2aaaab,0x3e2703a3,0x3e1c3692,0x3e0ab9d0
.long 0x3e2aaaab,0x3e269f06,0x3e1aad31,0x3e076623,0x3e2aaaab,0x3e263556,0x3e1910f8,0x3e03ed58
.long 0x3e2aaaab,0x3e25c695,0x3e176218,0x3e005062,0x3e2aaaab,0x3e2552c8,0x3e15a0c7,0x3df9207f
.long 0x3e2aaaab,0x3e24d9f1,0x3e13cd3a,0x3df15bef,0x3e2aaaab,0x3e245c16,0x3e11e7ab,0x3de95535
.long 0x3e2aaaab,0x3e23d938,0x3e0ff056,0x3de10e84,0x3e2aaaab,0x3e23515c,0x3e0de776,0x3dd88a22
.long 0x3e2aaaab,0x3e22c488,0x3e0bcd4d,0x3dcfca63,0x3e2aaaab,0x3e2232bd,0x3e09a21a,0x3dc6d1ae
.long 0x3e2aaaab,0x3e219c02,0x3e076623,0x3dbda278,0x3e2aaaab,0x3e21005b,0x3e0519ac,0x3db43f46
.long 0x3e02bcfe,0x3ddb67a3,0x3daaaaab,0x3d697c5a,0x3dfba847,0x3dccd306,0x3d96f7c7,0x3d37de96
.long 0x3df15bef,0x3dbda278,0x3d829f63,0x3d052e81,0x3de699f9,0x3dade188,0x3d5b6f9e,0x3ca36f76
.long 0x3ddb67a3,0x3d9d9c36,0x3d30afe8,0x3bee3853,0x3dcfca63,0x3d8cdee4,0x3d052e81,0xbbb2b098
.long 0x3dc3c7e0,0x3d776ca3,0x3cb23636,0xbc94a3bb,0x3db765f5,0x3d545f1e,0x3c32981a,0xbcfbbd8f
.long 0x3daaaaab,0x3d30afe8,0x233c4197,0xbd30afe8,0x3d9d9c36,0x3d0c7a2d,0xbc32981a,0xbd62796f
.long 0x3d9040f2,0x3ccfb2fa,0xbcb23636,0xbd89788b,0x3d829f63,0x3c85d379,0xbd052e81,0xbda0e747
.long 0x3d697c5a,0x3bee3853,0xbd30afe8,0xbdb765f5,0x3d4d4826,0xbaee4a78,0xbd5b6f9e,0xbdccd306
.long 0x3d30afe8,0xbc32981a,0xbd829f63,0xbde10e84,0x3d13c190,0xbca36f76,0xbd96f7c7,0xbdf3fa3f
.long 0x3ced1670,0x233c4197,0xbced1670,0xbd697c5a,0x3c6dfe48,0xbc85d379,0xbd3f07aa,0xbd9a4c58
.long 0x233c4197,0xbd052e81,0xbd829f63,0xbdbda278,0xbc6dfe48,0xbd462aed,0xbda42d71,0xbdde3e76
.long 0xbced1670,0xbd829f63,0xbdc3c7e0,0xbdfba847,0xbd30afe8,0xbda0e747,0xbde10e84,0xbe0ab9d0
.long 0xbd697c5a,0xbdbda278,0xbdfba847,0xbe15a0c7,0xbd9040f2,0xbdd88a22,0xbe09a21a,0xbe1e60e4
.long 0xbdaaaaab,0xbdf15bef,0xbe13cd3a,0xbe24d9f1,0xbdc3c7e0,0xbe03ed58,0xbe1c3692,0xbe28f41a
.long 0xbddb67a3,0xbe0de776,0xbe22c488,0xbe2aa045,0xbdf15bef,0xbe1683ba,0xbe27632a,0xbe29d849
.long 0xbe02bcfe,0xbe1dacea,0xbe2a0469,0xbe269f06,0xbe0bcd4d,0xbe23515c,0xbe2aa045,0xbe21005b
.long 0xbe13cd3a,0xbe27632a,0xbe2934e3,0xbe1910f8,0xbe1aad31,0xbe29d849,0xbe25c695,0xbe0eee13
.long 0xbdaaaaab,0xbddb67a3,0xbe02bcfe,0xbe13cd3a,0xbdcfca63,0xbdfe2864,0xbe11e7ab,0xbe1fba5b
.long 0xbdf15bef,0xbe0de776,0xbe1dacea,0xbe27632a,0xbe076623,0xbe19e16c,0xbe25c695,0xbe2a9346
.long 0xbe13cd3a,0xbe22c488,0xbe2a0469,0xbe2934e3,0xbe1dacea,0xbe28631b,0xbe2a4d1f,0xbe23515c
.long 0xbe24d9f1,0xbe2aa045,0xbe269f06,0xbe1910f8,0xbe2934e3,0xbe297084,0xbe1f100c,0xbe0ab9d0
.long 0xbe2aaaab,0xbe24d9f1,0xbe13cd3a,0xbdf15bef,0xbe2934e3,0xbe1cf422,0xbe0519ac,0xbdc6d1ae
.long 0xbe24d9f1,0xbe11e7ab,0xbde699f9,0xbd96f7c7,0xbe1dacea,0xbe03ed58,0xbdbda278,0xbd462aed
.long 0xbe13cd3a,0xbde699f9,0xbd9040f2,0xbcb23636,0xbe076623,0xbdc0b81b,0xbd3f07aa,0x3bb2b098
.long 0xbdf15bef,0xbd96f7c7,0xbcb23636,0x3d052e81,0xbdcfca63,0xbd545f1e,0x3b6e46d7,0x3d707828
.long 0x80000000,0xbced1670,0xbd697c5a,0xbdaaaaab,0x80000000,0xbcfbbd8f,0xbd776ca3,0xbdb43f46
.long 0x80000000,0xbd052e81,0xbd829f63,0xbdbda278,0x80000000,0xbd0c7a2d,0xbd89788b,0xbdc6d1ae
.long 0x80000000,0xbd13c190,0xbd9040f2,0xbdcfca63,0x80000000,0xbd1b0474,0xbd96f7c7,0xbdd88a22
.long 0x80000000,0xbd22429f,0xbd9d9c36,0xbde10e84,0x80000000,0xbd297bd8,0xbda42d71,0xbde95535
.long 0x80000000,0xbd30afe8,0xbdaaaaab,0xbdf15bef,0x80000000,0xbd37de96,0xbdb11319,0xbdf9207f
.long 0x80000000,0xbd3f07aa,0xbdb765f5,0xbe005062,0x80000000,0xbd462aed,0xbdbda278,0xbe03ed58
.long 0x80000000,0xbd4d4826,0xbdc3c7e0,0xbe076623,0x80000000,0xbd545f1e,0xbdc9d56d,0xbe0ab9d0
.long 0x80000000,0xbd5b6f9e,0xbdcfca63,0xbe0de776,0x80000000,0xbd62796f,0xbdd5a607,0xbe10ee36
.long 0xbddb67a3,0xbe02bcfe,0xbe13cd3a,0xbe205fcc,0xbde699f9,0xbe088633,0xbe1910f8,0xbe245c16
.long 0xbdf15bef,0xbe0de776,0xbe1dacea,0xbe27632a,0xbdfba847,0xbe12dcaf,0xbe219c02,0xbe297084
.long 0xbe02bcfe,0xbe176218,0xbe24d9f1,0xbe2a8115,0xbe076623,0xbe1b743f,0xbe27632a,0xbe2a9346
.long 0xbe0bcd4d,0xbe1f100c,0xbe2934e3,0xbe29a6fc,0xbe0ff056,0xbe2232bd,0xbe2a4d1f,0xbe27bd97
.long 0xbe13cd3a,0xbe24d9f1,0xbe2aaaab,0xbe24d9f1,0xbe176218,0xbe2703a3,0xbe2a4d1f,0xbe21005b
.long 0xbe1aad31,0xbe28ae2c,0xbe2934e3,0xbe1c3692,0xbe1dacea,0xbe29d849,0xbe27632a,0xbe1683ba
.long 0xbe205fcc,0xbe2a8115,0xbe24d9f1,0xbe0ff056,0xbe22c488,0xbe2aa811,0xbe219c02,0xbe088633
.long 0xbe24d9f1,0xbe2a4d1f,0xbe1dacea,0xbe005062,0xbe269f06,0xbe297084,0xbe1910f8,0xbdeeb645
.long 0xbe2812e8,0xbe2aaaab,0xbe2812e8,0xbe205fcc,0xbe2a0469,0xbe29d849,0xbe23d938,0xbe183bda
.long 0xbe2aaaab,0xbe27632a,0xbe1dacea,0xbe0de776,0xbe2a0469,0xbe23515c,0xbe15a0c7,0xbe0188a9
.long 0xbe2812e8,0xbe1dacea,0xbe0bcd4d,0xbde699f9,0xbe24d9f1,0xbe1683ba,0xbe005062,0xbdc6d1ae
.long 0xbe205fcc,0xbe0de776,0xbde699f9,0xbda42d71,0xbe1aad31,0xbe03ed58,0xbdc9d56d,0xbd7e5995
.long 0xbe13cd3a,0xbdf15bef,0xbdaaaaab,0xbd30afe8,0xbe0bcd4d,0xbdd88a22,0xbd89788b,0xbcc0f788
.long 0xbe02bcfe,0xbdbda278,0xbd4d4826,0xbb6e46d7,0xbdf15bef,0xbda0e747,0xbd052e81,0x3c85d379
.long 0xbddb67a3,0xbd829f63,0xbc6dfe48,0x3d13c190,0xbdc3c7e0,0xbd462aed,0x3b6e46d7,0x3d62796f
.long 0xbdaaaaab,0xbd052e81,0x3cb23636,0x3d96f7c7,0xbd9040f2,0xbc85d379,0x3d22429f,0x3dba870e
.long 0xbe13cd3a,0xbe02bcfe,0xbddb67a3,0xbdaaaaab,0xbe076623,0xbde3d7b7,0xbdb11319,0xbd707828
.long 0xbdf15bef,0xbdbda278,0xbd829f63,0xbd052e81,0xbdcfca63,0xbd939e9c,0xbd22429f,0xbbb2b098
.long 0xbdaaaaab,0xbd4d4826,0xbc6dfe48,0x3cb23636,0xbd829f63,0xbcde6818,0x3c32981a,0x3d462aed
.long 0xbd30afe8,0xbb6e46d7,0x3d13c190,0x3d96f7c7,0xbcb23636,0x3ca36f76,0x3d776ca3,0x3dc6d1ae
.long 0xa3bc4197,0x3d30afe8,0x3daaaaab,0x3df15bef,0x3cb23636,0x3d860e02,0x3dd5a607,0x3e0ab9d0
.long 0x3d30afe8,0x3db11319,0x3dfba847,0x3e1910f8,0x3d829f63,0x3dd88a22,0x3e0de776,0x3e23515c
.long 0x3daaaaab,0x3dfba847,0x3e1aad31,0x3e2934e3,0x3dcfca63,0x3e0cdc87,0x3e23d938,0x3e2a9346
.long 0x3df15bef,0x3e1910f8,0x3e2934e3,0x3e27632a,0x3e076623,0x3e2232bd,0x3e2aa045,0x3e1fba5b
.long 0x3400,0x3400,0x3400,0x3400,0x3400,0x2e1f3364,0x31a831a8,0x33642e1f
.long 0x3400,0x31a831a8,0x34000000,0x31a8b1a8,0x3400,0x33642e1f,0x31a8b1a8,0xae1fb364
.long 0x3400,0x34000000,0xb400,0xb4008000,0x3400,0x3364ae1f,0xb1a8b1a8,0xae1f3364
.long 0x3400,0x31a8b1a8,0xb4008000,0x31a831a8,0x3400,0x2e1fb364,0xb1a831a8,0x3364ae1f
.long 0x3400,0xb400,0x3400,0xb400,0x3400,0xae1fb364,0x31a831a8,0xb364ae1f
.long 0x3400,0xb1a8b1a8,0x34000000,0xb1a831a8,0x3400,0xb364ae1f,0x31a8b1a8,0x2e1f3364
.long 0x3400,0xb4008000,0xb400,0x34000000,0x3400,0xb3642e1f,0xb1a8b1a8,0x2e1fb364
.long 0x3400,0xb1a831a8,0xb4008000,0xb1a8b1a8,0x3400,0xae1f3364,0xb1a831a8,0xb3642e1f
.long 0x3400,0x3400,0x3400,0x3400,0x34000000,0x3364ae1f,0x31a8b1a8,0x2e1fb364
.long 0xb400,0xb1a8b1a8,0xb4008000,0xb1a831a8,0xb4008000,0xae1f3364,0x31a831a8,0x3364ae1f
.long 0x3400,0x34000000,0xb400,0xb4008000,0x34000000,0xae1fb364,0xb1a831a8,0x33642e1f
.long 0xb400,0xb1a831a8,0x34000000,0xb1a8b1a8,0xb4008000,0x33642e1f,0xb1a8b1a8,0x2e1f3364
.long 0x3400,0xb400,0x3400,0xb400,0x34000000,0xb3642e1f,0x31a8b1a8,0xae1f3364
.long 0xb400,0x31a831a8,0xb4008000,0x31a8b1a8,0xb4008000,0x2e1fb364,0x31a831a8,0xb3642e1f
.long 0x3400,0xb4008000,0xb400,0x34000000,0x34000000,0x2e1f3364,0xb1a831a8,0xb364ae1f
.long 0xb400,0x31a8b1a8,0x34000000,0x31a831a8,0xb4008000,0xb364ae1f,0xb1a8b1a8,0xae1fb364
.long 0x3400,0x3400,0x3400,0x3400,0xb400,0xae1fb364,0xb1a8b1a8,0xb364ae1f
.long 0x3400,0x31a831a8,0x34000000,0x31a8b1a8,0xb400,0xb364ae1f,0xb1a831a8,0x2e1f3364
.long 0x3400,0x34000000,0xb400,0xb4008000,0xb400,0xb3642e1f,0x31a831a8,0x2e1fb364
.long 0x3400,0x31a8b1a8,0xb4008000,0x31a831a8,0xb400,0xae1f3364,0x31a8b1a8,0xb3642e1f
.long 0x3400,0xb400,0x3400,0xb400,0xb400,0x2e1f3364,0xb1a8b1a8,0x33642e1f
.long 0x3400,0xb1a8b1a8,0x34000000,0xb1a831a8,0xb400,0x33642e1f,0xb1a831a8,0xae1fb364
.long 0x3400,0xb4008000,0xb400,0x34000000,0xb400,0x3364ae1f,0x31a831a8,0xae1f3364
.long 0x3400,0xb1a831a8,0xb4008000,0xb1a8b1a8,0xb400,0x2e1fb364,0x31a8b1a8,0x3364ae1f
.long 0x3400,0x3400,0x3400,0x3400,0xb4008000,0xb3642e1f,0xb1a831a8,0xae1f3364
.long 0xb400,0xb1a8b1a8,0xb4008000,0xb1a831a8,0x34000000,0x2e1fb364,0xb1a8b1a8,0xb3642e1f
.long 0x3400,0x34000000,0xb400,0xb4008000,0xb4008000,0x2e1f3364,0x31a8b1a8,0xb364ae1f
.long 0xb400,0xb1a831a8,0x34000000,0xb1a8b1a8,0x34000000,0xb364ae1f,0x31a831a8,0xae1fb364
.long 0x3400,0xb400,0x3400,0xb400,0xb4008000,0x3364ae1f,0xb1a831a8,0x2e1fb364
.long 0xb400,0x31a831a8,0xb4008000,0x31a8b1a8,0x34000000,0xae1f3364,0xb1a8b1a8,0x3364ae1f
.long 0x3400,0xb4008000,0xb400,0x34000000,0xb4008000,0xae1fb364,0x31a8b1a8,0x33642e1f
.long 0xb400,0x31a8b1a8,0x34000000,0x31a831a8,0x34000000,0x33642e1f,0x31a831a8,0x2e1f3364
.long 0x34008000,0x34008000,0x34008000,0x34008000,0x34008000,0x3364ae1f,0x31a8b1a8,0x2e1fb364
.long 0x34008000,0x31a8b1a8,0xb400,0xb1a8b1a8,0x34008000,0x2e1fb364,0xb1a8b1a8,0xb3642e1f
.long 0x34008000,0xb400,0xb4008000,0x80003400,0x34008000,0xae1fb364,0xb1a831a8,0x33642e1f
.long 0x34008000,0xb1a8b1a8,0x80003400,0x31a8b1a8,0x34008000,0xb364ae1f,0x31a831a8,0xae1fb364
.long 0xb4000000,0x34000000,0xb4000000,0x34000000,0xb4000000,0x3364ae1f,0xb1a831a8,0x2e1fb364
.long 0xb4000000,0x31a8b1a8,0x80003400,0xb1a8b1a8,0xb4000000,0x2e1fb364,0x31a831a8,0xb3642e1f
.long 0xb4000000,0xb400,0x34000000,0x80003400,0xb4000000,0xae1fb364,0x31a8b1a8,0x33642e1f
.long 0xb4000000,0xb1a8b1a8,0xb400,0x31a8b1a8,0xb4000000,0xb364ae1f,0xb1a8b1a8,0xae1fb364
.long 0x34008000,0x34008000,0x34008000,0x34008000,0xb400,0xae1fb364,0xb1a8b1a8,0xb364ae1f
.long 0xb4008000,0xb1a831a8,0x80003400,0x31a831a8,0x80003400,0x33642e1f,0x31a8b1a8,0xae1fb364
.long 0x34008000,0xb400,0xb4008000,0x80003400,0xb400,0xb3642e1f,0x31a831a8,0x2e1fb364
.long 0xb4008000,0x31a831a8,0xb400,0xb1a831a8,0x80003400,0x2e1fb364,0xb1a831a8,0x3364ae1f
.long 0xb4000000,0x34000000,0xb4000000,0x34000000,0x80003400,0xae1fb364,0x31a831a8,0xb364ae1f
.long 0x34000000,0xb1a831a8,0xb400,0x31a831a8,0xb400,0x33642e1f,0xb1a831a8,0xae1fb364
.long 0xb4000000,0xb400,0x34000000,0x80003400,0x80003400,0xb3642e1f,0xb1a8b1a8,0x2e1fb364
.long 0x34000000,0x31a831a8,0x80003400,0xb1a831a8,0xb400,0x2e1fb364,0x31a8b1a8,0x3364ae1f
.long 0x34008000,0x34008000,0x34008000,0x34008000,0xb4008000,0xb3642e1f,0xb1a831a8,0xae1f3364
.long 0x34008000,0x31a8b1a8,0xb400,0xb1a8b1a8,0xb4008000,0xae1f3364,0x31a831a8,0x3364ae1f
.long 0x34008000,0xb400,0xb4008000,0x80003400,0xb4008000,0x2e1f3364,0x31a8b1a8,0xb364ae1f
.long 0x34008000,0xb1a8b1a8,0x80003400,0x31a8b1a8,0xb4008000,0x33642e1f,0xb1a8b1a8,0x2e1f3364
.long 0xb4000000,0x34000000,0xb4000000,0x34000000,0x34000000,0xb3642e1f,0x31a8b1a8,0xae1f3364
.long 0xb4000000,0x31a8b1a8,0x80003400,0xb1a8b1a8,0x34000000,0xae1f3364,0xb1a8b1a8,0x3364ae1f
.long 0xb4000000,0xb400,0x34000000,0x80003400,0x34000000,0x2e1f3364,0xb1a831a8,0xb364ae1f
.long 0xb4000000,0xb1a8b1a8,0xb400,0x31a8b1a8,0x34000000,0x33642e1f,0x31a831a8,0x2e1f3364
.long 0x34008000,0x34008000,0x34008000,0x34008000,0x80003400,0x2e1f3364,0x31a831a8,0x33642e1f
.long 0xb4008000,0xb1a831a8,0x80003400,0x31a831a8,0xb400,0xb364ae1f,0xb1a831a8,0x2e1f3364
.long 0x34008000,0xb400,0xb4008000,0x80003400,0x80003400,0x3364ae1f,0xb1a8b1a8,0xae1f3364
.long 0xb4008000,0x31a831a8,0xb400,0xb1a831a8,0xb400,0xae1f3364,0x31a8b1a8,0xb3642e1f
.long 0xb4000000,0x34000000,0xb4000000,0x34000000,0xb400,0x2e1f3364,0xb1a8b1a8,0x33642e1f
.long 0x34000000,0xb1a831a8,0xb400,0x31a831a8,0x80003400,0xb364ae1f,0x31a8b1a8,0x2e1f3364
.long 0xb4000000,0xb400,0x34000000,0x80003400,0xb400,0x3364ae1f,0x31a831a8,0xae1f3364
.long 0x34000000,0x31a831a8,0x80003400,0xb1a831a8,0x80003400,0xae1f3364,0xb1a831a8,0xb3642e1f
.long 0x0,0x90,0x120,0x1b0,0x4,0x94,0x124,0x1b4
.long 0x8,0x98,0x128,0x1b8,0xc,0x9c,0x12c,0x1bc
.long 0x10,0xa0,0x130,0x1c0,0x14,0xa4,0x134,0x1c4
.long 0x18,0xa8,0x138,0x1c8,0x1c,0xac,0x13c,0x1cc
.long 0x20,0xb0,0x140,0x1d0,0x24,0xb4,0x144,0x1d4
.long 0x28,0xb8,0x148,0x1d8,0x2c,0xbc,0x14c,0x1dc
.long 0x30,0xc0,0x150,0x1e0,0x34,0xc4,0x154,0x1e4
.long 0x38,0xc8,0x158,0x1e8,0x3c,0xcc,0x15c,0x1ec
.long 0x240,0x2d0,0x360,0x3f0,0x244,0x2d4,0x364,0x3f4
.long 0x248,0x2d8,0x368,0x3f8,0x24c,0x2dc,0x36c,0x3fc
.long 0x250,0x2e0,0x370,0x400,0x254,0x2e4,0x374,0x404
.long 0x258,0x2e8,0x378,0x408,0x25c,0x2ec,0x37c,0x40c
.long 0x260,0x2f0,0x380,0x410,0x264,0x2f4,0x384,0x414
.long 0x268,0x2f8,0x388,0x418,0x26c,0x2fc,0x38c,0x41c
.long 0x270,0x300,0x390,0x420,0x274,0x304,0x394,0x424
.long 0x278,0x308,0x398,0x428,0x27c,0x30c,0x39c,0x42c
.long 0x480,0x3f0,0x360,0x2d0,0x47c,0x3ec,0x35c,0x2cc
.long 0x478,0x3e8,0x358,0x2c8,0x474,0x3e4,0x354,0x2c4
.long 0x470,0x3e0,0x350,0x2c0,0x46c,0x3dc,0x34c,0x2bc
.long 0x468,0x3d8,0x348,0x2b8,0x464,0x3d4,0x344,0x2b4
.long 0x460,0x3d0,0x340,0x2b0,0x45c,0x3cc,0x33c,0x2ac
.long 0x458,0x3c8,0x338,0x2a8,0x454,0x3c4,0x334,0x2a4
.long 0x450,0x3c0,0x330,0x2a0,0x44c,0x3bc,0x32c,0x29c
.long 0x448,0x3b8,0x328,0x298,0x444,0x3b4,0x324,0x294
.long 0x240,0x1b0,0x120,0x90,0x23c,0x1ac,0x11c,0x8c
.long 0x238,0x1a8,0x118,0x88,0x234,0x1a4,0x114,0x84
.long 0x230,0x1a0,0x110,0x80,0x22c,0x19c,0x10c,0x7c
.long 0x228,0x198,0x108,0x78,0x224,0x194,0x104,0x74
.long 0x220,0x190,0x100,0x70,0x21c,0x18c,0xfc,0x6c
.long 0x218,0x188,0xf8,0x68,0x214,0x184,0xf4,0x64
.long 0x210,0x180,0xf0,0x60,0x20c,0x17c,0xec,0x5c
.long 0x208,0x178,0xe8,0x58,0x204,0x174,0xe4,0x54
.long 0x40,0xd0,0x160,0x1f0,0x44,0xd4,0x164,0x1f4
.long 0x48,0xd8,0x168,0x1f8,0x484,0x484,0x484,0x484
.long 0x484,0x484,0x484,0x484,0x484,0x484,0x484,0x484
.long 0x484,0x484,0x484,0x484,0x484,0x484,0x484,0x484
.long 0x484,0x484,0x484,0x484,0x484,0x484,0x484,0x484
.long 0x484,0x484,0x484,0x484,0x484,0x484,0x484,0x484
.long 0x484,0x484,0x484,0x484,0x484,0x484,0x484,0x484
.long 0x484,0x484,0x484,0x484,0x484,0x484,0x484,0x484
.long 0x280,0x310,0x3a0,0x430,0x284,0x314,0x3a4,0x434
.long 0x288,0x318,0x3a8,0x438,0x484,0x484,0x484,0x484
.long 0x484,0x484,0x484,0x484,0x484,0x484,0x484,0x484
.long 0x484,0x484,0x484,0x484,0x484,0x484,0x484,0x484
.long 0x484,0x484,0x484,0x484,0x484,0x484,0x484,0x484
.long 0x484,0x484,0x484,0x484,0x484,0x484,0x484,0x484
.long 0x484,0x484,0x484,0x484,0x484,0x484,0x484,0x484
.long 0x484,0x484,0x484,0x484,0x484,0x484,0x484,0x484
.long 0x440,0x3b0,0x320,0x290,0x43c,0x3ac,0x31c,0x28c
.long 0x438,0x3a8,0x318,0x288,0x484,0x484,0x484,0x484
.long 0x484,0x484,0x484,0x484,0x484,0x484,0x484,0x484
.long 0x484,0x484,0x484,0x484,0x484,0x484,0x484,0x484
.long 0x484,0x484,0x484,0x484,0x484,0x484,0x484,0x484
.long 0x484,0x484,0x484,0x484,0x484,0x484,0x484,0x484
.long 0x484,0x484,0x484,0x484,0x484,0x484,0x484,0x484
.long 0x484,0x484,0x484,0x484,0x484,0x484,0x484,0x484
.long 0x200,0x170,0xe0,0x50,0x1fc,0x16c,0xdc,0x4c
.long 0x1f8,0x168,0xd8,0x48,0x484,0x484,0x484,0x484
.long 0x484,0x484,0x484,0x484,0x484,0x484,0x484,0x484
.long 0x484,0x484,0x484,0x484,0x484,0x484,0x484,0x484
.long 0x484,0x484,0x484,0x484,0x484,0x484,0x484,0x484
.long 0x484,0x484,0x484,0x484,0x484,0x484,0x484,0x484
.long 0x484,0x484,0x484,0x484,0x484,0x484,0x484,0x484
.long 0x484,0x484,0x484,0x484,0x484,0x484,0x484,0x484
.long 0x3400,0x3400,0x3400,0x3400,0x3400,0x2e1f3364,0x31a831a8,0x33642e1f
.long 0x3400,0x31a831a8,0x34000000,0x31a8b1a8,0x3400,0x33642e1f,0x31a8b1a8,0xae1fb364
.long 0x3400,0x34000000,0xb400,0xb4008000,0x3400,0x3364ae1f,0xb1a8b1a8,0xae1f3364
.long 0x3400,0x31a8b1a8,0xb4008000,0x31a831a8,0x3400,0x2e1fb364,0xb1a831a8,0x3364ae1f
.long 0x3400,0xb400,0x3400,0xb400,0x3400,0xae1fb364,0x31a831a8,0xb364ae1f
.long 0x3400,0xb1a8b1a8,0x34000000,0xb1a831a8,0x3400,0xb364ae1f,0x31a8b1a8,0x2e1f3364
.long 0x3400,0xb4008000,0xb400,0x34000000,0x3400,0xb3642e1f,0xb1a8b1a8,0x2e1fb364
.long 0x3400,0xb1a831a8,0xb4008000,0xb1a8b1a8,0x3400,0xae1f3364,0xb1a831a8,0xb3642e1f
.long 0x3400,0x3400,0x3400,0x3400,0x34000000,0x3364ae1f,0x31a8b1a8,0x2e1fb364
.long 0xb400,0xb1a8b1a8,0xb4008000,0xb1a831a8,0xb4008000,0xae1f3364,0x31a831a8,0x3364ae1f
.long 0x3400,0x34000000,0xb400,0xb4008000,0x34000000,0xae1fb364,0xb1a831a8,0x33642e1f
.long 0xb400,0xb1a831a8,0x34000000,0xb1a8b1a8,0xb4008000,0x33642e1f,0xb1a8b1a8,0x2e1f3364
.long 0x3400,0xb400,0x3400,0xb400,0x34000000,0xb3642e1f,0x31a8b1a8,0xae1f3364
.long 0xb400,0x31a831a8,0xb4008000,0x31a8b1a8,0xb4008000,0x2e1fb364,0x31a831a8,0xb3642e1f
.long 0x3400,0xb4008000,0xb400,0x34000000,0x34000000,0x2e1f3364,0xb1a831a8,0xb364ae1f
.long 0xb400,0x31a8b1a8,0x34000000,0x31a831a8,0xb4008000,0xb364ae1f,0xb1a8b1a8,0xae1fb364
.long 0x3400,0x3400,0x3400,0x3400,0xb400,0xae1fb364,0xb1a8b1a8,0xb364ae1f
.long 0x3400,0x31a831a8,0x34000000,0x31a8b1a8,0xb400,0xb364ae1f,0xb1a831a8,0x2e1f3364
.long 0x3400,0x34000000,0xb400,0xb4008000,0xb400,0xb3642e1f,0x31a831a8,0x2e1fb364
.long 0x3400,0x31a8b1a8,0xb4008000,0x31a831a8,0xb400,0xae1f3364,0x31a8b1a8,0xb3642e1f
.long 0x3400,0xb400,0x3400,0xb400,0xb400,0x2e1f3364,0xb1a8b1a8,0x33642e1f
.long 0x3400,0xb1a8b1a8,0x34000000,0xb1a831a8,0xb400,0x33642e1f,0xb1a831a8,0xae1fb364
.long 0x3400,0xb4008000,0xb400,0x34000000,0xb400,0x3364ae1f,0x31a831a8,0xae1f3364
.long 0x3400,0xb1a831a8,0xb4008000,0xb1a8b1a8,0xb400,0x2e1fb364,0x31a8b1a8,0x3364ae1f
.long 0x3400,0x3400,0x3400,0x3400,0xb4008000,0xb3642e1f,0xb1a831a8,0xae1f3364
.long 0xb400,0xb1a8b1a8,0xb4008000,0xb1a831a8,0x34000000,0x2e1fb364,0xb1a8b1a8,0xb3642e1f
.long 0x3400,0x34000000,0xb400,0xb4008000,0xb4008000,0x2e1f3364,0x31a8b1a8,0xb364ae1f
.long 0xb400,0xb1a831a8,0x34000000,0xb1a8b1a8,0x34000000,0xb364ae1f,0x31a831a8,0xae1fb364
.long 0x3400,0xb400,0x3400,0xb400,0xb4008000,0x3364ae1f,0xb1a831a8,0x2e1fb364
.long 0xb400,0x31a831a8,0xb4008000,0x31a8b1a8,0x34000000,0xae1f3364,0xb1a8b1a8,0x3364ae1f
.long 0x3400,0xb4008000,0xb400,0x34000000,0xb4008000,0xae1fb364,0x31a8b1a8,0x33642e1f
.long 0xb400,0x31a8b1a8,0x34000000,0x31a831a8,0x34000000,0x33642e1f,0x31a831a8,0x2e1f3364
.long 0x34008000,0x34008000,0x34008000,0x34008000,0x34008000,0x3364ae1f,0x31a8b1a8,0x2e1fb364
.long 0x34008000,0x31a8b1a8,0xb400,0xb1a8b1a8,0x34008000,0x2e1fb364,0xb1a8b1a8,0xb3642e1f
.long 0x34008000,0xb400,0xb4008000,0x80003400,0x34008000,0xae1fb364,0xb1a831a8,0x33642e1f
.long 0x34008000,0xb1a8b1a8,0x80003400,0x31a8b1a8,0x34008000,0xb364ae1f,0x31a831a8,0xae1fb364
.long 0x34008000,0xb4008000,0x34008000,0xb4008000,0x34008000,0xb3642e1f,0x31a8b1a8,0xae1f3364
.long 0x34008000,0xb1a831a8,0xb400,0x31a831a8,0x34008000,0xae1f3364,0xb1a8b1a8,0x3364ae1f
.long 0x34008000,0x80003400,0xb4008000,0xb400,0x34008000,0x2e1f3364,0xb1a831a8,0xb364ae1f
.long 0x34008000,0x31a831a8,0x80003400,0xb1a831a8,0x34008000,0x33642e1f,0x31a831a8,0x2e1f3364
.long 0x34008000,0x34008000,0x34008000,0x34008000,0xb400,0xae1fb364,0xb1a8b1a8,0xb364ae1f
.long 0xb4008000,0xb1a831a8,0x80003400,0x31a831a8,0x80003400,0x33642e1f,0x31a8b1a8,0xae1fb364
.long 0x34008000,0xb400,0xb4008000,0x80003400,0xb400,0xb3642e1f,0x31a831a8,0x2e1fb364
.long 0xb4008000,0x31a831a8,0xb400,0xb1a831a8,0x80003400,0x2e1fb364,0xb1a831a8,0x3364ae1f
.long 0x34008000,0xb4008000,0x34008000,0xb4008000,0xb400,0x2e1f3364,0xb1a8b1a8,0x33642e1f
.long 0xb4008000,0x31a8b1a8,0x80003400,0xb1a8b1a8,0x80003400,0xb364ae1f,0x31a8b1a8,0x2e1f3364
.long 0x34008000,0x80003400,0xb4008000,0xb400,0xb400,0x3364ae1f,0x31a831a8,0xae1f3364
.long 0xb4008000,0xb1a8b1a8,0xb400,0x31a8b1a8,0x80003400,0xae1f3364,0xb1a831a8,0xb3642e1f
.long 0x34008000,0x34008000,0x34008000,0x34008000,0xb4008000,0xb3642e1f,0xb1a831a8,0xae1f3364
.long 0x34008000,0x31a8b1a8,0xb400,0xb1a8b1a8,0xb4008000,0xae1f3364,0x31a831a8,0x3364ae1f
.long 0x34008000,0xb400,0xb4008000,0x80003400,0xb4008000,0x2e1f3364,0x31a8b1a8,0xb364ae1f
.long 0x34008000,0xb1a8b1a8,0x80003400,0x31a8b1a8,0xb4008000,0x33642e1f,0xb1a8b1a8,0x2e1f3364
.long 0x34008000,0xb4008000,0x34008000,0xb4008000,0xb4008000,0x3364ae1f,0xb1a831a8,0x2e1fb364
.long 0x34008000,0xb1a831a8,0xb400,0x31a831a8,0xb4008000,0x2e1fb364,0x31a831a8,0xb3642e1f
.long 0x34008000,0x80003400,0xb4008000,0xb400,0xb4008000,0xae1fb364,0x31a8b1a8,0x33642e1f
.long 0x34008000,0x31a831a8,0x80003400,0xb1a831a8,0xb4008000,0xb364ae1f,0xb1a8b1a8,0xae1fb364
.long 0x34008000,0x34008000,0x34008000,0x34008000,0x80003400,0x2e1f3364,0x31a831a8,0x33642e1f
.long 0xb4008000,0xb1a831a8,0x80003400,0x31a831a8,0xb400,0xb364ae1f,0xb1a831a8,0x2e1f3364
.long 0x34008000,0xb400,0xb4008000,0x80003400,0x80003400,0x3364ae1f,0xb1a8b1a8,0xae1f3364
.long 0xb4008000,0x31a831a8,0xb400,0xb1a831a8,0xb400,0xae1f3364,0x31a8b1a8,0xb3642e1f
.long 0x34008000,0xb4008000,0x34008000,0xb4008000,0x80003400,0xae1fb364,0x31a831a8,0xb364ae1f
.long 0xb4008000,0x31a8b1a8,0x80003400,0xb1a8b1a8,0xb400,0x33642e1f,0xb1a831a8,0xae1fb364
.long 0x34008000,0x80003400,0xb4008000,0xb400,0x80003400,0xb3642e1f,0xb1a8b1a8,0x2e1fb364
.long 0xb4008000,0xb1a8b1a8,0xb400,0x31a8b1a8,0xb400,0x2e1fb364,0x31a8b1a8,0x3364ae1f
.long 0x3f800000,0x3f800000,0x3f800000,0x3f800000,0x3f800000,0x3f7fec43,0x3f7fb10f,0x3f7f4e6d
.long 0x3f800000,0x3f7fb10f,0x3f7ec46d,0x3f7d3aac,0x3f800000,0x3f7f4e6d,0x3f7d3aac,0x3f79c79d
.long 0x3f800000,0x3f7ec46d,0x3f7b14be,0x3f74fa0b,0x3f800000,0x3f7e1324,0x3f7853f8,0x3f6ed89e
.long 0x3f800000,0x3f7d3aac,0x3f74fa0b,0x3f676bd8,0x3f800000,0x3f7c3b28,0x3f710908,0x3f5ebe05
.long 0x3f800000,0x3f7b14be,0x3f6c835e,0x3f54db31,0x3f800000,0x3f79c79d,0x3f676bd8,0x3f49d112
.long 0x3f800000,0x3f7853f8,0x3f61c598,0x3f3daef9,0x3f800000,0x3f76ba07,0x3f5b941a,0x3f3085bb
.long 0x3f800000,0x3f74fa0b,0x3f54db31,0x3f226799,0x3f800000,0x3f731447,0x3f4d9f02,0x3f13682a
.long 0x3f800000,0x3f710908,0x3f45e403,0x3f039c3d,0x3f800000,0x3f6ed89e,0x3f3daef9,0x3ee63375
.long 0x3f800000,0x3f800000,0x3f800000,0x3f800000,0x3f7ec46d,0x3f7e1324,0x3f7d3aac,0x3f7c3b28
.long 0x3f7b14be,0x3f7853f8,0x3f74fa0b,0x3f710908,0x3f74fa0b,0x3f6ed89e,0x3f676bd8,0x3f5ebe05
.long 0x3f6c835e,0x3f61c598,0x3f54db31,0x3f45e403,0x3f61c598,0x3f514d3d,0x3f3daef9,0x3f273656
.long 0x3f54db31,0x3f3daef9,0x3f226799,0x3f039c3d,0x3f45e403,0x3f273656,0x3f039c3d,0x3eb8442a
.long 0x3f3504f3,0x3f0e39da,0x3ec3ef15,0x3e47c5c2,0x3f226799,0x3ee63375,0x3e78cfcc,0x3cc90ab0
.long 0x3f0e39da,0x3eac7cd4,0x3dc8bd36,0xbe164083,0x3ef15aea,0x3e605c13,0xbd48fb30,0xbea09ae5
.long 0x3ec3ef15,0x3dc8bd36,0xbe47c5c2,0xbef15aea,0x3e94a031,0xbcc90ab0,0xbeac7cd4,0xbf1d7fd1
.long 0x3e47c5c2,0xbe164083,0xbef15aea,0xbf3daef9,0x3dc8bd36,0xbe888e93,0xbf187fc0,0xbf584853
.long 0x3f800000,0x3f800000,0x3f800000,0x3f800000,0x3f7b14be,0x3f79c79d,0x3f7853f8,0x3f76ba07
.long 0x3f6c835e,0x3f676bd8,0x3f61c598,0x3f5b941a,0x3f54db31,0x3f49d112,0x3f3daef9,0x3f3085bb
.long 0x3f3504f3,0x3f226799,0x3f0e39da,0x3ef15aea,0x3f0e39da,0x3ee63375,0x3eac7cd4,0x3e605c13
.long 0x3ec3ef15,0x3e78cfcc,0x3dc8bd36,0xbd48fb30,0x3e47c5c2,0x3cc90ab0,0xbe164083,0xbea09ae5
.long 0x248d3132,0xbe47c5c2,0xbec3ef15,0xbf0e39da,0xbe47c5c2,0xbecf7bca,0xbf187fc0,0xbf41d870
.long 0xbec3ef15,0xbf187fc0,0xbf45e403,0xbf676bd8,0xbf0e39da,0xbf41d870,0xbf676bd8,0xbf7c3b28
.long 0xbf3504f3,0xbf61c598,0xbf7b14be,0xbf7ec46d,0xbf54db31,0xbf76ba07,0xbf7fb10f,0xbf6ed89e
.long 0xbf6c835e,0xbf7fb10f,0xbf74fa0b,0xbf4d9f02,0xbf7b14be,0xbf7c3b28,0xbf5b941a,0xbf1d7fd1
.long 0x3f800000,0x3f800000,0x3f800000,0x3f800000,0x3f74fa0b,0x3f731447,0x3f710908,0x3f6ed89e
.long 0x3f54db31,0x3f4d9f02,0x3f45e403,0x3f3daef9,0x3f226799,0x3f13682a,0x3f039c3d,0x3ee63375
.long 0x3ec3ef15,0x3e94a031,0x3e47c5c2,0x3dc8bd36,0x3dc8bd36,0xbcc90ab0,0xbe164083,0xbe888e93
.long 0xbe47c5c2,0xbeac7cd4,0xbef15aea,0xbf187fc0,0xbef15aea,0xbf1d7fd1,0xbf3daef9,0xbf584853
.long 0xbf3504f3,0xbf54db31,0xbf6c835e,0xbf7b14be,0xbf61c598,0xbf76ba07,0xbf7fb10f,0xbf7c3b28
.long 0xbf7b14be,0xbf7fb10f,0xbf74fa0b,0xbf5b941a,0xbf7ec46d,0xbf6ed89e,0xbf4d9f02,0xbf1d7fd1
.long 0xbf6c835e,0xbf45e403,0xbf0e39da,0xbe94a031,0xbf45e403,0xbf08f59b,0xbe78cfcc,0x3d96a905
.long 0xbf0e39da,0xbe78cfcc,0x3dc8bd36,0x3edae880,0xbe94a031,0x3d96a905,0x3edae880,0x3f396842
.long 0x80000000,0x80000000,0x80000000,0x80000000,0x80000000,0xbcc90ab0,0xbd48fb30,0xbd96a905
.long 0x80000000,0xbd48fb30,0xbdc8bd36,0xbe164083,0x80000000,0xbd96a905,0xbe164083,0xbe605c13
.long 0x80000000,0xbdc8bd36,0xbe47c5c2,0xbe94a031,0x80000000,0xbdfab273,0xbe78cfcc,0xbeb8442a
.long 0x80000000,0xbe164083,0xbe94a031,0xbedae880,0x80000000,0xbe2f10a2,0xbeac7cd4,0xbefc5d27
.long 0x80000000,0xbe47c5c2,0xbec3ef15,0xbf0e39da,0x80000000,0xbe605c13,0xbedae880,0xbf1d7fd1
.long 0x80000000,0xbe78cfcc,0xbef15aea,0xbf2beb4a,0x80000000,0xbe888e93,0xbf039c3d,0xbf396842
.long 0x80000000,0xbe94a031,0xbf0e39da,0xbf45e403,0x80000000,0xbea09ae5,0xbf187fc0,0xbf514d3d
.long 0x80000000,0xbeac7cd4,0xbf226799,0xbf5b941a,0x80000000,0xbeb8442a,0xbf2beb4a,0xbf64aa59
.long 0x80000000,0x80000000,0x80000000,0x80000000,0xbdc8bd36,0xbdfab273,0xbe164083,0xbe2f10a2
.long 0xbe47c5c2,0xbe78cfcc,0xbe94a031,0xbeac7cd4,0xbe94a031,0xbeb8442a,0xbedae880,0xbefc5d27
.long 0xbec3ef15,0xbef15aea,0xbf0e39da,0xbf226799,0xbef15aea,0xbf13682a,0xbf2beb4a,0xbf41d870
.long 0xbf0e39da,0xbf2beb4a,0xbf45e403,0xbf5b941a,0xbf226799,0xbf41d870,0xbf5b941a,0xbf6ed89e
.long 0xbf3504f3,0xbf54db31,0xbf6c835e,0xbf7b14be,0xbf45e403,0xbf64aa59,0xbf7853f8,0xbf7fec43
.long 0xbf54db31,0xbf710908,0xbf7ec46d,0xbf7d3aac,0xbf61c598,0xbf79c79d,0xbf7fb10f,0xbf731447
.long 0xbf6c835e,0xbf7ec46d,0xbf7b14be,0xbf61c598,0xbf74fa0b,0xbf7fec43,0xbf710908,0xbf49d112
.long 0xbf7b14be,0xbf7d3aac,0xbf61c598,0xbf2beb4a,0xbf7ec46d,0xbf76ba07,0xbf4d9f02,0xbf08f59b
.long 0x80000000,0x80000000,0x80000000,0x80000000,0xbe47c5c2,0xbe605c13,0xbe78cfcc,0xbe888e93
.long 0xbec3ef15,0xbedae880,0xbef15aea,0xbf039c3d,0xbf0e39da,0xbf1d7fd1,0xbf2beb4a,0xbf396842
.long 0xbf3504f3,0xbf45e403,0xbf54db31,0xbf61c598,0xbf54db31,0xbf64aa59,0xbf710908,0xbf79c79d
.long 0xbf6c835e,0xbf7853f8,0xbf7ec46d,0xbf7fb10f,0xbf7b14be,0xbf7fec43,0xbf7d3aac,0xbf731447
.long 0xbf800000,0xbf7b14be,0xbf6c835e,0xbf54db31,0xbf7b14be,0xbf6a09a7,0xbf4d9f02,0xbf273656
.long 0xbf6c835e,0xbf4d9f02,0xbf226799,0xbedae880,0xbf54db31,0xbf273656,0xbedae880,0xbe2f10a2
.long 0xbf3504f3,0xbef15aea,0xbe47c5c2,0x3dc8bd36,0xbf0e39da,0xbe888e93,0x3d48fb30,0x3eb8442a
.long 0xbec3ef15,0xbd48fb30,0x3e94a031,0x3f187fc0,0xbe47c5c2,0x3e2f10a2,0x3f039c3d,0x3f49d112
.long 0x80000000,0x80000000,0x80000000,0x80000000,0xbe94a031,0xbea09ae5,0xbeac7cd4,0xbeb8442a
.long 0xbf0e39da,0xbf187fc0,0xbf226799,0xbf2beb4a,0xbf45e403,0xbf514d3d,0xbf5b941a,0xbf64aa59
.long 0xbf6c835e,0xbf74fa0b,0xbf7b14be,0xbf7ec46d,0xbf7ec46d,0xbf7fec43,0xbf7d3aac,0xbf76ba07
.long 0xbf7b14be,0xbf710908,0xbf61c598,0xbf4d9f02,0xbf61c598,0xbf49d112,0xbf2beb4a,0xbf08f59b
.long 0xbf3504f3,0xbf0e39da,0xbec3ef15,0xbe47c5c2,0xbef15aea,0xbe888e93,0xbd48fb30,0x3e2f10a2
.long 0xbe47c5c2,0x3d48fb30,0x3e94a031,0x3f039c3d,0x3dc8bd36,0x3eb8442a,0x3f187fc0,0x3f49d112
.long 0x3ec3ef15,0x3f226799,0x3f54db31,0x3f74fa0b,0x3f226799,0x3f584853,0x3f7853f8,0x3f7f4e6d
.long 0x3f54db31,0x3f7853f8,0x3f7ec46d,0x3f676bd8,0x3f74fa0b,0x3f7f4e6d,0x3f676bd8,0x3f3085bb
.long 0x80003400,0x80003400,0x80003400,0x80003400,0x80003400,0xae1f3364,0xb1a831a8,0xb3642e1f
.long 0x80003400,0xb1a831a8,0xb4000000,0xb1a8b1a8,0x80003400,0xb3642e1f,0xb1a8b1a8,0x2e1fb364
.long 0x80003400,0xb4000000,0x8000b400,0x34008000,0x80003400,0xb364ae1f,0x31a8b1a8,0x2e1f3364
.long 0x80003400,0xb1a8b1a8,0x34008000,0xb1a831a8,0x80003400,0xae1fb364,0x31a831a8,0xb364ae1f
.long 0x80003400,0x8000b400,0x80003400,0x8000b400,0x80003400,0x2e1fb364,0xb1a831a8,0x3364ae1f
.long 0x80003400,0x31a8b1a8,0xb4000000,0x31a831a8,0x80003400,0x3364ae1f,0xb1a8b1a8,0xae1f3364
.long 0x80003400,0x34008000,0x8000b400,0xb4000000,0x80003400,0x33642e1f,0x31a8b1a8,0xae1fb364
.long 0x80003400,0x31a831a8,0x34008000,0x31a8b1a8,0x80003400,0x2e1f3364,0x31a831a8,0x33642e1f
.long 0x80003400,0x80003400,0x80003400,0x80003400,0xb4000000,0xb364ae1f,0xb1a8b1a8,0xae1fb364
.long 0x8000b400,0x31a8b1a8,0x34008000,0x31a831a8,0x34008000,0x2e1f3364,0xb1a831a8,0xb364ae1f
.long 0x80003400,0xb4000000,0x8000b400,0x34008000,0xb4000000,0x2e1fb364,0x31a831a8,0xb3642e1f
.long 0x8000b400,0x31a831a8,0xb4000000,0x31a8b1a8,0x34008000,0xb3642e1f,0x31a8b1a8,0xae1f3364
.long 0x80003400,0x8000b400,0x80003400,0x8000b400,0xb4000000,0x33642e1f,0xb1a8b1a8,0x2e1f3364
.long 0x8000b400,0xb1a831a8,0x34008000,0xb1a8b1a8,0x34008000,0xae1fb364,0xb1a831a8,0x33642e1f
.long 0x80003400,0x34008000,0x8000b400,0xb4000000,0xb4000000,0xae1f3364,0x31a831a8,0x3364ae1f
.long 0x8000b400,0xb1a8b1a8,0xb4000000,0xb1a831a8,0x34008000,0x3364ae1f,0x31a8b1a8,0x2e1fb364
.long 0x3400,0x3400,0x3400,0x3400,0xb400,0xae1fb364,0xb1a8b1a8,0xb364ae1f
.long 0x3400,0x31a831a8,0x34000000,0x31a8b1a8,0xb400,0xb364ae1f,0xb1a831a8,0x2e1f3364
.long 0x3400,0x34000000,0xb400,0xb4008000,0xb400,0xb3642e1f,0x31a831a8,0x2e1fb364
.long 0x3400,0x31a8b1a8,0xb4008000,0x31a831a8,0xb400,0xae1f3364,0x31a8b1a8,0xb3642e1f
.long 0x3400,0xb400,0x3400,0xb400,0xb400,0x2e1f3364,0xb1a8b1a8,0x33642e1f
.long 0x3400,0xb1a8b1a8,0x34000000,0xb1a831a8,0xb400,0x33642e1f,0xb1a831a8,0xae1fb364
.long 0x3400,0xb4008000,0xb400,0x34000000,0xb400,0x3364ae1f,0x31a831a8,0xae1f3364
.long 0x3400,0xb1a831a8,0xb4008000,0xb1a8b1a8,0xb400,0x2e1fb364,0x31a8b1a8,0x3364ae1f
.long 0x3400,0x3400,0x3400,0x3400,0xb4008000,0xb3642e1f,0xb1a831a8,0xae1f3364
.long 0xb400,0xb1a8b1a8,0xb4008000,0xb1a831a8,0x34000000,0x2e1fb364,0xb1a8b1a8,0xb3642e1f
.long 0x3400,0x34000000,0xb400,0xb4008000,0xb4008000,0x2e1f3364,0x31a8b1a8,0xb364ae1f
.long 0xb400,0xb1a831a8,0x34000000,0xb1a8b1a8,0x34000000,0xb364ae1f,0x31a831a8,0xae1fb364
.long 0x3400,0xb400,0x3400,0xb400,0xb4008000,0x3364ae1f,0xb1a831a8,0x2e1fb364
.long 0xb400,0x31a831a8,0xb4008000,0x31a8b1a8,0x34000000,0xae1f3364,0xb1a8b1a8,0x3364ae1f
.long 0x3400,0xb4008000,0xb400,0x34000000,0xb4008000,0xae1fb364,0x31a8b1a8,0x33642e1f
.long 0xb400,0x31a8b1a8,0x34000000,0x31a831a8,0x34000000,0x33642e1f,0x31a831a8,0x2e1f3364
.long 0x34000000,0x34000000,0x34000000,0x34000000,0x34000000,0x33642e1f,0x31a831a8,0x2e1f3364
.long 0x34000000,0x31a831a8,0x3400,0xb1a831a8,0x34000000,0x2e1f3364,0xb1a831a8,0xb364ae1f
.long 0x34000000,0x3400,0xb4000000,0x8000b400,0x34000000,0xae1f3364,0xb1a8b1a8,0x3364ae1f
.long 0x34000000,0xb1a831a8,0x8000b400,0x31a831a8,0x34000000,0xb3642e1f,0x31a8b1a8,0xae1f3364
.long 0x34000000,0xb4000000,0x34000000,0xb4000000,0x34000000,0xb364ae1f,0x31a831a8,0xae1fb364
.long 0x34000000,0xb1a8b1a8,0x3400,0x31a8b1a8,0x34000000,0xae1fb364,0xb1a831a8,0x33642e1f
.long 0x34000000,0x8000b400,0xb4000000,0x3400,0x34000000,0x2e1fb364,0xb1a8b1a8,0xb3642e1f
.long 0x34000000,0x31a8b1a8,0x8000b400,0xb1a8b1a8,0x34000000,0x3364ae1f,0x31a8b1a8,0x2e1fb364
.long 0x34000000,0x34000000,0x34000000,0x34000000,0x3400,0xae1f3364,0xb1a831a8,0xb3642e1f
.long 0xb4000000,0xb1a8b1a8,0x8000b400,0x31a8b1a8,0x8000b400,0x3364ae1f,0x31a831a8,0xae1f3364
.long 0x34000000,0x3400,0xb4000000,0x8000b400,0x3400,0xb364ae1f,0x31a8b1a8,0x2e1f3364
.long 0xb4000000,0x31a8b1a8,0x3400,0xb1a8b1a8,0x8000b400,0x2e1f3364,0xb1a8b1a8,0x33642e1f
.long 0x34000000,0xb4000000,0x34000000,0xb4000000,0x3400,0x2e1fb364,0xb1a831a8,0x3364ae1f
.long 0xb4000000,0x31a831a8,0x8000b400,0xb1a831a8,0x8000b400,0xb3642e1f,0x31a831a8,0x2e1fb364
.long 0x34000000,0x8000b400,0xb4000000,0x3400,0x3400,0x33642e1f,0x31a8b1a8,0xae1fb364
.long 0xb4000000,0xb1a831a8,0x3400,0x31a831a8,0x8000b400,0xae1fb364,0xb1a8b1a8,0xb364ae1f
.long 0xb4000000,0xb4000000,0xb4000000,0xb4000000,0x34000000,0x3364ae1f,0x31a8b1a8,0x2e1fb364
.long 0xb4000000,0xb1a831a8,0x80003400,0x31a831a8,0x34000000,0x2e1fb364,0xb1a8b1a8,0xb3642e1f
.long 0xb4000000,0x80003400,0x34000000,0xb400,0x34000000,0xae1fb364,0xb1a831a8,0x33642e1f
.long 0xb4000000,0x31a831a8,0xb400,0xb1a831a8,0x34000000,0xb364ae1f,0x31a831a8,0xae1fb364
.long 0xb4000000,0x34000000,0xb4000000,0x34000000,0x34000000,0xb3642e1f,0x31a8b1a8,0xae1f3364
.long 0xb4000000,0x31a8b1a8,0x80003400,0xb1a8b1a8,0x34000000,0xae1f3364,0xb1a8b1a8,0x3364ae1f
.long 0xb4000000,0xb400,0x34000000,0x80003400,0x34000000,0x2e1f3364,0xb1a831a8,0xb364ae1f
.long 0xb4000000,0xb1a8b1a8,0xb400,0x31a8b1a8,0x34000000,0x33642e1f,0x31a831a8,0x2e1f3364
.long 0xb4000000,0xb4000000,0xb4000000,0xb4000000,0xb400,0xae1fb364,0xb1a8b1a8,0xb364ae1f
.long 0x34000000,0x31a8b1a8,0xb400,0xb1a8b1a8,0x80003400,0x33642e1f,0x31a8b1a8,0xae1fb364
.long 0xb4000000,0x80003400,0x34000000,0xb400,0xb400,0xb3642e1f,0x31a831a8,0x2e1fb364
.long 0x34000000,0xb1a8b1a8,0x80003400,0x31a8b1a8,0x80003400,0x2e1fb364,0xb1a831a8,0x3364ae1f
.long 0xb4000000,0x34000000,0xb4000000,0x34000000,0xb400,0x2e1f3364,0xb1a8b1a8,0x33642e1f
.long 0x34000000,0xb1a831a8,0xb400,0x31a831a8,0x80003400,0xb364ae1f,0x31a8b1a8,0x2e1f3364
.long 0xb4000000,0xb400,0x34000000,0x80003400,0xb400,0x3364ae1f,0x31a831a8,0xae1f3364
.long 0x34000000,0x31a831a8,0x80003400,0xb1a831a8,0x80003400,0xae1f3364,0xb1a831a8,0xb3642e1f
.long 0x3e2aaaab,0x3e2aaaab,0x3e2aaaab,0x3e2aaaab,0x3e2aaaab,0x3e2aa811,0x3e2aa045,0x3e2a9346
.long 0x3e2aaaab,0x3e2aa045,0x3e2a8115,0x3e2a4d1f,0x3e2aaaab,0x3e2a9346,0x3e2a4d1f,0x3e29d849
.long 0x3e2aaaab,0x3e2a8115,0x3e2a0469,0x3e2934e3,0x3e2aaaab,0x3e2a69b3,0x3e29a6fc,0x3e28631b
.long 0x3e2aaaab,0x3e2a4d1f,0x3e2934e3,0x3e27632a,0x3e2aaaab,0x3e2a2b5c,0x3e28ae2c,0x3e263556
.long 0x3e2aaaab,0x3e2a0469,0x3e2812e8,0x3e24d9f1,0x3e2aaaab,0x3e29d849,0x3e27632a,0x3e23515c
.long 0x3e2aaaab,0x3e29a6fc,0x3e269f06,0x3e219c02,0x3e2aaaab,0x3e297084,0x3e25c695,0x3e1fba5b
.long 0x3e2aaaab,0x3e2934e3,0x3e24d9f1,0x3e1dacea,0x3e2aaaab,0x3e28f41a,0x3e23d938,0x3e1b743f
.long 0x3e2aaaab,0x3e28ae2c,0x3e22c488,0x3e1910f8,0x3e2aaaab,0x3e28631b,0x3e219c02,0x3e1683ba
.long 0x3e2aaaab,0x3e2aaaab,0x3e2aaaab,0x3e2aaaab,0x3e2a8115,0x3e2a69b3,0x3e2a4d1f,0x3e2a2b5c
.long 0x3e2a0469,0x3e29a6fc,0x3e2934e3,0x3e28ae2c,0x3e2934e3,0x3e28631b,0x3e27632a,0x3e263556
.long 0x3e2812e8,0x3e269f06,0x3e24d9f1,0x3e22c488,0x3e269f06,0x3e245c16,0x3e219c02,0x3e1e60e4
.long 0x3e24d9f1,0x3e219c02,0x3e1dacea,0x3e1910f8,0x3e22c488,0x3e1e60e4,0x3e1910f8,0x3e12dcaf
.long 0x3e205fcc,0x3e1aad31,0x3e13cd3a,0x3e0bcd4d,0x3e1dacea,0x3e1683ba,0x3e0de776,0x3e03ed58
.long 0x3e1aad31,0x3e11e7ab,0x3e076623,0x3df69120,0x3e176218,0x3e0cdc87,0x3e005062,0x3de3d7b7
.long 0x3e13cd3a,0x3e076623,0x3df15bef,0x3dcfca63,0x3e0ff056,0x3e0188a9,0x3de10e84,0x3dba870e
.long 0x3e0bcd4d,0x3df69120,0x3dcfca63,0x3da42d71,0x3e076623,0x3de95535,0x3dbda278,0x3d8cdee4
.long 0x3e2aaaab,0x3e2aaaab,0x3e2aaaab,0x3e2aaaab,0x3e2a0469,0x3e29d849,0x3e29a6fc,0x3e297084
.long 0x3e2812e8,0x3e27632a,0x3e269f06,0x3e25c695,0x3e24d9f1,0x3e23515c,0x3e219c02,0x3e1fba5b
.long 0x3e205fcc,0x3e1dacea,0x3e1aad31,0x3e176218,0x3e1aad31,0x3e1683ba,0x3e11e7ab,0x3e0cdc87
.long 0x3e13cd3a,0x3e0de776,0x3e076623,0x3e005062,0x3e0bcd4d,0x3e03ed58,0x3df69120,0x3de3d7b7
.long 0x3e02bcfe,0x3df15bef,0x3ddb67a3,0x3dc3c7e0,0x3df15bef,0x3dd88a22,0x3dbda278,0x3da0e747
.long 0x3ddb67a3,0x3dbda278,0x3d9d9c36,0x3d776ca3,0x3dc3c7e0,0x3da0e747,0x3d776ca3,0x3d297bd8
.long 0x3daaaaab,0x3d829f63,0x3d30afe8,0x3cb23636,0x3d9040f2,0x3d462aed,0x3ccfb2fa,0x3aee4a78
.long 0x3d697c5a,0x3d052e81,0x3bee3853,0xbc94a3bb,0x3d30afe8,0x3c85d379,0xbc32981a,0xbd1b0474
.long 0x3e2aaaab,0x3e2aaaab,0x3e2aaaab,0x3e2aaaab,0x3e2934e3,0x3e28f41a,0x3e28ae2c,0x3e28631b
.long 0x3e24d9f1,0x3e23d938,0x3e22c488,0x3e219c02,0x3e1dacea,0x3e1b743f,0x3e1910f8,0x3e1683ba
.long 0x3e13cd3a,0x3e0ff056,0x3e0bcd4d,0x3e076623,0x3e076623,0x3e0188a9,0x3df69120,0x3de95535
.long 0x3df15bef,0x3de10e84,0x3dcfca63,0x3dbda278,0x3dcfca63,0x3dba870e,0x3da42d71,0x3d8cdee4
.long 0x3daaaaab,0x3d9040f2,0x3d697c5a,0x3d30afe8,0x3d829f63,0x3d462aed,0x3d052e81,0x3c85d379
.long 0x3d30afe8,0x3ccfb2fa,0x3bee3853,0xbc32981a,0x3cb23636,0x3aee4a78,0xbc94a3bb,0xbd1b0474
.long 0x233c4197,0xbcb23636,0xbd30afe8,0xbd829f63,0xbcb23636,0xbd37de96,0xbd89788b,0xbdb43f46
.long 0xbd30afe8,0xbd89788b,0xbdb765f5,0xbde10e84,0xbd829f63,0xbdb43f46,0xbde10e84,0xbe03ed58
.long 0x0,0x0,0x0,0x0,0x0,0x3aee4a78,0x3b6e46d7,0x3bb2b098
.long 0x0,0x3b6e46d7,0x3bee3853,0x3c32981a,0x0,0x3bb2b098,0x3c32981a,0x3c85d379
.long 0x0,0x3bee3853,0x3c6dfe48,0x3cb23636,0x0,0x3c14dc66,0x3c94a3bb,0x3cde6818
.long 0x0,0x3c32981a,0x3cb23636,0x3d052e81,0x0,0x3c504e5d,0x3ccfb2fa,0x3d1b0474
.long 0x0,0x3c6dfe48,0x3ced1670,0x3d30afe8,0x0,0x3c85d379,0x3d052e81,0x3d462aed
.long 0x0,0x3c94a3bb,0x3d13c190,0x3d5b6f9e,0x0,0x3ca36f76,0x3d22429f,0x3d707828
.long 0x0,0x3cb23636,0x3d30afe8,0x3d829f63,0x0,0x3cc0f788,0x3d3f07aa,0x3d8cdee4
.long 0x0,0x3ccfb2fa,0x3d4d4826,0x3d96f7c7,0x0,0x3cde6818,0x3d5b6f9e,0x3da0e747
.long 0x0,0x0,0x0,0x0,0x3bee3853,0x3c14dc66,0x3c32981a,0x3c504e5d
.long 0x3c6dfe48,0x3c94a3bb,0x3cb23636,0x3ccfb2fa,0x3cb23636,0x3cde6818,0x3d052e81,0x3d1b0474
.long 0x3ced1670,0x3d13c190,0x3d30afe8,0x3d4d4826,0x3d13c190,0x3d37de96,0x3d5b6f9e,0x3d7e5995
.long 0x3d30afe8,0x3d5b6f9e,0x3d829f63,0x3d96f7c7,0x3d4d4826,0x3d7e5995,0x3d96f7c7,0x3dade188
.long 0x3d697c5a,0x3d9040f2,0x3daaaaab,0x3dc3c7e0,0x3d829f63,0x3da0e747,0x3dbda278,0x3dd88a22
.long 0x3d9040f2,0x3db11319,0x3dcfca63,0x3dec0955,0x3d9d9c36,0x3dc0b81b,0x3de10e84,0x3dfe2864
.long 0x3daaaaab,0x3dcfca63,0x3df15bef,0x3e076623,0x3db765f5,0x3dde3e76,0x3e005062,0x3e0eee13
.long 0x3dc3c7e0,0x3dec0955,0x3e076623,0x3e15a0c7,0x3dcfca63,0x3df9207f,0x3e0de776,0x3e1b743f
.long 0x0,0x0,0x0,0x0,0x3c6dfe48,0x3c85d379,0x3c94a3bb,0x3ca36f76
.long 0x3ced1670,0x3d052e81,0x3d13c190,0x3d22429f,0x3d30afe8,0x3d462aed,0x3d5b6f9e,0x3d707828
.long 0x3d697c5a,0x3d829f63,0x3d9040f2,0x3d9d9c36,0x3d9040f2,0x3da0e747,0x3db11319,0x3dc0b81b
.long 0x3daaaaab,0x3dbda278,0x3dcfca63,0x3de10e84,0x3dc3c7e0,0x3dd88a22,0x3dec0955,0x3dfe2864
.long 0x3ddb67a3,0x3df15bef,0x3e02bcfe,0x3e0bcd4d,0x3df15bef,0x3e03ed58,0x3e0de776,0x3e1683ba
.long 0x3e02bcfe,0x3e0de776,0x3e176218,0x3e1f100c,0x3e0bcd4d,0x3e1683ba,0x3e1f100c,0x3e2552c8
.long 0x3e13cd3a,0x3e1dacea,0x3e24d9f1,0x3e2934e3,0x3e1aad31,0x3e23515c,0x3e28ae2c,0x3e2aa811
.long 0x3e205fcc,0x3e27632a,0x3e2a8115,0x3e29a6fc,0x3e24d9f1,0x3e29d849,0x3e2a4d1f,0x3e263556
.long 0x0,0x0,0x0,0x0,0x3cb23636,0x3cc0f788,0x3ccfb2fa,0x3cde6818
.long 0x3d30afe8,0x3d3f07aa,0x3d4d4826,0x3d5b6f9e,0x3d829f63,0x3d8cdee4,0x3d96f7c7,0x3da0e747
.long 0x3daaaaab,0x3db765f5,0x3dc3c7e0,0x3dcfca63,0x3dcfca63,0x3dde3e76,0x3dec0955,0x3df9207f
.long 0x3df15bef,0x3e005062,0x3e076623,0x3e0de776,0x3e076623,0x3e0eee13,0x3e15a0c7,0x3e1b743f
.long 0x3e13cd3a,0x3e1aad31,0x3e205fcc,0x3e24d9f1,0x3e1dacea,0x3e23515c,0x3e27632a,0x3e29d849
.long 0x3e24d9f1,0x3e28ae2c,0x3e2a8115,0x3e2a4d1f,0x3e2934e3,0x3e2aa811,0x3e29a6fc,0x3e263556
.long 0x3e2aaaab,0x3e2934e3,0x3e24d9f1,0x3e1dacea,0x3e2934e3,0x3e245c16,0x3e1c3692,0x3e10ee36
.long 0x3e24d9f1,0x3e1c3692,0x3e0ff056,0x3e005062,0x3e1dacea,0x3e10ee36,0x3e005062,0x3dd88a22
.long 0x3e2aaaab,0x3e2aaaab,0x3e2aaaab,0x0,0x3e2812e8,0x3e27bd97,0x3e27632a,0x0
.long 0x3e205fcc,0x3e1f100c,0x3e1dacea,0x0,0x3e13cd3a,0x3e10ee36,0x3e0de776,0x0
.long 0x3e02bcfe,0x3dfba847,0x3df15bef,0x0,0x3ddb67a3,0x3dccd306,0x3dbda278,0x0
.long 0x3daaaaab,0x3d96f7c7,0x3d829f63,0x0,0x3d697c5a,0x3d37de96,0x3d052e81,0x0
.long 0x3ced1670,0x3c6dfe48,0x233c4197,0x0,0x233c4197,0xbc85d379,0xbd052e81,0x0
.long 0xbced1670,0xbd3f07aa,0xbd829f63,0x0,0xbd697c5a,0xbd9a4c58,0xbdbda278,0x0
.long 0xbdaaaaab,0xbdcfca63,0xbdf15bef,0x0,0xbddb67a3,0xbdfe2864,0xbe0de776,0x0
.long 0xbe02bcfe,0xbe11e7ab,0xbe1dacea,0x0,0xbe13cd3a,0xbe1fba5b,0xbe27632a,0x0
.long 0x0,0x0,0x0,0x0,0x0,0x0,0x0,0x0
.long 0x0,0x0,0x0,0x0,0x0,0x0,0x0,0x0
.long 0x0,0x0,0x0,0x0,0x0,0x0,0x0,0x0
.long 0x0,0x0,0x0,0x0,0x0,0x0,0x0,0x0
.long 0x0,0x0,0x0,0x0,0x0,0x0,0x0,0x0
.long 0x0,0x0,0x0,0x0,0x0,0x0,0x0,0x0
.long 0x0,0x0,0x0,0x0,0x0,0x0,0x0,0x0
.long 0x0,0x0,0x0,0x0,0x0,0x0,0x0,0x0
.long 0x0,0x0,0x0,0x0,0x0,0x0,0x0,0x0
.long 0x0,0x0,0x0,0x0,0x0,0x0,0x0,0x0
.long 0x0,0x0,0x0,0x0,0x0,0x0,0x0,0x0
.long 0x0,0x0,0x0,0x0,0x0,0x0,0x0,0x0
.long 0x0,0x0,0x0,0x0,0x0,0x0,0x0,0x0
.long 0x0,0x0,0x0,0x0,0x0,0x0,0x0,0x0
.long 0x0,0x0,0x0,0x0,0x0,0x0,0x0,0x0
.long 0x0,0x0,0x0,0x0,0x0,0x0,0x0,0x0
.long 0x0,0x0,0x0,0x0,0x0,0x0,0x0,0x0
.long 0x0,0x0,0x0,0x0,0x0,0x0,0x0,0x0
.long 0x0,0x0,0x0,0x0,0x0,0x0,0x0,0x0
.long 0x0,0x0,0x0,0x0,0x0,0x0,0x0,0x0
.long 0x0,0x0,0x0,0x0,0x0,0x0,0x0,0x0
.long 0x0,0x0,0x0,0x0,0x0,0x0,0x0,0x0
.long 0x0,0x0,0x0,0x0,0x0,0x0,0x0,0x0
.long 0x0,0x0,0x0,0x0,0x0,0x0,0x0,0x0
.long 0x0,0x0,0x0,0x0,0x3ced1670,0x3cfbbd8f,0x3d052e81,0x0
.long 0x3d697c5a,0x3d776ca3,0x3d829f63,0x0,0x3daaaaab,0x3db43f46,0x3dbda278,0x0
.long 0x3ddb67a3,0x3de699f9,0x3df15bef,0x0,0x3e02bcfe,0x3e088633,0x3e0de776,0x0
.long 0x3e13cd3a,0x3e1910f8,0x3e1dacea,0x0,0x3e205fcc,0x3e245c16,0x3e27632a,0x0
.long 0x3e2812e8,0x3e2a0469,0x3e2aaaab,0x0,0x3e2aaaab,0x3e29d849,0x3e27632a,0x0
.long 0x3e2812e8,0x3e23d938,0x3e1dacea,0x0,0x3e205fcc,0x3e183bda,0x3e0de776,0x0
.long 0x3e13cd3a,0x3e076623,0x3df15bef,0x0,0x3e02bcfe,0x3de3d7b7,0x3dbda278,0x0
.long 0x3ddb67a3,0x3db11319,0x3d829f63,0x0,0x3daaaaab,0x3d707828,0x3d052e81,0x0
.long 0x0,0x0,0x0,0x0,0x0,0x0,0x0,0x0
.long 0x0,0x0,0x0,0x0,0x0,0x0,0x0,0x0
.long 0x0,0x0,0x0,0x0,0x0,0x0,0x0,0x0
.long 0x0,0x0,0x0,0x0,0x0,0x0,0x0,0x0
.long 0x0,0x0,0x0,0x0,0x0,0x0,0x0,0x0
.long 0x0,0x0,0x0,0x0,0x0,0x0,0x0,0x0
.long 0x0,0x0,0x0,0x0,0x0,0x0,0x0,0x0
.long 0x0,0x0,0x0,0x0,0x0,0x0,0x0,0x0
.long 0x0,0x0,0x0,0x0,0x0,0x0,0x0,0x0
.long 0x0,0x0,0x0,0x0,0x0,0x0,0x0,0x0
.long 0x0,0x0,0x0,0x0,0x0,0x0,0x0,0x0
.long 0x0,0x0,0x0,0x0,0x0,0x0,0x0,0x0
.long 0x0,0x0,0x0,0x0,0x0,0x0,0x0,0x0
.long 0x0,0x0,0x0,0x0,0x0,0x0,0x0,0x0
.long 0x0,0x0,0x0,0x0,0x0,0x0,0x0,0x0
.long 0x0,0x0,0x0,0x0,0x0,0x0,0x0,0x0
.long 0x0,0x0,0x0,0x0,0x0,0x0,0x0,0x0
.long 0x0,0x0,0x0,0x0,0x0,0x0,0x0,0x0
.long 0x0,0x0,0x0,0x0,0x0,0x0,0x0,0x0
.long 0x0,0x0,0x0,0x0,0x0,0x0,0x0,0x0
.long 0x0,0x0,0x0,0x0,0x0,0x0,0x0,0x0
.long 0x0,0x0,0x0,0x0,0x0,0x0,0x0,0x0
.long 0x0,0x0,0x0,0x0,0x0,0x0,0x0,0x0
.long 0x0,0x0,0x0,0x0,0x0,0x0,0x0,0x0
.long 0x80003c00,0x80004000,0x80004000,0x80004000,0x80003c00,0xb58f3fe1,0xb9793f84,0xbc003eee
.long 0x80003c00,0xb9793f84,0xbd243e21,0xbeee3c00,0x80003c00,0xbc003eee,0xbeee3c00,0xc0000000
.long 0x80003c00,0xbd243e21,0xbfe1358f,0xbeeebc00,0x80003c00,0xbe213d24,0xbfe1b58f,0xbc00beee
.long 0x80003c00,0xbeee3c00,0xbeeebc00,0x8000c000,0x80003c00,0xbf843979,0xbd24be21,0x3c00beee
.long 0x80003c00,0xbfe1358f,0xb979bf84,0x3eeebc00,0x80003c00,0xc0000000,0x8000c000,0x40008000
.long 0x80003c00,0xbfe1b58f,0x3979bf84,0x3eee3c00,0x80003c00,0xbf84b979,0x3d24be21,0x3c003eee
.long 0x80003c00,0xbeeebc00,0x3eeebc00,0x80004000,0x80003c00,0xbe21bd24,0x3fe1b58f,0xbc003eee
.long 0x80003c00,0xbd24be21,0x3fe1358f,0xbeee3c00,0x80003c00,0xbc00beee,0x3eee3c00,0xc0000000
.long 0x80004000,0x80004000,0x80004000,0x80004000,0xbd243e21,0xbe213d24,0xbeee3c00,0xbf843979
.long 0xbfe1358f,0xbfe1b58f,0xbeeebc00,0xbd24be21,0xbeeebc00,0xbc00beee,0x8000c000,0x3c00beee
.long 0xb979bf84,0x3979bf84,0x3eeebc00,0x3fe1358f,0x3979bf84,0x3f84b979,0x3eee3c00,0x358f3fe1
.long 0x3eeebc00,0x3eee3c00,0x80004000,0xbeee3c00,0x3fe1358f,0x358f3fe1,0xbeee3c00,0xbe21bd24
.long 0x3d243e21,0xbd243e21,0xbeeebc00,0x3979bf84,0x80004000,0xc0000000,0x8000c000,0x40008000
.long 0xbd243e21,0xbd24be21,0x3eeebc00,0x39793f84,0xbfe1358f,0x358fbfe1,0x3eee3c00,0xbe213d24
.long 0xbeeebc00,0x3eeebc00,0x80004000,0xbeeebc00,0xb979bf84,0x3f843979,0xbeee3c00,0x358fbfe1
.long 0x3979bf84,0x39793f84,0xbeeebc00,0x3fe1b58f,0x3eeebc00,0xbc003eee,0x8000c000,0x3c003eee
.long 0x80004000,0x80004000,0x80004000,0x80004000,0xbfe1358f,0xc0000000,0xbfe1b58f,0xbf84b979
.long 0xb979bf84,0x8000c000,0x3979bf84,0x3d24be21,0x3eeebc00,0x40008000,0x3eee3c00,0x3c003eee
.long 0x3d243e21,0x80004000,0xbd243e21,0xbfe1358f,0xbd243e21,0xc0000000,0xbd24be21,0x358fbfe1
.long 0xbeeebc00,0x8000c000,0x3eeebc00,0x3eee3c00,0x3979bf84,0x40008000,0x39793f84,0xbe213d24
.long 0x3fe1358f,0x80004000,0xbfe1358f,0xb979bf84,0x80004000,0xc0000000,0x8000c000,0x40008000
.long 0xbfe1358f,0x8000c000,0x3fe1358f,0xb9793f84,0xb979bf84,0x40008000,0xb9793f84,0xbe21bd24
.long 0x3eeebc00,0x80004000,0xbeeebc00,0x3eeebc00,0x3d243e21,0xc0000000,0x3d24be21,0x358f3fe1
.long 0xbd243e21,0x8000c000,0x3d243e21,0xbfe1b58f,0xbeeebc00,0x40008000,0xbeee3c00,0x3c00beee
.long 0x80004000,0x80004000,0x80004000,0x80004000,0xbeeebc00,0xbe21bd24,0xbd24be21,0xbc00beee
.long 0x3eeebc00,0x3fe1b58f,0x3fe1358f,0x3eee3c00,0x80004000,0xbc003eee,0xbeee3c00,0xc0000000
.long 0xbeeebc00,0xb979bf84,0x3979bf84,0x3eeebc00,0x3eeebc00,0x3f843979,0x39793f84,0xbc003eee
.long 0x80004000,0xbeee3c00,0xbeeebc00,0x8000c000,0xbeeebc00,0x358fbfe1,0x3fe1b58f,0x3c003eee
.long 0x3eeebc00,0x3d243e21,0xbd243e21,0xbeeebc00,0x80004000,0xc0000000,0x8000c000,0x40008000
.long 0xbeeebc00,0x3d24be21,0x3d243e21,0xbeee3c00,0x3eeebc00,0x358f3fe1,0xbfe1b58f,0x3c00beee
.long 0x80004000,0xbeeebc00,0x3eeebc00,0x80004000,0xbeeebc00,0x3f84b979,0xb9793f84,0xbc00beee
.long 0x3eeebc00,0xb9793f84,0xb979bf84,0x3eee3c00,0x80004000,0xbc00beee,0x3eee3c00,0xc0000000
.long 0x80004000,0x80004000,0x80003c00,0x80000000,0xb979bf84,0xb58fbfe1,0x8000bc00,0x8000
.long 0x3d243e21,0x39793f84,0x80003c00,0x80000000,0xbeeebc00,0xbc00beee,0x8000bc00,0x8000
.long 0x3fe1358f,0x3d243e21,0x80003c00,0x80000000,0xbfe1358f,0xbe21bd24,0x8000bc00,0x8000
.long 0x3eeebc00,0x3eee3c00,0x80003c00,0x80000000,0xbd243e21,0xbf84b979,0x8000bc00,0x8000
.long 0x3979bf84,0x3fe1358f,0x80003c00,0x80000000,0x80004000,0xc0000000,0x8000bc00,0x8000
.long 0xb979bf84,0x3fe1b58f,0x80003c00,0x80008000,0x3d243e21,0xbf843979,0x8000bc00,0x0
.long 0xbeeebc00,0x3eeebc00,0x80003c00,0x80008000,0x3fe1358f,0xbe213d24,0x8000bc00,0x0
.long 0xbfe1358f,0x3d24be21,0x80003c00,0x80008000,0x3eeebc00,0xbc003eee,0x8000bc00,0x0
.long 0x80000000,0x80000000,0x80000000,0x80000000,0x8000,0x8000,0x8000,0x8000
.long 0x80000000,0x80000000,0x80000000,0x80008000,0x8000,0x8000,0x0,0x0
.long 0x80000000,0x80008000,0x80008000,0x8000,0x0,0x0,0x80000000,0x80000000
.long 0x80008000,0x80008000,0x8000,0x0,0x0,0x80000000,0x80008000,0x80008000
.long 0x80008000,0x8000,0x0,0x80000000,0x80000000,0x80000000,0x80008000,0x8000
.long 0x8000,0x0,0x80000000,0x80008000,0x80000000,0x80008000,0x8000,0x80000000
.long 0x8000,0x80000000,0x80008000,0x8000,0x80000000,0x8000,0x0,0x80008000
.long 0x0,0x80000000,0x8000,0x0,0x80008000,0x8000,0x80000000,0x8000
.long 0x80000000,0x80000000,0x80000000,0x80000000,0x8000,0x8000,0x8000,0x8000
.long 0x80008000,0x80008000,0x80008000,0x80008000,0x80000000,0x80000000,0x80000000,0x80000000
.long 0x8000,0x0,0x0,0x80000000,0x80008000,0x80008000,0x8000,0x8000
.long 0x80000000,0x80000000,0x80008000,0x80008000,0x8000,0x0,0x80000000,0x80000000
.long 0x80008000,0x8000,0x0,0x80000000,0x80000000,0x80000000,0x80008000,0x8000
.long 0x8000,0x0,0x80000000,0x80008000,0x80008000,0x8000,0x0,0x80000000
.long 0x80000000,0x80008000,0x8000,0x80000000,0x8000,0x80000000,0x80008000,0x8000
.long 0x80008000,0x8000,0x80000000,0x80008000,0x80000000,0x80008000,0x0,0x80000000
.long 0x80000000,0x80000000,0x80000000,0x80000000,0x0,0x0,0x0,0x0
.long 0x8000,0x8000,0x8000,0x8000,0x80008000,0x80008000,0x80008000,0x8000
.long 0x80000000,0x80000000,0x80008000,0x80008000,0x0,0x80000000,0x80000000,0x80008000
.long 0x8000,0x0,0x80000000,0x80000000,0x80008000,0x8000,0x0,0x80000000
.long 0x80000000,0x80008000,0x8000,0x0,0x80000000,0x80000000,0x80008000,0x8000
.long 0x0,0x80000000,0x80008000,0x8000,0x8000,0x0,0x80000000,0x80008000
.long 0x80008000,0x8000,0x80000000,0x80008000,0x80000000,0x80008000,0x0,0x80000000
.long 0x0,0x80008000,0x8000,0x80000000,0x8000,0x80000000,0x80008000,0x0
.long 0x80003c00,0xb979bf84,0x3d243e21,0xbeeebc00,0x80003c00,0xb58fbfe1,0x39793f84,0xbc00beee
.long 0x80003c00,0x8000c000,0x80004000,0x8000c000,0x80003c00,0x358fbfe1,0xb9793f84,0x3c00beee
.long 0x80003c00,0x3979bf84,0xbd243e21,0x3eeebc00,0x80003c00,0x3c00beee,0xbeee3c00,0x40008000
.long 0x80003c00,0x3d24be21,0xbfe1358f,0x3eee3c00,0x80003c00,0x3e21bd24,0xbfe1b58f,0x3c003eee
.long 0x80003c00,0x3eeebc00,0xbeeebc00,0x80004000,0x80003c00,0x3f84b979,0xbd24be21,0xbc003eee
.long 0x80003c00,0x3fe1b58f,0xb979bf84,0xbeee3c00,0x80003c00,0x40008000,0x8000c000,0xc0000000
.long 0x80003c00,0x3fe1358f,0x3979bf84,0xbeeebc00,0x80003c00,0x3f843979,0x3d24be21,0xbc00beee
.long 0x80003c00,0x3eee3c00,0x3eeebc00,0x8000c000,0x80003c00,0x3e213d24,0x3fe1b58f,0x3c00beee
.long 0x3fe1358f,0xbfe1358f,0x3eeebc00,0xbd243e21,0x3d243e21,0xbe21bd24,0x3eee3c00,0xbf84b979
.long 0x80004000,0x8000c000,0x80004000,0x8000c000,0xbd243e21,0x3e21bd24,0xbeee3c00,0x3f84b979
.long 0xbfe1358f,0x3fe1358f,0xbeeebc00,0x3d243e21,0xbeeebc00,0x3c003eee,0x8000c000,0xbc003eee
.long 0xb979bf84,0xb9793f84,0x3eeebc00,0xbfe1b58f,0x3979bf84,0xbf843979,0x3eee3c00,0xb58fbfe1
.long 0x3eeebc00,0xbeeebc00,0x80004000,0x3eeebc00,0x3fe1358f,0xb58fbfe1,0xbeee3c00,0x3e213d24
.long 0x3d243e21,0x3d24be21,0xbeeebc00,0xb9793f84,0x80004000,0x40008000,0x8000c000,0xc0000000
.long 0xbd243e21,0x3d243e21,0x3eeebc00,0xb979bf84,0xbfe1358f,0xb58f3fe1,0x3eee3c00,0x3e21bd24
.long 0xbeeebc00,0xbeee3c00,0x80004000,0x3eee3c00,0xb979bf84,0xbf84b979,0xbeee3c00,0xb58f3fe1
.long 0x3979bf84,0x80004000,0xb979bf84,0x3d243e21,0x3fe1358f,0xc0000000,0x3fe1b58f,0xbf843979
.long 0x80004000,0x8000c000,0x80004000,0x8000c000,0xbfe1358f,0x40008000,0xbfe1b58f,0x3f843979
.long 0xb979bf84,0x80004000,0x3979bf84,0xbd243e21,0x3eeebc00,0xc0000000,0x3eee3c00,0xbc00beee
.long 0x3d243e21,0x8000c000,0xbd243e21,0x3fe1b58f,0xbd243e21,0x40008000,0xbd24be21,0xb58f3fe1
.long 0xbeeebc00,0x80004000,0x3eeebc00,0xbeeebc00,0x3979bf84,0xc0000000,0x39793f84,0x3e21bd24
.long 0x3fe1358f,0x8000c000,0xbfe1358f,0x39793f84,0x80004000,0x40008000,0x8000c000,0xc0000000
.long 0xbfe1358f,0x80004000,0x3fe1358f,0x3979bf84,0xb979bf84,0xc0000000,0xb9793f84,0x3e213d24
.long 0x3eeebc00,0x8000c000,0xbeeebc00,0xbeee3c00,0x3d243e21,0x40008000,0x3d24be21,0xb58fbfe1
.long 0xbeeebc00,0x3fe1358f,0xbfe1358f,0x3eeebc00,0x3eeebc00,0xbe213d24,0x3d24be21,0xbc003eee
.long 0x80004000,0x8000c000,0x80004000,0x8000c000,0xbeeebc00,0x3e213d24,0xbd24be21,0x3c003eee
.long 0x3eeebc00,0xbfe1358f,0x3fe1358f,0xbeeebc00,0x80004000,0x3c00beee,0xbeee3c00,0x40008000
.long 0xbeeebc00,0x39793f84,0x3979bf84,0xbeee3c00,0x3eeebc00,0xbf84b979,0x39793f84,0x3c00beee
.long 0x80004000,0x3eeebc00,0xbeeebc00,0x80004000,0xbeeebc00,0xb58f3fe1,0x3fe1b58f,0xbc00beee
.long 0x3eeebc00,0xbd24be21,0xbd243e21,0x3eee3c00,0x80004000,0x40008000,0x8000c000,0xc0000000
.long 0xbeeebc00,0xbd243e21,0x3d243e21,0x3eeebc00,0x3eeebc00,0xb58fbfe1,0xbfe1b58f,0xbc003eee
.long 0x80004000,0x3eee3c00,0x3eeebc00,0x8000c000,0xbeeebc00,0xbf843979,0xb9793f84,0x3c003eee
.long 0xbd243e21,0x3979bf84,0x80003c00,0x80008000,0x3979bf84,0xb58f3fe1,0x8000bc00,0x0
.long 0x80004000,0x8000c000,0x80003c00,0x80008000,0xb979bf84,0x358f3fe1,0x8000bc00,0x80000000
.long 0x3d243e21,0xb979bf84,0x80003c00,0x8000,0xbeeebc00,0x3c003eee,0x8000bc00,0x80000000
.long 0x3fe1358f,0xbd24be21,0x80003c00,0x8000,0xbfe1358f,0x3e213d24,0x8000bc00,0x80000000
.long 0x3eeebc00,0xbeeebc00,0x80003c00,0x8000,0xbd243e21,0x3f843979,0x8000bc00,0x80000000
.long 0x3979bf84,0xbfe1b58f,0x80003c00,0x8000,0x80004000,0x40008000,0x8000bc00,0x80000000
.long 0xb979bf84,0xbfe1358f,0x80003c00,0x0,0x3d243e21,0x3f84b979,0x8000bc00,0x80008000
.long 0xbeeebc00,0xbeee3c00,0x80003c00,0x0,0x3fe1358f,0x3e21bd24,0x8000bc00,0x80008000
.long 0x0,0x80008000,0x0,0x80000000,0x80008000,0x0,0x80008000,0x0
.long 0x80000000,0x80008000,0x80000000,0x80008000,0x8000,0x80000000,0x8000,0x80000000
.long 0x80000000,0x8000,0x80000000,0x0,0x8000,0x80000000,0x0,0x80008000
.long 0x80000000,0x0,0x80008000,0x80000000,0x0,0x80008000,0x80000000,0x8000
.long 0x80008000,0x80000000,0x8000,0x80008000,0x0,0x8000,0x80008000,0x0
.long 0x80008000,0x80000000,0x0,0x8000,0x80000000,0x8000,0x80008000,0x80000000
.long 0x8000,0x80008000,0x80000000,0x0,0x80000000,0x0,0x8000,0x8000
.long 0x8000,0x80008000,0x80008000,0x80000000,0x80000000,0x80000000,0x0,0x0
.long 0x8000,0x80000000,0x8000,0x80000000,0x80008000,0x0,0x80008000,0x8000
.long 0x80000000,0x80008000,0x80000000,0x80008000,0x8000,0x80000000,0x8000,0x80000000
.long 0x80008000,0x0,0x80008000,0x80000000,0x80000000,0x8000,0x80000000,0x8000
.long 0x8000,0x80008000,0x0,0x80008000,0x80008000,0x0,0x8000,0x80000000
.long 0x80000000,0x8000,0x80008000,0x80000000,0x8000,0x80008000,0x80000000,0x8000
.long 0x80008000,0x80000000,0x0,0x80008000,0x80000000,0x8000,0x80008000,0x80000000
.long 0x8000,0x80008000,0x80000000,0x80000000,0x80008000,0x80000000,0x0,0x8000
.long 0x80000000,0x0,0x8000,0x80008000,0x8000,0x8000,0x80008000,0x80000000
.long 0x80008000,0x0,0x80008000,0x0,0x80000000,0x8000,0x80000000,0x8000
.long 0x80000000,0x80008000,0x80000000,0x80008000,0x0,0x80008000,0x0,0x80008000
.long 0x8000,0x80000000,0x8000,0x80000000,0x80008000,0x0,0x80008000,0x80000000
.long 0x80000000,0x8000,0x80008000,0x0,0x0,0x8000,0x80000000,0x0
.long 0x8000,0x80008000,0x80000000,0x8000,0x80008000,0x80000000,0x0,0x8000
.long 0x80000000,0x0,0x8000,0x80008000,0x80000000,0x8000,0x80008000,0x80000000
.long 0x0,0x8000,0x80008000,0x80000000,0x8000,0x80008000,0x80000000,0x0
.long 0x80008000,0x80000000,0x80000000,0x0,0x80000000,0x0,0x0,0x8000
.long 0x80003c00,0x3d243e21,0x3fe1358f,0x3eeebc00,0x80003c00,0x3c003eee,0x3eee3c00,0x40008000
.long 0x80003c00,0x39793f84,0x3d243e21,0x3eee3c00,0x80003c00,0x358f3fe1,0x39793f84,0x3c003eee
.long 0x80000000,0x80000000,0x80000000,0x80000000,0x80000000,0x80000000,0x80000000,0x80000000
.long 0x80000000,0x80000000,0x80000000,0x80000000,0x80000000,0x80000000,0x80000000,0x80000000
.long 0x80000000,0x80000000,0x80000000,0x80008000,0x80000000,0x80000000,0x80008000,0x80008000
.long 0x80000000,0x80000000,0x80008000,0x80008000,0x80000000,0x80000000,0x80008000,0x8000
.long 0x80000000,0x80000000,0x80008000,0x8000,0x80000000,0x80000000,0x80008000,0x8000
.long 0x80000000,0x80008000,0x8000,0x0,0x80000000,0x80008000,0x8000,0x0
.long 0x3979bf84,0xb979bf84,0xbeeebc00,0xbfe1358f,0x3eeebc00,0x3c00beee,0x8000c000,0xbc00beee
.long 0x3fe1358f,0x3fe1b58f,0x3eeebc00,0x3d24be21,0x3d243e21,0x3e213d24,0x3eee3c00,0x3f843979
.long 0x80000000,0x80000000,0x80000000,0x80000000,0x80000000,0x80000000,0x80000000,0x80000000
.long 0x80000000,0x80008000,0x80008000,0x80008000,0x80008000,0x80008000,0x80008000,0x8000
.long 0x80008000,0x8000,0x8000,0x0,0x8000,0x8000,0x0,0x0
.long 0x8000,0x0,0x80000000,0x80000000,0x0,0x0,0x80000000,0x80008000
.long 0x0,0x80000000,0x80008000,0x8000,0x80000000,0x80000000,0x80008000,0x8000
.long 0x80000000,0x80008000,0x8000,0x0,0x80000000,0x8000,0x0,0x80000000
.long 0xbd243e21,0x80004000,0x3d243e21,0x3fe1358f,0xbeeebc00,0xc0000000,0xbeee3c00,0xbc003eee
.long 0x3979bf84,0x8000c000,0xb979bf84,0xbd24be21,0x3fe1358f,0x40008000,0x3fe1b58f,0x3f84b979
.long 0x80000000,0x80000000,0x80000000,0x80000000,0x80000000,0x80000000,0x80008000,0x80008000
.long 0x80008000,0x80008000,0x8000,0x8000,0x8000,0x8000,0x0,0x0
.long 0x0,0x80000000,0x80000000,0x80000000,0x80000000,0x80000000,0x80008000,0x8000
.long 0x80008000,0x80008000,0x8000,0x0,0x8000,0x8000,0x0,0x80000000
.long 0x0,0x80000000,0x80000000,0x80008000,0x80000000,0x80000000,0x80008000,0x8000
.long 0x80000000,0x80008000,0x0,0x80000000,0x80008000,0x8000,0x80000000,0x80008000
.long 0x3eeebc00,0x3979bf84,0xb979bf84,0xbeeebc00,0x80004000,0x3c003eee,0x3eee3c00,0x40008000
.long 0xbeeebc00,0xbfe1b58f,0xbfe1358f,0xbeee3c00,0x3eeebc00,0x3e21bd24,0x3d24be21,0x3c00beee
.long 0x80000000,0x80000000,0x80000000,0x80000000,0x80008000,0x80008000,0x80008000,0x80008000
.long 0x8000,0x8000,0x0,0x0,0x80000000,0x80000000,0x80000000,0x80000000
.long 0x80008000,0x80008000,0x8000,0x8000,0x8000,0x0,0x0,0x80000000
.long 0x80000000,0x80000000,0x80008000,0x80008000,0x80008000,0x8000,0x8000,0x0
.long 0x8000,0x0,0x80000000,0x80008000,0x80000000,0x80000000,0x80008000,0x8000
.long 0x80008000,0x8000,0x0,0x80000000,0x8000,0x0,0x80008000,0x8000
.long 0xbfe1358f,0xbd243e21,0x80003c00,0x0,0x3eeebc00,0x3c00beee,0x8000bc00,0x80008000
.long 0xbd243e21,0xb9793f84,0x80003c00,0x0,0x3979bf84,0x358fbfe1,0x8000bc00,0x80008000
.long 0x80000000,0x80000000,0x80000000,0x80000000,0x80008000,0x80008000,0x80008000,0x8000
.long 0x0,0x0,0x80000000,0x80000000,0x80008000,0x80008000,0x80008000,0x8000
.long 0x0,0x0,0x80000000,0x80000000,0x80000000,0x80008000,0x80008000,0x8000
.long 0x8000,0x0,0x80000000,0x80000000,0x80000000,0x80008000,0x80008000,0x8000
.long 0x8000,0x0,0x80000000,0x80000000,0x80000000,0x80000000,0x80008000,0x8000
.long 0x80008000,0x8000,0x80000000,0x80008000,0x0,0x80000000,0x80008000,0x0
.long 0x0,0x8000,0x8000,0x80008000,0x80008000,0x80000000,0x80000000,0x80000000
.long 0x0,0x0,0x0,0x8000,0x80008000,0x80008000,0x80008000,0x80008000
.long 0x80000000,0x80000000,0x80000000,0x80000000,0x8000,0x8000,0x8000,0x8000
.long 0x80000000,0x80000000,0x80000000,0x80008000,0x8000,0x8000,0x0,0x0
.long 0x80000000,0x80008000,0x80008000,0x8000,0x0,0x0,0x80000000,0x80000000
.long 0x80008000,0x80008000,0x8000,0x0,0x0,0x80000000,0x80008000,0x80008000
.long 0x80008000,0x8000,0x0,0x80000000,0x80000000,0x80000000,0x80008000,0x8000
.long 0x8000,0x0,0x80000000,0x80008000,0x80000000,0x80008000,0x8000,0x80000000
.long 0x80008000,0x80000000,0x80000000,0x80000000,0x80000000,0x0,0x0,0x8000
.long 0x8000,0x8000,0x8000,0x80008000,0x80008000,0x80008000,0x80008000,0x80000000
.long 0x80000000,0x80000000,0x80000000,0x80000000,0x8000,0x8000,0x8000,0x8000
.long 0x80008000,0x80008000,0x80008000,0x80008000,0x80000000,0x80000000,0x80000000,0x80000000
.long 0x8000,0x0,0x0,0x80000000,0x80008000,0x80008000,0x8000,0x8000
.long 0x80000000,0x80000000,0x80008000,0x80008000,0x8000,0x0,0x80000000,0x80000000
.long 0x80008000,0x8000,0x0,0x80000000,0x80000000,0x80000000,0x80008000,0x8000
.long 0x8000,0x0,0x80000000,0x80008000,0x80008000,0x8000,0x0,0x80000000
.long 0x0,0x0,0x8000,0x8000,0x8000,0x8000,0x80008000,0x80008000
.long 0x80008000,0x80008000,0x80008000,0x80008000,0x80000000,0x80000000,0x80000000,0x80000000
.long 0x80000000,0x80000000,0x80000000,0x80000000,0x0,0x0,0x0,0x0
.long 0x8000,0x8000,0x8000,0x8000,0x80008000,0x80008000,0x80008000,0x8000
.long 0x80000000,0x80000000,0x80008000,0x80008000,0x0,0x80000000,0x80000000,0x80008000
.long 0x8000,0x0,0x80000000,0x80000000,0x80008000,0x8000,0x0,0x80000000
.long 0x80000000,0x80008000,0x8000,0x0,0x80000000,0x80000000,0x80008000,0x8000
.long 0x0,0x80000000,0x80008000,0x8000,0x8000,0x0,0x80000000,0x80008000
.long 0x0,0x90,0x120,0x1b0,0x4,0x94,0x124,0x1b4
.long 0x8,0x98,0x128,0x1b8,0xc,0x9c,0x12c,0x1bc
.long 0x10,0xa0,0x130,0x1c0,0x14,0xa4,0x134,0x1c4
.long 0x18,0xa8,0x138,0x1c8,0x1c,0xac,0x13c,0x1cc
.long 0x20,0xb0,0x140,0x1d0,0x24,0xb4,0x144,0x1d4
.long 0x28,0xb8,0x148,0x1d8,0x2c,0xbc,0x14c,0x1dc
.long 0x30,0xc0,0x150,0x1e0,0x34,0xc4,0x154,0x1e4
.long 0x38,0xc8,0x158,0x1e8,0x3c,0xcc,0x15c,0x1ec
.long 0x240,0x2d0,0x360,0x3f0,0x244,0x2d4,0x364,0x3f4
.long 0x248,0x2d8,0x368,0x3f8,0x24c,0x2dc,0x36c,0x3fc
.long 0x250,0x2e0,0x370,0x400,0x254,0x2e4,0x374,0x404
.long 0x258,0x2e8,0x378,0x408,0x25c,0x2ec,0x37c,0x40c
.long 0x260,0x2f0,0x380,0x410,0x264,0x2f4,0x384,0x414
.long 0x268,0x2f8,0x388,0x418,0x26c,0x2fc,0x38c,0x41c
.long 0x270,0x300,0x390,0x420,0x274,0x304,0x394,0x424
.long 0x278,0x308,0x398,0x428,0x27c,0x30c,0x39c,0x42c
.long 0x480,0x3f0,0x360,0x2d0,0x47c,0x3ec,0x35c,0x2cc
.long 0x478,0x3e8,0x358,0x2c8,0x474,0x3e4,0x354,0x2c4
.long 0x470,0x3e0,0x350,0x2c0,0x46c,0x3dc,0x34c,0x2bc
.long 0x468,0x3d8,0x348,0x2b8,0x464,0x3d4,0x344,0x2b4
.long 0x460,0x3d0,0x340,0x2b0,0x45c,0x3cc,0x33c,0x2ac
.long 0x458,0x3c8,0x338,0x2a8,0x454,0x3c4,0x334,0x2a4
.long 0x450,0x3c0,0x330,0x2a0,0x44c,0x3bc,0x32c,0x29c
.long 0x448,0x3b8,0x328,0x298,0x444,0x3b4,0x324,0x294
.long 0x240,0x1b0,0x120,0x90,0x23c,0x1ac,0x11c,0x8c
.long 0x238,0x1a8,0x118,0x88,0x234,0x1a4,0x114,0x84
.long 0x230,0x1a0,0x110,0x80,0x22c,0x19c,0x10c,0x7c
.long 0x228,0x198,0x108,0x78,0x224,0x194,0x104,0x74
.long 0x220,0x190,0x100,0x70,0x21c,0x18c,0xfc,0x6c
.long 0x218,0x188,0xf8,0x68,0x214,0x184,0xf4,0x64
.long 0x210,0x180,0xf0,0x60,0x20c,0x17c,0xec,0x5c
.long 0x208,0x178,0xe8,0x58,0x204,0x174,0xe4,0x54
.long 0x40,0xd0,0x160,0x1f0,0x44,0xd4,0x164,0x1f4
.long 0x48,0xd8,0x168,0x1f8,0x0,0x0,0x0,0x0
.long 0x0,0x0,0x0,0x0,0x0,0x0,0x0,0x0
.long 0x0,0x0,0x0,0x0,0x0,0x0,0x0,0x0
.long 0x0,0x0,0x0,0x0,0x0,0x0,0x0,0x0
.long 0x0,0x0,0x0,0x0,0x0,0x0,0x0,0x0
.long 0x0,0x0,0x0,0x0,0x0,0x0,0x0,0x0
.long 0x0,0x0,0x0,0x0,0x0,0x0,0x0,0x0
.long 0x280,0x310,0x3a0,0x430,0x284,0x314,0x3a4,0x434
.long 0x288,0x318,0x3a8,0x438,0x0,0x0,0x0,0x0
.long 0x0,0x0,0x0,0x0,0x0,0x0,0x0,0x0
.long 0x0,0x0,0x0,0x0,0x0,0x0,0x0,0x0
.long 0x0,0x0,0x0,0x0,0x0,0x0,0x0,0x0
.long 0x0,0x0,0x0,0x0,0x0,0x0,0x0,0x0
.long 0x0,0x0,0x0,0x0,0x0,0x0,0x0,0x0
.long 0x0,0x0,0x0,0x0,0x0,0x0,0x0,0x0
.long 0x440,0x3b0,0x320,0x290,0x43c,0x3ac,0x31c,0x28c
.long 0x438,0x3a8,0x318,0x288,0x0,0x0,0x0,0x0
.long 0x0,0x0,0x0,0x0,0x0,0x0,0x0,0x0
.long 0x0,0x0,0x0,0x0,0x0,0x0,0x0,0x0
.long 0x0,0x0,0x0,0x0,0x0,0x0,0x0,0x0
.long 0x0,0x0,0x0,0x0,0x0,0x0,0x0,0x0
.long 0x0,0x0,0x0,0x0,0x0,0x0,0x0,0x0
.long 0x0,0x0,0x0,0x0,0x0,0x0,0x0,0x0
.long 0x200,0x170,0xe0,0x50,0x1fc,0x16c,0xdc,0x4c
.long 0x1f8,0x168,0xd8,0x48,0x0,0x0,0x0,0x0
.long 0x0,0x0,0x0,0x0,0x0,0x0,0x0,0x0
.long 0x0,0x0,0x0,0x0,0x0,0x0,0x0,0x0
.long 0x0,0x0,0x0,0x0,0x0,0x0,0x0,0x0
.long 0x0,0x0,0x0,0x0,0x0,0x0,0x0,0x0
.long 0x0,0x0,0x0,0x0,0x0,0x0,0x0,0x0
.long 0x0,0x0,0x0,0x0,0x0,0x0,0x0,0x0
.long 0x3eb504f3,0x80000000,0x3eb504f3,0x80000000,0x3eb504f3,0x80000000,0x3eb504f3,0x80000000
.long 0x3eb504f3,0x80000000,0x3eb504f3,0x80000000,0x3eb504f3,0x80000000,0x3eb504f3,0x80000000
.long 0x3eb504f3,0x80000000,0x3eb504bb,0xba8e2c0a,0x3eb50414,0xbb0e2bde,0x3eb502fd,0xbb554160
.long 0x3eb50176,0xbb8e2b2f,0x3eb4ff7f,0xbbb1b556,0x3eb4fd19,0xbbd53f10,0x3eb4fa44,0xbbf8c846
.long 0x3eb504f3,0x80000000,0x3eb50414,0xbb0e2bde,0x3eb50176,0xbb8e2b2f,0x3eb4fd19,0xbbd53f10
.long 0x3eb4f6fe,0xbc0e2871,0x3eb4ef25,0xbc31affc,0x3eb4e58c,0xbc5535d0,0x3eb4da36,0xbc78b996
.long 0x3eb504f3,0x80000000,0x3eb502fd,0xbb554160,0x3eb4fd19,0xbbd53f10,0x3eb4f349,0xbc1fec68
.long 0x3eb4e58c,0xbc5535d0,0x3eb4d3e3,0xbc853d4c,0x3eb4be4f,0xbc9fdccd,0x3eb4a4ce,0xbcba78d6
.long 0x3eb504f3,0x80000000,0x3eb50176,0xbb8e2b2f,0x3eb4f6fe,0xbc0e2871,0x3eb4e58c,0xbc5535d0
.long 0x3eb4cd21,0xbc8e1d7b,0x3eb4adbe,0xbcb19a94,0x3eb48763,0xbcd510d4,0x3eb45a13,0xbcf87edd
.long 0x3eb504f3,0x80000000,0x3eb4ff7f,0xbbb1b556,0x3eb4ef25,0xbc31affc,0x3eb4d3e3,0xbc853d4c
.long 0x3eb4adbe,0xbcb19a94,0x3eb47cb6,0xbcdded29,0x3eb440cf,0xbd051930,0x3eb3fa0c,0xbd1b33c7
.long 0x3eb504f3,0x80000000,0x3eb4fd19,0xbbd53f10,0x3eb4e58c,0xbc5535d0,0x3eb4be4f,0xbc9fdccd
.long 0x3eb48763,0xbcd510d4,0x3eb440cf,0xbd051930,0x3eb3ea98,0xbd1f9e6a,0x3eb384c6,0xbd3a15cc
.long 0x3eb504f3,0x80000000,0x3eb4fa44,0xbbf8c846,0x3eb4da36,0xbc78b996,0x3eb4a4ce,0xbcba78d6
.long 0x3eb45a13,0xbcf87edd,0x3eb3fa0c,0xbd1b33c7,0x3eb384c6,0xbd3a15cc,0x3eb2fa4d,0xbd58e1d9
.long 0x3eb504f3,0x80000000,0x3eb4f6fe,0xbc0e2871,0x3eb4cd21,0xbc8e1d7b,0x3eb48763,0xbcd510d4
.long 0x3eb425ce,0xbd0df1a9,0x3eb3a872,0xbd314504,0x3eb30f61,0xbd547d09,0x3eb25ab4,0xbd77944a
.long 0x3eb504f3,0x80000000,0x3eb4f349,0xbc1fec68,0x3eb4be4f,0xbc9fdccd,0x3eb4660e,0xbcefa433
.long 0x3eb3ea98,0xbd1f9e6a,0x3eb34c05,0xbd474b94,0x3eb28a74,0xbd6ed1d8,0x3eb1a60b,0xbd8b14c1
.long 0x3eb504f3,0x80000000,0x3eb4ef25,0xbc31affc,0x3eb4adbe,0xbcb19a94,0x3eb440cf,0xbd051930
.long 0x3eb3a872,0xbd314504,0x3eb2e4cb,0xbd5d4622,0x3eb1f60b,0xbd8488f8,0x3eb0dc6a,0xbd9a4ef0
.long 0x3eb504f3,0x80000000,0x3eb4ea90,0xbc437322,0x3eb49b6f,0xbcc356a5,0x3eb417a7,0xbd125d63
.long 0x3eb35f5f,0xbd42e4c8,0x3eb272cb,0xbd73335c,0x3eb15232,0xbd919d85,0x3eaffde6,0xbda976e8
.long 0x3eb504f3,0x80000000,0x3eb4e58c,0xbc5535d0,0x3eb48763,0xbcd510d4,0x3eb3ea98,0xbd1f9e6a
.long 0x3eb30f61,0xbd547d09,0x3eb1f60b,0xbd8488f8,0x3eb09ef7,0xbd9ea570,0x3eaf0a9c,0xbdb88ade
.long 0x3eb504f3,0x80000000,0x3eb4e019,0xbc66f7fb,0x3eb4719a,0xbce6c8f5,0x3eb3b9a2,0xbd2cdbfb
.long 0x3eb2b87c,0xbd660d19,0x3eb16e92,0xbd8f7046,0x3eafdc6a,0xbdab9f99,0x3eae02a7,0xbdc7890a
.long 0x3eb504f3,0x80000000,0x3eb4da36,0xbc78b996,0x3eb45a13,0xbcf87edd,0x3eb384c6,0xbd3a15cc
.long 0x3eb25ab4,0xbd77944a,0x3eb0dc6a,0xbd9a4ef0,0x3eaf0a9c,0xbdb88ade,0x3eace626,0xbdd66fa7
.long 0x3eb504f3,0x80000000,0x3eb4d3e3,0xbc853d4c,0x3eb440cf,0xbd051930,0x3eb34c05,0xbd474b94
.long 0x3eb1f60b,0xbd8488f8,0x3eb03f99,0xbda5244f,0x3eae299f,0xbdc56621,0x3eabb53c,0xbde53cf3
.long 0x3eb504f3,0x80000000,0x3eb4cd21,0xbc8e1d7b,0x3eb425ce,0xbd0df1a9,0x3eb30f61,0xbd547d09
.long 0x3eb18a86,0xbd8d42af,0x3eaf982b,0xbdafefbb,0x3ead3986,0xbdd23045,0x3eaa700c,0xbdf3ef2f
.long 0x3eb504f3,0x80000000,0x3eb4c5f0,0xbc96fd53,0x3eb40911,0xbd16c8c3,0x3eb2cedb,0xbd61a9e3
.long 0x3eb11828,0xbd95f6f4,0x3eaee62a,0xbdbab08e,0x3eac3a67,0xbddee82e,0x3ea916bc,0xbe01424f
.long 0x3eb504f3,0x80000000,0x3eb4be4f,0xbc9fdccd,0x3eb3ea98,0xbd1f9e6a,0x3eb28a74,0xbd6ed1d8
.long 0x3eb09ef7,0xbd9ea570,0x3eae299f,0xbdc56621,0x3eab2c57,0xbdeb8cc0,0x3ea7a976,0xbe087dc3
.long 0x3eb504f3,0x80000000,0x3eb4b63e,0xbca8bbe5,0x3eb3ca63,0xbd287287,0x3eb2422e,0xbd7bf4a0
.long 0x3eb01ef6,0xbda74dcf,0x3ead6296,0xbdd00fd1,0x3eaa0f6f,0xbdf81ce5,0x3ea62865,0xbe0fa91b
.long 0x3eb504f3,0x80000000,0x3eb4adbe,0xbcb19a94,0x3eb3a872,0xbd314504,0x3eb1f60b,0xbd8488f8
.long 0x3eaf982b,0xbdafefbb,0x3eac911c,0xbddaacf8,0x3ea8e3c6,0xbe024bc1,0x3ea493b5,0xbe16c37c
.long 0x3eb504f3,0x80000000,0x3eb4a4ce,0xbcba78d6,0x3eb384c6,0xbd3a15cc,0x3eb1a60b,0xbd8b14c1
.long 0x3eaf0a9c,0xbdb88ade,0x3eabb53c,0xbde53cf3,0x3ea7a976,0xbe087dc3,0x3ea2eb97,0xbe1dcc10
.long 0x3eb504f3,0x80000000,0x3eb49b6f,0xbcc356a5,0x3eb35f5f,0xbd42e4c8,0x3eb15232,0xbd919d85
.long 0x3eae764c,0xbdc11ee4,0x3eaacf04,0xbdefbf20,0x3ea6609c,0xbe0ea3ee,0x3ea1303d,0xbe24c203
.long 0x3eb504f3,0x80000000,0x3eb491a1,0xbccc33fc,0x3eb3383d,0xbd4bb1e4,0x3eb0fa7f,0xbd982321
.long 0x3eaddb43,0xbdc9ab78,0x3ea9de83,0xbdfa32da,0x3ea50953,0xbe14bdba,0x3e9f61dc,0xbe2ba482
.long 0x3eb504f3,0x80000000,0x3eb48763,0xbcd510d4,0x3eb30f61,0xbd547d09,0x3eb09ef7,0xbd9ea570
.long 0x3ead3986,0xbdd23045,0x3ea8e3c6,0xbe024bc1,0x3ea3a3b9,0xbe1aca9e,0x3e9d80a8,0xbe3272be
.long 0x3eb504f3,0x80000000,0x3eb47cb6,0xbcdded29,0x3eb2e4cb,0xbd5d4622,0x3eb03f99,0xbda5244f
.long 0x3eac911c,0xbddaacf8,0x3ea7dedc,0xbe07763c,0x3ea22fed,0xbe20ca16,0x3e9b8cdd,0xbe392be8
.long 0x3eb504f3,0x80000000,0x3eb4719a,0xbce6c8f5,0x3eb2b87c,0xbd660d19,0x3eafdc6a,0xbdab9f99
.long 0x3eabe20a,0xbde3213d,0x3ea6cfd6,0xbe0c988f,0x3ea0ae10,0xbe26bb9a,0x3e9986b4,0xbe3fcf35
.long 0x3eb504f3,0x80000000,0x3eb4660e,0xbcefa433,0x3eb28a74,0xbd6ed1d8,0x3eaf756a,0xbdb2172a
.long 0x3eab2c57,0xbdeb8cc0,0x3ea5b6c3,0xbe11b268,0x3e9f1e43,0xbe2c9ea9,0x3e976e6b,0xbe465bdd
.long 0x3eb504f3,0x80000000,0x3eb45a13,0xbcf87edd,0x3eb25ab4,0xbd77944a,0x3eaf0a9c,0xbdb88ade
.long 0x3eaa700c,0xbdf3ef2f,0x3ea493b5,0xbe16c37c,0x3e9d80a8,0xbe3272be,0x3e954440,0xbe4cd119
.long 0x3eb504f3,0x80000000,0x3eb44da8,0xbd00ac77,0x3eb2293b,0xbd802a2d,0x3eae9c02,0xbdbefa92
.long 0x3ea9ad2e,0xbdfc4836,0x3ea366bd,0xbe1bcb7a,0x3e9bd564,0xbe383758,0x3e930877,0xbe532e27
.long 0x3eb504f3,0x80000000,0x3eb440cf,0xbd051930,0x3eb1f60b,0xbd8488f8,0x3eae299f,0xbdc56621
.long 0x3ea8e3c6,0xbe024bc1,0x3ea22fed,0xbe20ca16,0x3e9a1c9c,0xbe3debf8,0x3e90bb51,0xbe597247
.long 0x3eb504f3,0x80000000,0x3eb43386,0xbd098597,0x3eb1c123,0xbd88e67c,0x3eadb375,0xbdcbcd69
.long 0x3ea813db,0xbe066e62,0x3ea0ef58,0xbe25bf02,0x3e985675,0xbe43901e,0x3e8e5d15,0xbe5f9cba
.long 0x3eb504f3,0x80000000,0x3eb425ce,0xbd0df1a9,0x3eb18a86,0xbd8d42af,0x3ead3986,0xbdd23045
.long 0x3ea73d75,0xbe0a8bd4,0x3e9fa512,0xbe2aa9f2,0x3e968317,0xbe49234e,0x3e8bee0a,0xbe65acc6
.long 0x3eb504f3,0x80000000,0x3eb417a7,0xbd125d63,0x3eb15232,0xbd919d85,0x3eacbbd6,0xbdd88e93
.long 0x3ea6609c,0xbe0ea3ee,0x3e9e512d,0xbe2f8a9a,0x3e94a2ac,0xbe4ea50b,0x3e896e7a,0xbe6ba1b5
.long 0x3eb504f3,0x80000000,0x3eb40911,0xbd16c8c3,0x3eb11828,0xbd95f6f4,0x3eac3a67,0xbddee82e
.long 0x3ea57d59,0xbe12b689,0x3e9cf3bf,0xbe3460b0,0x3e92b55b,0xbe5414dc,0x3e86deb0,0xbe717ad2
.long 0x3eb504f3,0x80000000,0x3eb3fa0c,0xbd1b33c7,0x3eb0dc6a,0xbd9a4ef0,0x3eabb53c,0xbde53cf3
.long 0x3ea493b5,0xbe16c37c,0x3e9b8cdd,0xbe392be8,0x3e90bb51,0xbe597247,0x3e843ef9,0xbe77376c
.long 0x3eb504f3,0x80000000,0x3eb3ea98,0xbd1f9e6a,0x3eb09ef7,0xbd9ea570,0x3eab2c57,0xbdeb8cc0
.long 0x3ea3a3b9,0xbe1aca9e,0x3e9a1c9c,0xbe3debf8,0x3e8eb4b9,0xbe5ebcd5,0x3e818fa5,0xbe7cd6d6
.long 0x3eb504f3,0x80000000,0x3eb3dab5,0xbd2408ab,0x3eb05fd0,0xbda2fa69,0x3eaa9fbd,0xbdf1d772
.long 0x3ea2ad6e,0xbe1ecbc9,0x3e98a312,0xbe42a097,0x3e8ca1c0,0xbe63f411,0x3e7da20c,0xbe812c33
.long 0x3eb504f3,0x80000000,0x3eb3ca63,0xbd287287,0x3eb01ef6,0xbda74dcf,0x3eaa0f6f,0xbdf81ce5
.long 0x3ea1b0dd,0xbe22c6d5,0x3e972057,0xbe47497e,0x3e8a8294,0xbe691788,0x3e7806db,0xbe83ddbb
.long 0x3eb504f3,0x80000000,0x3eb3b9a2,0xbd2cdbfb,0x3eafdc6a,0xbdab9f99,0x3ea97b71,0xbdfe5cf6
.long 0x3ea0ae10,0xbe26bb9a,0x3e959481,0xbe4be663,0x3e885764,0xbe6e26c6,0x3e724e62,0xbe867fb2
.long 0x3eb504f3,0x80000000,0x3eb3a872,0xbd314504,0x3eaf982b,0xbdafefbb,0x3ea8e3c6,0xbe024bc1
.long 0x3e9fa512,0xbe2aa9f2,0x3e93ffa8,0xbe5076ff,0x3e862061,0xbe73215c,0x3e6c794d,0xbe8911c7
.long 0x3eb504f3,0x80000000,0x3eb396d3,0xbd35ada0,0x3eaf523c,0xbdb43e2b,0x3ea84871,0xbe056635
.long 0x3e9e95ec,0xbe2e91b5,0x3e9261e5,0xbe54fb0d,0x3e83ddbb,0xbe7806db,0x3e66884d,0xbe8b93ad
.long 0x3eb504f3,0x80000000,0x3eb384c6,0xbd3a15cc,0x3eaf0a9c,0xbdb88ade,0x3ea7a976,0xbe087dc3
.long 0x3e9d80a8,0xbe3272be,0x3e90bb51,0xbe597247,0x3e818fa5,0xbe7cd6d6,0x3e607c15,0xbe8e0519
.long 0x3eb504f3,0x80000000,0x3eb37249,0xbd3e7d85,0x3eaec14c,0xbdbcd5ca,0x3ea706d9,0xbe0b925c
.long 0x3e9c6553,0xbe364ce5,0x3e8f0c05,0xbe5ddc67,0x3e7e6ca5,0xbe80c872,0x3e5a555c,0xbe9065c0
.long 0x3eb504f3,0x80000000,0x3eb35f5f,0xbd42e4c8,0x3eae764c,0xbdc11ee4,0x3ea6609c,0xbe0ea3ee
.long 0x3e9b43f5,0xbe3a2005,0x3e8d541b,0xbe62392a,0x3e79a3ee,0xbe831a4c,0x3e5414dc,0xbe92b55b
.long 0x3eb504f3,0x80000000,0x3eb34c05,0xbd474b94,0x3eae299f,0xbdc56621,0x3ea5b6c3,0xbe11b268
.long 0x3e9a1c9c,0xbe3debf8,0x3e8b93ad,0xbe66884d,0x3e74c58e,0xbe8560c8,0x3e4dbb52,0xbe94f3a4
.long 0x3eb504f3,0x80000000,0x3eb3383d,0xbd4bb1e4,0x3eaddb43,0xbdc9ab78,0x3ea50953,0xbe14bdba
.long 0x3e98ef51,0xbe41b099,0x3e89cad7,0xbe6ac98c,0x3e6fd1f4,0xbe879bb1,0x3e47497e,0xbe972057
.long 0x3eb504f3,0x80000000,0x3eb32406,0xbd5017b7,0x3ead8b3b,0xbdcdeedd,0x3ea4584e,0xbe17c5d1
.long 0x3e97bc21,0xbe456dc2,0x3e87f9b5,0xbe6efca7,0x3e6ac98c,0xbe89cad7,0x3e40c022,0xbe993b32
.long 0x3eb504f3,0x80000000,0x3eb30f61,0xbd547d09,0x3ead3986,0xbdd23045,0x3ea3a3b9,0xbe1aca9e
.long 0x3e968317,0xbe49234e,0x3e862061,0xbe73215c,0x3e65acc6,0xbe8bee0a,0x3e3a2005,0xbe9b43f5
.long 0x3eb504f3,0x80000000,0x3eb2fa4d,0xbd58e1d9,0x3eace626,0xbdd66fa7,0x3ea2eb97,0xbe1dcc10
.long 0x3e954440,0xbe4cd119,0x3e843ef9,0xbe77376c,0x3e607c15,0xbe8e0519,0x3e3369ee,0xbe9d3a64
.long 0x3eb504f3,0x80000000,0x3eb2e4cb,0xbd5d4622,0x3eac911c,0xbddaacf8,0x3ea22fed,0xbe20ca16
.long 0x3e93ffa8,0xbe5076ff,0x3e82559a,0xbe7b3e98,0x3e5b37ea,0xbe900fd7,0x3e2c9ea9,0xbe9f1e43
.long 0x3eb504f3,0x80000000,0x3eb2cedb,0xbd61a9e3,0x3eac3a67,0xbddee82e,0x3ea170bf,0xbe23c49f
.long 0x3e92b55b,0xbe5414dc,0x3e806460,0xbe7f36a1,0x3e55e0bb,0xbe920e15,0x3e25bf02,0xbea0ef58
.long 0x3eb504f3,0x80000000,0x3eb2b87c,0xbd660d19,0x3eabe20a,0xbde3213d,0x3ea0ae10,0xbe26bb9a
.long 0x3e916566,0xbe57aa8b,0x3e7cd6d6,0xbe818fa5,0x3e5076ff,0xbe93ffa8,0x3e1ecbc9,0xbea2ad6e
.long 0x3eb504f3,0x80000000,0x3eb2a1af,0xbd6a6fc1,0x3eab8804,0xbde7581c,0x3e9fe7e5,0xbe29aef8
.long 0x3e900fd7,0xbe5b37ea,0x3e78d5b1,0xbe837c2c,0x3e4afb2e,0xbe95e465,0x3e17c5d1,0xbea4584e
.long 0x3eb504f3,0x80000000,0x3eb28a74,0xbd6ed1d8,0x3eab2c57,0xbdeb8cc0,0x3e9f1e43,0xbe2c9ea9
.long 0x3e8eb4b9,0xbe5ebcd5,0x3e74c58e,0xbe8560c8,0x3e456dc2,0xbe97bc21,0x3e10adee,0xbea5efc7
.long 0x3eb504f3,0x80000000,0x3eb272cb,0xbd73335c,0x3eaacf04,0xbdefbf20,0x3e9e512d,0xbe2f8a9a
.long 0x3e8d541b,0xbe62392a,0x3e70a6ad,0xbe873d5a,0x3e3fcf35,0xbe9986b4,0x3e0984f6,0xbea773a9
.long 0x3eb504f3,0x80000000,0x3eb25ab4,0xbd77944a,0x3eaa700c,0xbdf3ef2f,0x3e9d80a8,0xbe3272be
.long 0x3e8bee0a,0xbe65acc6,0x3e6c794d,0xbe8911c7,0x3e3a2005,0xbe9b43f5,0x3e024bc1,0xbea8e3c6
.long 0x3eb504f3,0x80000000,0x3eb2422e,0xbd7bf4a0,0x3eaa0f6f,0xbdf81ce5,0x3e9cacb9,0xbe355702
.long 0x3e8a8294,0xbe691788,0x3e683dae,0xbe8addf2,0x3e3460b0,0xbe9cf3bf,0x3df60656,0xbeaa3ff2
.long 0x3eb504f3,0x80000000,0x3eb2293b,0xbd802a2d,0x3ea9ad2e,0xbdfc4836,0x3e9bd564,0xbe383758
.long 0x3e8911c7,0xbe6c794d,0x3e63f411,0xbe8ca1c0,0x3e2e91b5,0xbe9e95ec,0x3de7581c,0xbeab8804
.long 0x3eb504f3,0x80000000,0x3eb20fda,0xbd8259bb,0x3ea9494b,0xbe00388c,0x3e9afaae,0xbe3b13af
.long 0x3e879bb1,0xbe6fd1f4,0x3e5f9cba,0xbe8e5d15,0x3e28b396,0xbea02a57,0x3dd88e93,0xbeacbbd6
.long 0x3eb504f3,0x80000000,0x3eb1f60b,0xbd8488f8,0x3ea8e3c6,0xbe024bc1,0x3e9a1c9c,0xbe3debf8
.long 0x3e862061,0xbe73215c,0x3e5b37ea,0xbe900fd7,0x3e22c6d5,0xbea1b0dd,0x3dc9ab78,0xbeaddb43
.long 0x3eb504f3,0x80000000,0x3eb1dbce,0xbd86b7e4,0x3ea87ca0,0xbe045db5,0x3e993b32,0xbe40c022
.long 0x3e849fe5,0xbe766765,0x3e56c5e5,0xbe91b9eb,0x3e1ccbf5,0xbea3295d,0x3dbab08e,0xbeaee62a
.long 0x3eb504f3,0x80000000,0x3eb1c123,0xbd88e67c,0x3ea813db,0xbe066e62,0x3e985675,0xbe43901e
.long 0x3e831a4c,0xbe79a3ee,0x3e5246f1,0xbe935b38,0x3e16c37c,0xbea493b5,0x3dab9f99,0xbeafdc6a
.long 0x3eb504f3,0x80000000,0x3eb1a60b,0xbd8b14c1,0x3ea7a976,0xbe087dc3,0x3e976e6b,0xbe465bdd
.long 0x3e818fa5,0xbe7cd6d6,0x3e4dbb52,0xbe94f3a4,0x3e10adee,0xbea5efc7,0x3d9c7a61,0xbeb0bde7
.long 0x3eb504f3,0x80000000,0x3eb18a86,0xbd8d42af,0x3ea73d75,0xbe0a8bd4,0x3e968317,0xbe49234e
.long 0x3e800000,0xbe800000,0x3e49234e,0xbe968317,0x3e0a8bd4,0xbea73d75,0x3d8d42af,0xbeb18a86
.long 0x3eb504f3,0x80000000,0x3eb16e92,0xbd8f7046,0x3ea6cfd6,0xbe0c988f,0x3e959481,0xbe4be663
.long 0x3e7cd6d6,0xbe818fa5,0x3e447f2d,0xbe98097a,0x3e045db5,0xbea87ca0,0x3d7bf4a0,0xbeb2422e
.long 0x3eb504f3,0x80000000,0x3eb15232,0xbd919d85,0x3ea6609c,0xbe0ea3ee,0x3e94a2ac,0xbe4ea50b
.long 0x3e79a3ee,0xbe831a4c,0x3e3fcf35,0xbe9986b4,0x3dfc4836,0xbea9ad2e,0x3d5d4622,0xbeb2e4cb
.long 0x3eb504f3,0x80000000,0x3eb13563,0xbd93ca6a,0x3ea5efc7,0xbe10adee,0x3e93ad9d,0xbe515f39
.long 0x3e766765,0xbe849fe5,0x3e3b13af,0xbe9afaae,0x3defbf20,0xbeaacf04,0x3d3e7d85,0xbeb37249
.long 0x3eb504f3,0x80000000,0x3eb11828,0xbd95f6f4,0x3ea57d59,0xbe12b689,0x3e92b55b,0xbe5414dc
.long 0x3e73215c,0xbe862061,0x3e364ce5,0xbe9c6553,0x3de3213d,0xbeabe20a,0x3d1f9e6a,0xbeb3ea98
.long 0x3eb504f3,0x80000000,0x3eb0fa7f,0xbd982321,0x3ea50953,0xbe14bdba,0x3e91b9eb,0xbe56c5e5
.long 0x3e6fd1f4,0xbe879bb1,0x3e317b1f,0xbe9dc68b,0x3dd66fa7,0xbeace626,0x3d00ac77,0xbeb44da8
.long 0x3eb504f3,0x80000000,0x3eb0dc6a,0xbd9a4ef0,0x3ea493b5,0xbe16c37c,0x3e90bb51,0xbe597247
.long 0x3e6c794d,0xbe8911c7,0x3e2c9ea9,0xbe9f1e43,0x3dc9ab78,0xbeaddb43,0x3cc356a5,0xbeb49b6f
.long 0x3eb504f3,0x80000000,0x3eb0bde7,0xbd9c7a61,0x3ea41c82,0xbe18c7c9,0x3e8fb994,0xbe5c19f1
.long 0x3e691788,0xbe8a8294,0x3e27b7cc,0xbea06c65,0x3dbcd5ca,0xbeaec14c,0x3c853d4c,0xbeb4d3e3
.long 0x3eb504f3,0x80000000,0x3eb09ef7,0xbd9ea570,0x3ea3a3b9,0xbe1aca9e,0x3e8eb4b9,0xbe5ebcd5
.long 0x3e65acc6,0xbe8bee0a,0x3e22c6d5,0xbea1b0dd,0x3dafefbb,0xbeaf982b,0x3c0e2871,0xbeb4f6fe
.long 0x3eb504f3,0x80000000,0x3eb07f9a,0xbda0d01e,0x3ea3295d,0xbe1ccbf5,0x3e8dacc6,0xbe615ae5
.long 0x3e62392a,0xbe8d541b,0x3e1dcc10,0xbea2eb97,0x3da2fa69,0xbeb05fd0,0x3a8e2c0a,0xbeb504bb
.long 0x3eb504f3,0x80000000,0x3eb05fd0,0xbda2fa69,0x3ea2ad6e,0xbe1ecbc9,0x3e8ca1c0,0xbe63f411
.long 0x3e5ebcd5,0xbe8eb4b9,0x3e18c7c9,0xbea41c82,0x3d95f6f4,0xbeb11828,0xbbd53f10,0xbeb4fd19
.long 0x3eb504f3,0x80000000,0x3eb03f99,0xbda5244f,0x3ea22fed,0xbe20ca16,0x3e8b93ad,0xbe66884d
.long 0x3e5b37ea,0xbe900fd7,0x3e13ba4f,0xbea54389,0x3d88e67c,0xbeb1c123,0xbc66f7fb,0xbeb4e019
.long 0x3eb504f3,0x80000000,0x3eb01ef6,0xbda74dcf,0x3ea1b0dd,0xbe22c6d5,0x3e8a8294,0xbe691788
.long 0x3e57aa8b,0xbe916566,0x3e0ea3ee,0xbea6609c,0x3d77944a,0xbeb25ab4,0xbcb19a94,0xbeb4adbe
.long 0x3eb504f3,0x80000000,0x3eaffde6,0xbda976e8,0x3ea1303d,0xbe24c203,0x3e896e7a,0xbe6ba1b5
.long 0x3e5414dc,0xbe92b55b,0x3e0984f6,0xbea773a9,0x3d5d4622,0xbeb2e4cb,0xbcefa433,0xbeb4660e
.long 0x3eb504f3,0x80000000,0x3eafdc6a,0xbdab9f99,0x3ea0ae10,0xbe26bb9a,0x3e885764,0xbe6e26c6
.long 0x3e5076ff,0xbe93ffa8,0x3e045db5,0xbea87ca0,0x3d42e4c8,0xbeb35f5f,0xbd16c8c3,0xbeb40911
.long 0x3eb504f3,0x80000000,0x3eafba81,0xbdadc7df,0x3ea02a57,0xbe28b396,0x3e873d5a,0xbe70a6ad
.long 0x3e4cd119,0xbe954440,0x3dfe5cf6,0xbea97b71,0x3d287287,0xbeb3ca63,0xbd35ada0,0xbeb396d3
.long 0x3eb504f3,0x80000000,0x3eaf982b,0xbdafefbb,0x3e9fa512,0xbe2aa9f2,0x3e862061,0xbe73215c
.long 0x3e49234e,0xbe968317,0x3df3ef2f,0xbeaa700c,0x3d0df1a9,0xbeb425ce,0xbd547d09,0xbeb30f61
.long 0x3eb504f3,0x80000000,0x3eaf756a,0xbdb2172a,0x3e9f1e43,0xbe2c9ea9,0x3e85007f,0xbe7596c5
.long 0x3e456dc2,0xbe97bc21,0x3de972b6,0xbeab5a63,0x3ce6c8f5,0xbeb4719a,0xbd73335c,0xbeb272cb
.long 0x3eb504f3,0x80000000,0x3eaf523c,0xbdb43e2b,0x3e9e95ec,0xbe2e91b5,0x3e83ddbb,0xbe7806db
.long 0x3e41b099,0xbe98ef51,0x3ddee82e,0xbeac3a67,0x3cb19a94,0xbeb4adbe,0xbd88e67c,0xbeb1c123
.long 0x3eb504f3,0x80000000,0x3eaf2ea2,0xbdb664bd,0x3e9e0c0d,0xbe308313,0x3e82b81b,0xbe7a7190
.long 0x3e3debf8,0xbe9a1c9c,0x3dd45038,0xbead100c,0x3c78b996,0xbeb4da36,0xbd982321,0xbeb0fa7f
.long 0x3eb504f3,0x80000000,0x3eaf0a9c,0xbdb88ade,0x3e9d80a8,0xbe3272be,0x3e818fa5,0xbe7cd6d6
.long 0x3e3a2005,0xbe9b43f5,0x3dc9ab78,0xbeaddb43,0x3c0e2871,0xbeb4f6fe,0xbda74dcf,0xbeb01ef6
.long 0x3eb504f3,0x80000000,0x3eaee62a,0xbdbab08e,0x3e9cf3bf,0xbe3460b0,0x3e806460,0xbe7f36a1
.long 0x3e364ce5,0xbe9c6553,0x3dbefa92,0xbeae9c02,0x3b0e2bde,0xbeb50414,0xbdb664bd,0xbeaf2ea2
.long 0x3eb504f3,0x80000000,0x3eaec14c,0xbdbcd5ca,0x3e9c6553,0xbe364ce5,0x3e7e6ca5,0xbe80c872
.long 0x3e3272be,0xbe9d80a8,0x3db43e2b,0xbeaf523c,0xbb8e2b2f,0xbeb50176,0xbdc56621,0xbeae299f
.long 0x3eb504f3,0x80000000,0x3eae9c02,0xbdbefa92,0x3e9bd564,0xbe383758,0x3e7c0b05,0xbe81f2c8
.long 0x3e2e91b5,0xbe9e95ec,0x3da976e8,0xbeaffde6,0xbc31affc,0xbeb4ef25,0xbdd45038,0xbead100c
.long 0x3eb504f3,0x80000000,0x3eae764c,0xbdc11ee4,0x3e9b43f5,0xbe3a2005,0x3e79a3ee,0xbe831a4c
.long 0x3e2aa9f2,0xbe9fa512,0x3d9ea570,0xbeb09ef7,0xbc8e1d7b,0xbeb4cd21,0xbde3213d,0xbeabe20a
.long 0x3eb504f3,0x80000000,0x3eae502b,0xbdc342bf,0x3e9ab107,0xbe3c06e6,0x3e77376c,0xbe843ef9
.long 0x3e26bb9a,0xbea0ae10,0x3d93ca6a,0xbeb13563,0xbcc356a5,0xbeb49b6f,0xbdf1d772,0xbeaa9fbd
.long 0x3eb504f3,0x80000000,0x3eae299f,0xbdc56621,0x3e9a1c9c,0xbe3debf8,0x3e74c58e,0xbe8560c8
.long 0x3e22c6d5,0xbea1b0dd,0x3d88e67c,0xbeb1c123,0xbcf87edd,0xbeb45a13,0xbe00388c,0xbea9494b
.long 0x3eb504f3,0x80000000,0x3eae02a7,0xbdc7890a,0x3e9986b4,0xbe3fcf35,0x3e724e62,0xbe867fb2
.long 0x3e1ecbc9,0xbea2ad6e,0x3d7bf4a0,0xbeb2422e,0xbd16c8c3,0xbeb40911,0xbe07763c,0xbea7dedc
.long 0x3eb504f3,0x80000000,0x3eaddb43,0xbdc9ab78,0x3e98ef51,0xbe41b099,0x3e6fd1f4,0xbe879bb1
.long 0x3e1aca9e,0xbea3a3b9,0x3d660d19,0xbeb2b87c,0xbd314504,0xbeb3a872,0xbe0ea3ee,0xbea6609c
.long 0x3eb504f3,0x80000000,0x3eadb375,0xbdcbcd69,0x3e985675,0xbe43901e,0x3e6d5053,0xbe88b4c0
.long 0x3e16c37c,0xbea493b5,0x3d5017b7,0xbeb32406,0xbd4bb1e4,0xbeb3383d,0xbe15c0c9,0xbea4ceb7
.long 0x3eb504f3,0x80000000,0x3ead8b3b,0xbdcdeedd,0x3e97bc21,0xbe456dc2,0x3e6ac98c,0xbe89cad7
.long 0x3e12b689,0xbea57d59,0x3d3a15cc,0xbeb384c6,0xbd660d19,0xbeb2b87c,0xbe1ccbf5,0xbea3295d
.long 0x3eb504f3,0x80000000,0x3ead6296,0xbdd00fd1,0x3e972057,0xbe47497e,0x3e683dae,0xbe8addf2
.long 0x3e0ea3ee,0xbea6609c,0x3d2408ab,0xbeb3dab5,0xbd802a2d,0xbeb2293b,0xbe23c49f,0xbea170bf
.long 0x3eb504f3,0x80000000,0x3ead3986,0xbdd23045,0x3e968317,0xbe49234e,0x3e65acc6,0xbe8bee0a
.long 0x3e0a8bd4,0xbea73d75,0x3d0df1a9,0xbeb425ce,0xbd8d42af,0xbeb18a86,0xbe2aa9f2,0xbe9fa512
.long 0x3eb504f3,0x80000000,0x3ead100c,0xbdd45038,0x3e95e465,0xbe4afb2e,0x3e6316e4,0xbe8cfb19
.long 0x3e066e62,0xbea813db,0x3cefa433,0xbeb4660e,0xbd9a4ef0,0xbeb0dc6a,0xbe317b1f,0xbe9dc68b
.long 0x3eb504f3,0x80000000,0x3eace626,0xbdd66fa7,0x3e954440,0xbe4cd119,0x3e607c15,0xbe8e0519
.long 0x3e024bc1,0xbea8e3c6,0x3cc356a5,0xbeb49b6f,0xbda74dcf,0xbeb01ef6,0xbe383758,0xbe9bd564
.long 0x3eb504f3,0x80000000,0x3eacbbd6,0xbdd88e93,0x3e94a2ac,0xbe4ea50b,0x3e5ddc67,0xbe8f0c05
.long 0x3dfc4836,0xbea9ad2e,0x3c96fd53,0xbeb4c5f0,0xbdb43e2b,0xbeaf523c,0xbe3eddd1,0xbe99d1d7
.long 0x3eb504f3,0x80000000,0x3eac911c,0xbddaacf8,0x3e93ffa8,0xbe5076ff,0x3e5b37ea,0xbe900fd7
.long 0x3df3ef2f,0xbeaa700c,0x3c5535d0,0xbeb4e58c,0xbdc11ee4,0xbeae764c,0xbe456dc2,0xbe97bc21
.long 0x3eb504f3,0x80000000,0x3eac65f6,0xbddccad7,0x3e935b38,0xbe5246f1,0x3e588eac,0xbe911088
.long 0x3deb8cc0,0xbeab2c57,0x3bf8c846,0xbeb4fa44,0xbdcdeedd,0xbead8b3b,0xbe4be663,0xbe959481
.long 0x3eb504f3,0x80000000,0x3eac3a67,0xbddee82e,0x3e92b55b,0xbe5414dc,0x3e55e0bb,0xbe920e15
.long 0x3de3213d,0xbeabe20a,0x3b0e2bde,0xbeb50414,0xbddaacf8,0xbeac911c,0xbe5246f1,0xbe935b38
.long 0x3eb504f3,0x80000000,0x3eac0e6d,0xbde104fb,0x3e920e15,0xbe55e0bb,0x3e532e27,0xbe930877
.long 0x3ddaacf8,0xbeac911c,0xbb554160,0xbeb502fd,0xbde7581c,0xbeab8804,0xbe588eac,0xbe911088
.long 0x3eb504f3,0x80000000,0x3eabe20a,0xbde3213d,0x3e916566,0xbe57aa8b,0x3e5076ff,0xbe93ffa8
.long 0x3dd23045,0xbead3986,0xbc0e2871,0xbeb4f6fe,0xbdf3ef2f,0xbeaa700c,0xbe5ebcd5,0xbe8eb4b9
.long 0x3eb504f3,0x80000000,0x3eabb53c,0xbde53cf3,0x3e90bb51,0xbe597247,0x3e4dbb52,0xbe94f3a4
.long 0x3dc9ab78,0xbeaddb43,0xbc66f7fb,0xbeb4e019,0xbe00388c,0xbea9494b,0xbe64d0b3,0xbe8c4810
.long 0x3eb504f3,0x80000000,0x3eab8804,0xbde7581c,0x3e900fd7,0xbe5b37ea,0x3e4afb2e,0xbe95e465
.long 0x3dc11ee4,0xbeae764c,0xbc9fdccd,0xbeb4be4f,0xbe066e62,0xbea813db,0xbe6ac98c,0xbe89cad7
.long 0x3eb504f3,0x80000000,0x3eab5a63,0xbde972b6,0x3e8f62f9,0xbe5cfb70,0x3e4836a4,0xbe96d1e6
.long 0x3db88ade,0xbeaf0a9c,0xbccc33fc,0xbeb491a1,0xbe0c988f,0xbea6cfd6,0xbe70a6ad,0xbe873d5a
.long 0x3eb504f3,0x80000000,0x3eab2c57,0xbdeb8cc0,0x3e8eb4b9,0xbe5ebcd5,0x3e456dc2,0xbe97bc21
.long 0x3dafefbb,0xbeaf982b,0xbcf87edd,0xbeb45a13,0xbe12b689,0xbea57d59,0xbe766765,0xbe849fe5
.long 0x3eb504f3,0x80000000,0x3eaafde3,0xbdeda639,0x3e8e0519,0xbe607c15,0x3e42a097,0xbe98a312
.long 0x3da74dcf,0xbeb01ef6,0xbd125d63,0xbeb417a7,0xbe18c7c9,0xbea41c82,0xbe7c0b05,0xbe81f2c8
.long 0x3eb504f3,0x80000000,0x3eaacf04,0xbdefbf20,0x3e8d541b,0xbe62392a,0x3e3fcf35,0xbe9986b4
.long 0x3d9ea570,0xbeb09ef7,0xbd287287,0xbeb3ca63,0xbe1ecbc9,0xbea2ad6e,0xbe80c872,0xbe7e6ca5
.long 0x3eb504f3,0x80000000,0x3eaa9fbd,0xbdf1d772,0x3e8ca1c0,0xbe63f411,0x3e3cf9a9,0xbe9a6701
.long 0x3d95f6f4,0xbeb11828,0xbd3e7d85,0xbeb37249,0xbe24c203,0xbea1303d,0xbe837c2c,0xbe78d5b1
.long 0x3eb504f3,0x80000000,0x3eaa700c,0xbdf3ef2f,0x3e8bee0a,0xbe65acc6,0x3e3a2005,0xbe9b43f5
.long 0x3d8d42af,0xbeb18a86,0xbd547d09,0xbeb30f61,0xbe2aa9f2,0xbe9fa512,0xbe862061,0xbe73215c
.long 0x3eb504f3,0x80000000,0x3eaa3ff2,0xbdf60656,0x3e8b38fb,0xbe676345,0x3e374257,0xbe9c1d8c
.long 0x3d8488f8,0xbeb1f60b,0xbd6a6fc1,0xbeb2a1af,0xbe308313,0xbe9e0c0d,0xbe88b4c0,0xbe6d5053
.long 0x3eb504f3,0x80000000,0x3eaa0f6f,0xbdf81ce5,0x3e8a8294,0xbe691788,0x3e3460b0,0xbe9cf3bf
.long 0x3d77944a,0xbeb25ab4,0xbd802a2d,0xbeb2293b,0xbe364ce5,0xbe9c6553,0xbe8b38fb,0xbe676345
.long 0x3eb504f3,0x80000000,0x3ea9de83,0xbdfa32da,0x3e89cad7,0xbe6ac98c,0x3e317b1f,0xbe9dc68b
.long 0x3d660d19,0xbeb2b87c,0xbd8b14c1,0xbeb1a60b,0xbe3c06e6,0xbe9ab107,0xbe8dacc6,0xbe615ae5
.long 0x3eb504f3,0x80000000,0x3ea9ad2e,0xbdfc4836,0x3e8911c7,0xbe6c794d,0x3e2e91b5,0xbe9e95ec
.long 0x3d547d09,0xbeb30f61,0xbd95f6f4,0xbeb11828,0xbe41b099,0xbe98ef51,0xbe900fd7,0xbe5b37ea
.long 0x3eb504f3,0x80000000,0x3ea97b71,0xbdfe5cf6,0x3e885764,0xbe6e26c6,0x3e2ba482,0xbe9f61dc
.long 0x3d42e4c8,0xbeb35f5f,0xbda0d01e,0xbeb07f9a,0xbe47497e,0xbe972057,0xbe9261e5,0xbe54fb0d
.long 0x3eb504f3,0x80000000,0x3ea9494b,0xbe00388c,0x3e879bb1,0xbe6fd1f4,0x3e28b396,0xbea02a57
.long 0x3d314504,0xbeb3a872,0xbdab9f99,0xbeafdc6a,0xbe4cd119,0xbe954440,0xbe94a2ac,0xbe4ea50b
.long 0x3eb504f3,0x80000000,0x3ea916bc,0xbe01424f,0x3e86deb0,0xbe717ad2,0x3e25bf02,0xbea0ef58
.long 0x3d1f9e6a,0xbeb3ea98,0xbdb664bd,0xbeaf2ea2,0xbe5246f1,0xbe935b38,0xbe96d1e6,0xbe4836a4
.long 0x3eb504f3,0x80000000,0x3ea8e3c6,0xbe024bc1,0x3e862061,0xbe73215c,0x3e22c6d5,0xbea1b0dd
.long 0x3d0df1a9,0xbeb425ce,0xbdc11ee4,0xbeae764c,0xbe57aa8b,0xbe916566,0xbe98ef51,0xbe41b099
.long 0x3eb504f3,0x80000000,0x3ea8b067,0xbe0354e4,0x3e8560c8,0xbe74c58e,0x3e1fcb21,0xbea26ee0
.long 0x3cf87edd,0xbeb45a13,0xbdcbcd69,0xbeadb375,0xbe5cfb70,0xbe8f62f9,0xbe9afaae,0xbe3b13af
.long 0x3eb504f3,0x80000000,0x3ea87ca0,0xbe045db5,0x3e849fe5,0xbe766765,0x3e1ccbf5,0xbea3295d
.long 0x3cd510d4,0xbeb48763,0xbdd66fa7,0xbeace626,0xbe62392a,0xbe8d541b,0xbe9cf3bf,0xbe3460b0
.long 0x3eb504f3,0x80000000,0x3ea84871,0xbe056635,0x3e83ddbb,0xbe7806db,0x3e19c963,0xbea3e050
.long 0x3cb19a94,0xbeb4adbe,0xbde104fb,0xbeac0e6d,0xbe676345,0xbe8b38fb,0xbe9eda48,0xbe2d9864
.long 0x3eb504f3,0x80000000,0x3ea813db,0xbe066e62,0x3e831a4c,0xbe79a3ee,0x3e16c37c,0xbea493b5
.long 0x3c8e1d7b,0xbeb4cd21,0xbdeb8cc0,0xbeab2c57,0xbe6c794d,0xbe8911c7,0xbea0ae10,0xbe26bb9a
.long 0x3eb504f3,0x80000000,0x3ea7dedc,0xbe07763c,0x3e82559a,0xbe7b3e98,0x3e13ba4f,0xbea54389
.long 0x3c5535d0,0xbeb4e58c,0xbdf60656,0xbeaa3ff2,0xbe717ad2,0xbe86deb0,0xbea26ee0,0xbe1fcb21
.long 0x3eb504f3,0x80000000,0x3ea7a976,0xbe087dc3,0x3e818fa5,0xbe7cd6d6,0x3e10adee,0xbea5efc7
.long 0x3c0e2871,0xbeb4f6fe,0xbe00388c,0xbea9494b,0xbe766765,0xbe849fe5,0xbea41c82,0xbe18c7c9
.long 0x3eb504f3,0x80000000,0x3ea773a9,0xbe0984f6,0x3e80c872,0xbe7e6ca5,0x3e0d9e6a,0xbea6986c
.long 0x3b8e2b2f,0xbeb50176,0xbe056635,0xbea84871,0xbe7b3e98,0xbe82559a,0xbea5b6c3,0xbe11b268
.long 0x3eb504f3,0x80000000,0x3ea73d75,0xbe0a8bd4,0x3e800000,0xbe800000,0x3e0a8bd4,0xbea73d75
.long 0x23c7ad06,0xbeb504f3,0xbe0a8bd4,0xbea73d75,0xbe800000,0xbe800000,0xbea73d75,0xbe0a8bd4
.long 0x3eb504f3,0x80000000,0x3ea706d9,0xbe0b925c,0x3e7e6ca5,0xbe80c872,0x3e07763c,0xbea7dedc
.long 0xbb8e2b2f,0xbeb50176,0xbe0fa91b,0xbea62865,0xbe82559a,0xbe7b3e98,0xbea8b067,0xbe0354e4
.long 0x3eb504f3,0x80000000,0x3ea6cfd6,0xbe0c988f,0x3e7cd6d6,0xbe818fa5,0x3e045db5,0xbea87ca0
.long 0xbc0e2871,0xbeb4f6fe,0xbe14bdba,0xbea50953,0xbe849fe5,0xbe766765,0xbeaa0f6f,0xbdf81ce5
.long 0x3eb504f3,0x80000000,0x3ea6986c,0xbe0d9e6a,0x3e7b3e98,0xbe82559a,0x3e01424f,0xbea916bc
.long 0xbc5535d0,0xbeb4e58c,0xbe19c963,0xbea3e050,0xbe86deb0,0xbe717ad2,0xbeab5a63,0xbde972b6
.long 0x3eb504f3,0x80000000,0x3ea6609c,0xbe0ea3ee,0x3e79a3ee,0xbe831a4c,0x3dfc4836,0xbea9ad2e
.long 0xbc8e1d7b,0xbeb4cd21,0xbe1ecbc9,0xbea2ad6e,0xbe8911c7,0xbe6c794d,0xbeac911c,0xbddaacf8
.long 0x3eb504f3,0x80000000,0x3ea62865,0xbe0fa91b,0x3e7806db,0xbe83ddbb,0x3df60656,0xbeaa3ff2
.long 0xbcb19a94,0xbeb4adbe,0xbe23c49f,0xbea170bf,0xbe8b38fb,0xbe676345,0xbeadb375,0xbdcbcd69
.long 0x3eb504f3,0x80000000,0x3ea5efc7,0xbe10adee,0x3e766765,0xbe849fe5,0x3defbf20,0xbeaacf04
.long 0xbcd510d4,0xbeb48763,0xbe28b396,0xbea02a57,0xbe8d541b,0xbe62392a,0xbeaec14c,0xbdbcd5ca
.long 0x3eb504f3,0x80000000,0x3ea5b6c3,0xbe11b268,0x3e74c58e,0xbe8560c8,0x3de972b6,0xbeab5a63
.long 0xbcf87edd,0xbeb45a13,0xbe2d9864,0xbe9eda48,0xbe8f62f9,0xbe5cfb70,0xbeafba81,0xbdadc7df
.long 0x3eb504f3,0x80000000,0x3ea57d59,0xbe12b689,0x3e73215c,0xbe862061,0x3de3213d,0xbeabe20a
.long 0xbd0df1a9,0xbeb425ce,0xbe3272be,0xbe9d80a8,0xbe916566,0xbe57aa8b,0xbeb09ef7,0xbd9ea570
.long 0x3eb504f3,0x80000000,0x3ea54389,0xbe13ba4f,0x3e717ad2,0xbe86deb0,0x3ddccad7,0xbeac65f6
.long 0xbd1f9e6a,0xbeb3ea98,0xbe374257,0xbe9c1d8c,0xbe935b38,0xbe5246f1,0xbeb16e92,0xbd8f7046
.long 0x3eb504f3,0x80000000,0x3ea50953,0xbe14bdba,0x3e6fd1f4,0xbe879bb1,0x3dd66fa7,0xbeace626
.long 0xbd314504,0xbeb3a872,0xbe3c06e6,0xbe9ab107,0xbe954440,0xbe4cd119,0xbeb2293b,0xbd802a2d
.long 0x3eb504f3,0x80000000,0x3ea4ceb7,0xbe15c0c9,0x3e6e26c6,0xbe885764,0x3dd00fd1,0xbead6296
.long 0xbd42e4c8,0xbeb35f5f,0xbe40c022,0xbe993b32,0xbe972057,0xbe47497e,0xbeb2cedb,0xbd61a9e3
.long 0x3eb504f3,0x80000000,0x3ea493b5,0xbe16c37c,0x3e6c794d,0xbe8911c7,0x3dc9ab78,0xbeaddb43
.long 0xbd547d09,0xbeb30f61,0xbe456dc2,0xbe97bc21,0xbe98ef51,0xbe41b099,0xbeb35f5f,0xbd42e4c8
.long 0x3eb504f3,0x80000000,0x3ea4584e,0xbe17c5d1,0x3e6ac98c,0xbe89cad7,0x3dc342bf,0xbeae502b
.long 0xbd660d19,0xbeb2b87c,0xbe4a0f7c,0xbe9633ed,0xbe9ab107,0xbe3c06e6,0xbeb3dab5,0xbd2408ab
.long 0x3eb504f3,0x80000000,0x3ea41c82,0xbe18c7c9,0x3e691788,0xbe8a8294,0x3dbcd5ca,0xbeaec14c
.long 0xbd77944a,0xbeb25ab4,0xbe4ea50b,0xbe94a2ac,0xbe9c6553,0xbe364ce5,0xbeb440cf,0xbd051930
.long 0x3eb504f3,0x80000000,0x3ea3e050,0xbe19c963,0x3e676345,0xbe8b38fb,0x3db664bd,0xbeaf2ea2
.long 0xbd8488f8,0xbeb1f60b,0xbe532e27,0xbe930877,0xbe9e0c0d,0xbe308313,0xbeb491a1,0xbccc33fc
.long 0x3eb504f3,0x80000000,0x3ea3a3b9,0xbe1aca9e,0x3e65acc6,0xbe8bee0a,0x3dafefbb,0xbeaf982b
.long 0xbd8d42af,0xbeb18a86,0xbe57aa8b,0xbe916566,0xbe9fa512,0xbe2aa9f2,0xbeb4cd21,0xbc8e1d7b
.long 0x3eb504f3,0x80000000,0x3ea366bd,0xbe1bcb7a,0x3e63f411,0xbe8ca1c0,0x3da976e8,0xbeaffde6
.long 0xbd95f6f4,0xbeb11828,0xbe5c19f1,0xbe8fb994,0xbea1303d,0xbe24c203,0xbeb4f349,0xbc1fec68
.long 0x3eb504f3,0x80000000,0x3ea3295d,0xbe1ccbf5,0x3e62392a,0xbe8d541b,0x3da2fa69,0xbeb05fd0
.long 0xbd9ea570,0xbeb09ef7,0xbe607c15,0xbe8e0519,0xbea2ad6e,0xbe1ecbc9,0xbeb50414,0xbb0e2bde
.long 0x3eb504f3,0x80000000,0x3ea2eb97,0xbe1dcc10,0x3e607c15,0xbe8e0519,0x3d9c7a61,0xbeb0bde7
.long 0xbda74dcf,0xbeb01ef6,0xbe64d0b3,0xbe8c4810,0xbea41c82,0xbe18c7c9,0xbeb4ff7f,0x3bb1b556
.long 0x3eb504f3,0x80000000,0x3ea2ad6e,0xbe1ecbc9,0x3e5ebcd5,0xbe8eb4b9,0x3d95f6f4,0xbeb11828
.long 0xbdafefbb,0xbeaf982b,0xbe691788,0xbe8a8294,0xbea57d59,0xbe12b689,0xbeb4e58c,0x3c5535d0
.long 0x3eb504f3,0x80000000,0x3ea26ee0,0xbe1fcb21,0x3e5cfb70,0xbe8f62f9,0x3d8f7046,0xbeb16e92
.long 0xbdb88ade,0xbeaf0a9c,0xbe6d5053,0xbe88b4c0,0xbea6cfd6,0xbe0c988f,0xbeb4b63e,0x3ca8bbe5
.long 0x3eb504f3,0x80000000,0x3ea22fed,0xbe20ca16,0x3e5b37ea,0xbe900fd7,0x3d88e67c,0xbeb1c123
.long 0xbdc11ee4,0xbeae764c,0xbe717ad2,0xbe86deb0,0xbea813db,0xbe066e62,0xbeb4719a,0x3ce6c8f5
.long 0x3eb504f3,0x80000000,0x3ea1f097,0xbe21c8a7,0x3e597247,0xbe90bb51,0x3d8259bb,0xbeb20fda
.long 0xbdc9ab78,0xbeaddb43,0xbe7596c5,0xbe85007f,0xbea9494b,0xbe00388c,0xbeb417a7,0x3d125d63
.long 0x3eb504f3,0x80000000,0x3ea1b0dd,0xbe22c6d5,0x3e57aa8b,0xbe916566,0x3d77944a,0xbeb25ab4
.long 0xbdd23045,0xbead3986,0xbe79a3ee,0xbe831a4c,0xbeaa700c,0xbdf3ef2f,0xbeb3a872,0x3d314504
.long 0x3eb504f3,0x80000000,0x3ea170bf,0xbe23c49f,0x3e55e0bb,0xbe920e15,0x3d6a6fc1,0xbeb2a1af
.long 0xbddaacf8,0xbeac911c,0xbe7da20c,0xbe812c33,0xbeab8804,0xbde7581c,0xbeb32406,0x3d5017b7
.long 0x3eb504f3,0x80000000,0x3ea1303d,0xbe24c203,0x3e5414dc,0xbe92b55b,0x3d5d4622,0xbeb2e4cb
.long 0xbde3213d,0xbeabe20a,0xbe80c872,0xbe7e6ca5,0xbeac911c,0xbddaacf8,0xbeb28a74,0x3d6ed1d8
.long 0x3eb504f3,0x80000000,0x3ea0ef58,0xbe25bf02,0x3e5246f1,0xbe935b38,0x3d5017b7,0xbeb32406
.long 0xbdeb8cc0,0xbeab2c57,0xbe82b81b,0xbe7a7190,0xbead8b3b,0xbdcdeedd,0xbeb1dbce,0x3d86b7e4
.long 0x3eb504f3,0x80000000,0x3ea0ae10,0xbe26bb9a,0x3e5076ff,0xbe93ffa8,0x3d42e4c8,0xbeb35f5f
.long 0xbdf3ef2f,0xbeaa700c,0xbe849fe5,0xbe766765,0xbeae764c,0xbdc11ee4,0xbeb11828,0x3d95f6f4
.long 0x3eb504f3,0x80000000,0x3ea06c65,0xbe27b7cc,0x3e4ea50b,0xbe94a2ac,0x3d35ada0,0xbeb396d3
.long 0xbdfc4836,0xbea9ad2e,0xbe867fb2,0xbe724e62,0xbeaf523c,0xbdb43e2b,0xbeb03f99,0x3da5244f
.long 0x3eb504f3,0x80000000,0x3ea02a57,0xbe28b396,0x3e4cd119,0xbe954440,0x3d287287,0xbeb3ca63
.long 0xbe024bc1,0xbea8e3c6,0xbe885764,0xbe6e26c6,0xbeb01ef6,0xbda74dcf,0xbeaf523c,0x3db43e2b
.long 0x3eb504f3,0x80000000,0x3e9fe7e5,0xbe29aef8,0x3e4afb2e,0xbe95e465,0x3d1b33c7,0xbeb3fa0c
.long 0xbe066e62,0xbea813db,0xbe8a26e0,0xbe69f0d2,0xbeb0dc6a,0xbd9a4ef0,0xbeae502b,0x3dc342bf
.long 0x3eb504f3,0x80000000,0x3e9fa512,0xbe2aa9f2,0x3e49234e,0xbe968317,0x3d0df1a9,0xbeb425ce
.long 0xbe0a8bd4,0xbea73d75,0xbe8bee0a,0xbe65acc6,0xbeb18a86,0xbd8d42af,0xbead3986,0x3dd23045
.long 0x3eb504f3,0x80000000,0x3e9f61dc,0xbe2ba482,0x3e47497e,0xbe972057,0x3d00ac77,0xbeb44da8
.long 0xbe0ea3ee,0xbea6609c,0xbe8dacc6,0xbe615ae5,0xbeb2293b,0xbd802a2d,0xbeac0e6d,0x3de104fb
.long 0x3eb504f3,0x80000000,0x3e9f1e43,0xbe2c9ea9,0x3e456dc2,0xbe97bc21,0x3ce6c8f5,0xbeb4719a
.long 0xbe12b689,0xbea57d59,0xbe8f62f9,0xbe5cfb70,0xbeb2b87c,0xbd660d19,0xbeaacf04,0x3defbf20
.long 0x3eb504f3,0x80000000,0x3e9eda48,0xbe2d9864,0x3e43901e,0xbe985675,0x3ccc33fc,0xbeb491a1
.long 0xbe16c37c,0xbea493b5,0xbe911088,0xbe588eac,0xbeb3383d,0xbd4bb1e4,0xbea97b71,0x3dfe5cf6
.long 0x3eb504f3,0x80000000,0x3e9e95ec,0xbe2e91b5,0x3e41b099,0xbe98ef51,0x3cb19a94,0xbeb4adbe
.long 0xbe1aca9e,0xbea3a3b9,0xbe92b55b,0xbe5414dc,0xbeb3a872,0xbd314504,0xbea813db,0x3e066e62
.long 0x3eb504f3,0x80000000,0x3e9e512d,0xbe2f8a9a,0x3e3fcf35,0xbe9986b4,0x3c96fd53,0xbeb4c5f0
.long 0xbe1ecbc9,0xbea2ad6e,0xbe945158,0xbe4f8e45,0xbeb40911,0xbd16c8c3,0xbea6986c,0x3e0d9e6a
.long 0x3eb504f3,0x80000000,0x3e9e0c0d,0xbe308313,0x3e3debf8,0xbe9a1c9c,0x3c78b996,0xbeb4da36
.long 0xbe22c6d5,0xbea1b0dd,0xbe95e465,0xbe4afb2e,0xbeb45a13,0xbcf87edd,0xbea50953,0x3e14bdba
.long 0x3eb504f3,0x80000000,0x3e9dc68b,0xbe317b1f,0x3e3c06e6,0xbe9ab107,0x3c437322,0xbeb4ea90
.long 0xbe26bb9a,0xbea0ae10,0xbe976e6b,0xbe465bdd,0xbeb49b6f,0xbcc356a5,0xbea366bd,0x3e1bcb7a
.long 0x3eb504f3,0x80000000,0x3e9d80a8,0xbe3272be,0x3e3a2005,0xbe9b43f5,0x3c0e2871,0xbeb4f6fe
.long 0xbe2aa9f2,0xbe9fa512,0xbe98ef51,0xbe41b099,0xbeb4cd21,0xbc8e1d7b,0xbea1b0dd,0x3e22c6d5
.long 0x3eb504f3,0x80000000,0x3e9d3a64,0xbe3369ee,0x3e383758,0xbe9bd564,0x3bb1b556,0xbeb4ff7f
.long 0xbe2e91b5,0xbe9e95ec,0xbe9a6701,0xbe3cf9a9,0xbeb4ef25,0xbc31affc,0xbe9fe7e5,0x3e29aef8
.long 0x3eb504f3,0x80000000,0x3e9cf3bf,0xbe3460b0,0x3e364ce5,0xbe9c6553,0x3b0e2bde,0xbeb50414
.long 0xbe3272be,0xbe9d80a8,0xbe9bd564,0xbe383758,0xbeb50176,0xbb8e2b2f,0xbe9e0c0d,0x3e308313
.long 0x3eb504f3,0x80000000,0x3e9cacb9,0xbe355702,0x3e3460b0,0xbe9cf3bf,0xba8e2c0a,0xbeb504bb
.long 0xbe364ce5,0xbe9c6553,0xbe9d3a64,0xbe3369ee,0xbeb50414,0x3b0e2bde,0xbe9c1d8c,0x3e374257
.long 0x3eb504f3,0x80000000,0x3e9c6553,0xbe364ce5,0x3e3272be,0xbe9d80a8,0xbb8e2b2f,0xbeb50176
.long 0xbe3a2005,0xbe9b43f5,0xbe9e95ec,0xbe2e91b5,0xbeb4f6fe,0x3c0e2871,0xbe9a1c9c,0x3e3debf8
.long 0x3eb504f3,0x80000000,0x3e9c1d8c,0xbe374257,0x3e308313,0xbe9e0c0d,0xbbf8c846,0xbeb4fa44
.long 0xbe3debf8,0xbe9a1c9c,0xbe9fe7e5,0xbe29aef8,0xbeb4da36,0x3c78b996,0xbe98097a,0x3e447f2d
.long 0x3eb504f3,0x80000000,0x3e9bd564,0xbe383758,0x3e2e91b5,0xbe9e95ec,0xbc31affc,0xbeb4ef25
.long 0xbe41b099,0xbe98ef51,0xbea1303d,0xbe24c203,0xbeb4adbe,0x3cb19a94,0xbe95e465,0x3e4afb2e
.long 0x3eb504f3,0x80000000,0x3e9b8cdd,0xbe392be8,0x3e2c9ea9,0xbe9f1e43,0xbc66f7fb,0xbeb4e019
.long 0xbe456dc2,0xbe97bc21,0xbea26ee0,0xbe1fcb21,0xbeb4719a,0x3ce6c8f5,0xbe93ad9d,0x3e515f39
.long 0x3eb504f3,0x80000000,0x3e9b43f5,0xbe3a2005,0x3e2aa9f2,0xbe9fa512,0xbc8e1d7b,0xbeb4cd21
.long 0xbe49234e,0xbe968317,0xbea3a3b9,0xbe1aca9e,0xbeb425ce,0x3d0df1a9,0xbe916566,0x3e57aa8b
.long 0x3eb504f3,0x80000000,0x3e9afaae,0xbe3b13af,0x3e28b396,0xbea02a57,0xbca8bbe5,0xbeb4b63e
.long 0xbe4cd119,0xbe954440,0xbea4ceb7,0xbe15c0c9,0xbeb3ca63,0x3d287287,0xbe8f0c05,0x3e5ddc67
.long 0x3eb504f3,0x80000000,0x3e9ab107,0xbe3c06e6,0x3e26bb9a,0xbea0ae10,0xbcc356a5,0xbeb49b6f
.long 0xbe5076ff,0xbe93ffa8,0xbea5efc7,0xbe10adee,0xbeb35f5f,0x3d42e4c8,0xbe8ca1c0,0x3e63f411
.long 0x3eb504f3,0x80000000,0x3e9a6701,0xbe3cf9a9,0x3e24c203,0xbea1303d,0xbcdded29,0xbeb47cb6
.long 0xbe5414dc,0xbe92b55b,0xbea706d9,0xbe0b925c,0xbeb2e4cb,0x3d5d4622,0xbe8a26e0,0x3e69f0d2
.long 0x3eb504f3,0x80000000,0x3e9a1c9c,0xbe3debf8,0x3e22c6d5,0xbea1b0dd,0xbcf87edd,0xbeb45a13
.long 0xbe57aa8b,0xbe916566,0xbea813db,0xbe066e62,0xbeb25ab4,0x3d77944a,0xbe879bb1,0x3e6fd1f4
.long 0x3eb504f3,0x80000000,0x3e99d1d7,0xbe3eddd1,0x3e20ca16,0xbea22fed,0xbd098597,0xbeb43386
.long 0xbe5b37ea,0xbe900fd7,0xbea916bc,0xbe01424f,0xbeb1c123,0x3d88e67c,0xbe85007f,0x3e7596c5
.long 0x3eb504f3,0x80000000,0x3e9986b4,0xbe3fcf35,0x3e1ecbc9,0xbea2ad6e,0xbd16c8c3,0xbeb40911
.long 0xbe5ebcd5,0xbe8eb4b9,0xbeaa0f6f,0xbdf81ce5,0xbeb11828,0x3d95f6f4,0xbe82559a,0x3e7b3e98
.long 0x3eb504f3,0x80000000,0x3e993b32,0xbe40c022,0x3e1ccbf5,0xbea3295d,0xbd2408ab,0xbeb3dab5
.long 0xbe62392a,0xbe8d541b,0xbeaafde3,0xbdeda639,0xbeb05fd0,0x3da2fa69,0xbe7f36a1,0x3e806460
.long 0x3eb504f3,0x80000000,0x3e98ef51,0xbe41b099,0x3e1aca9e,0xbea3a3b9,0xbd314504,0xbeb3a872
.long 0xbe65acc6,0xbe8bee0a,0xbeabe20a,0xbde3213d,0xbeaf982b,0x3dafefbb,0xbe79a3ee,0x3e831a4c
.long 0x3eb504f3,0x80000000,0x3e98a312,0xbe42a097,0x3e18c7c9,0xbea41c82,0xbd3e7d85,0xbeb37249
.long 0xbe691788,0xbe8a8294,0xbeacbbd6,0xbdd88e93,0xbeaec14c,0x3dbcd5ca,0xbe73f3c1,0x3e85c0be
.long 0x3eb504f3,0x80000000,0x3e985675,0xbe43901e,0x3e16c37c,0xbea493b5,0xbd4bb1e4,0xbeb3383d
.long 0xbe6c794d,0xbe8911c7,0xbead8b3b,0xbdcdeedd,0xbeaddb43,0x3dc9ab78,0xbe6e26c6,0x3e885764
.long 0x3eb504f3,0x80000000,0x3e98097a,0xbe447f2d,0x3e14bdba,0xbea50953,0xbd58e1d9,0xbeb2fa4d
.long 0xbe6fd1f4,0xbe879bb1,0xbeae502b,0xbdc342bf,0xbeace626,0x3dd66fa7,0xbe683dae,0x3e8addf2
.long 0x3eb504f3,0x80000000,0x3e97bc21,0xbe456dc2,0x3e12b689,0xbea57d59,0xbd660d19,0xbeb2b87c
.long 0xbe73215c,0xbe862061,0xbeaf0a9c,0xbdb88ade,0xbeabe20a,0x3de3213d,0xbe62392a,0x3e8d541b
.long 0x3eb504f3,0x80000000,0x3e976e6b,0xbe465bdd,0x3e10adee,0xbea5efc7,0xbd73335c,0xbeb272cb
.long 0xbe766765,0xbe849fe5,0xbeafba81,0xbdadc7df,0xbeaacf04,0x3defbf20,0xbe5c19f1,0x3e8fb994
.long 0x3eb504f3,0x80000000,0x3e972057,0xbe47497e,0x3e0ea3ee,0xbea6609c,0xbd802a2d,0xbeb2293b
.long 0xbe79a3ee,0xbe831a4c,0xbeb05fd0,0xbda2fa69,0xbea9ad2e,0x3dfc4836,0xbe55e0bb,0x3e920e15
.long 0x3eb504f3,0x80000000,0x3e96d1e6,0xbe4836a4,0x3e0c988f,0xbea6cfd6,0xbd86b7e4,0xbeb1dbce
.long 0xbe7cd6d6,0xbe818fa5,0xbeb0fa7f,0xbd982321,0xbea87ca0,0x3e045db5,0xbe4f8e45,0x3e945158
.long 0x3eb504f3,0x80000000,0x3e968317,0xbe49234e,0x3e0a8bd4,0xbea73d75,0xbd8d42af,0xbeb18a86
.long 0xbe800000,0xbe800000,0xbeb18a86,0xbd8d42af,0xbea73d75,0x3e0a8bd4,0xbe49234e,0x3e968317
.long 0x3eb504f3,0x80000000,0x3e9633ed,0xbe4a0f7c,0x3e087dc3,0xbea7a976,0xbd93ca6a,0xbeb13563
.long 0xbe818fa5,0xbe7cd6d6,0xbeb20fda,0xbd8259bb,0xbea5efc7,0x3e10adee,0xbe42a097,0x3e98a312
.long 0x3eb504f3,0x80000000,0x3e95e465,0xbe4afb2e,0x3e066e62,0xbea813db,0xbd9a4ef0,0xbeb0dc6a
.long 0xbe831a4c,0xbe79a3ee,0xbeb28a74,0xbd6ed1d8,0xbea493b5,0x3e16c37c,0xbe3c06e6,0x3e9ab107
.long 0x3eb504f3,0x80000000,0x3e959481,0xbe4be663,0x3e045db5,0xbea87ca0,0xbda0d01e,0xbeb07f9a
.long 0xbe849fe5,0xbe766765,0xbeb2fa4d,0xbd58e1d9,0xbea3295d,0x3e1ccbf5,0xbe355702,0x3e9cacb9
.long 0x3eb504f3,0x80000000,0x3e954440,0xbe4cd119,0x3e024bc1,0xbea8e3c6,0xbda74dcf,0xbeb01ef6
.long 0xbe862061,0xbe73215c,0xbeb35f5f,0xbd42e4c8,0xbea1b0dd,0x3e22c6d5,0xbe2e91b5,0x3e9e95ec
.long 0x3eb504f3,0x80000000,0x3e94f3a4,0xbe4dbb52,0x3e00388c,0xbea9494b,0xbdadc7df,0xbeafba81
.long 0xbe879bb1,0xbe6fd1f4,0xbeb3b9a2,0xbd2cdbfb,0xbea02a57,0x3e28b396,0xbe27b7cc,0x3ea06c65
.long 0x3eb504f3,0x80000000,0x3e94a2ac,0xbe4ea50b,0x3dfc4836,0xbea9ad2e,0xbdb43e2b,0xbeaf523c
.long 0xbe8911c7,0xbe6c794d,0xbeb40911,0xbd16c8c3,0xbe9e95ec,0x3e2e91b5,0xbe20ca16,0x3ea22fed
.long 0x3eb504f3,0x80000000,0x3e945158,0xbe4f8e45,0x3df81ce5,0xbeaa0f6f,0xbdbab08e,0xbeaee62a
.long 0xbe8a8294,0xbe691788,0xbeb44da8,0xbd00ac77,0xbe9cf3bf,0x3e3460b0,0xbe19c963,0x3ea3e050
.long 0x3eb504f3,0x80000000,0x3e93ffa8,0xbe5076ff,0x3df3ef2f,0xbeaa700c,0xbdc11ee4,0xbeae764c
.long 0xbe8bee0a,0xbe65acc6,0xbeb48763,0xbcd510d4,0xbe9b43f5,0x3e3a2005,0xbe12b689,0x3ea57d59
.long 0x3eb504f3,0x80000000,0x3e93ad9d,0xbe515f39,0x3defbf20,0xbeaacf04,0xbdc7890a,0xbeae02a7
.long 0xbe8d541b,0xbe62392a,0xbeb4b63e,0xbca8bbe5,0xbe9986b4,0x3e3fcf35,0xbe0b925c,0x3ea706d9
.long 0x3eb504f3,0x80000000,0x3e935b38,0xbe5246f1,0x3deb8cc0,0xbeab2c57,0xbdcdeedd,0xbead8b3b
.long 0xbe8eb4b9,0xbe5ebcd5,0xbeb4da36,0xbc78b996,0xbe97bc21,0x3e456dc2,0xbe045db5,0x3ea87ca0
.long 0x3eb504f3,0x80000000,0x3e930877,0xbe532e27,0x3de7581c,0xbeab8804,0xbdd45038,0xbead100c
.long 0xbe900fd7,0xbe5b37ea,0xbeb4f349,0xbc1fec68,0xbe95e465,0x3e4afb2e,0xbdfa32da,0x3ea9de83
.long 0x3eb504f3,0x80000000,0x3e92b55b,0xbe5414dc,0x3de3213d,0xbeabe20a,0xbddaacf8,0xbeac911c
.long 0xbe916566,0xbe57aa8b,0xbeb50176,0xbb8e2b2f,0xbe93ffa8,0x3e5076ff,0xbdeb8cc0,0x3eab2c57
.long 0x3eb504f3,0x80000000,0x3e9261e5,0xbe54fb0d,0x3ddee82e,0xbeac3a67,0xbde104fb,0xbeac0e6d
.long 0xbe92b55b,0xbe5414dc,0xbeb504bb,0x3a8e2c0a,0xbe920e15,0x3e55e0bb,0xbddccad7,0x3eac65f6
.long 0x3eb504f3,0x80000000,0x3e920e15,0xbe55e0bb,0x3ddaacf8,0xbeac911c,0xbde7581c,0xbeab8804
.long 0xbe93ffa8,0xbe5076ff,0xbeb4fd19,0x3bd53f10,0xbe900fd7,0x3e5b37ea,0xbdcdeedd,0x3ead8b3b
.long 0x3eb504f3,0x80000000,0x3e91b9eb,0xbe56c5e5,0x3dd66fa7,0xbeace626,0xbdeda639,0xbeaafde3
.long 0xbe954440,0xbe4cd119,0xbeb4ea90,0x3c437322,0xbe8e0519,0x3e607c15,0xbdbefa92,0x3eae9c02
.long 0x3eb504f3,0x80000000,0x3e916566,0xbe57aa8b,0x3dd23045,0xbead3986,0xbdf3ef2f,0xbeaa700c
.long 0xbe968317,0xbe49234e,0xbeb4cd21,0x3c8e1d7b,0xbe8bee0a,0x3e65acc6,0xbdafefbb,0x3eaf982b
.long 0x3eb504f3,0x80000000,0x3e911088,0xbe588eac,0x3dcdeedd,0xbead8b3b,0xbdfa32da,0xbea9de83
.long 0xbe97bc21,0xbe456dc2,0xbeb4a4ce,0x3cba78d6,0xbe89cad7,0x3e6ac98c,0xbda0d01e,0x3eb07f9a
.long 0x3eb504f3,0x80000000,0x3e90bb51,0xbe597247,0x3dc9ab78,0xbeaddb43,0xbe00388c,0xbea9494b
.long 0xbe98ef51,0xbe41b099,0xbeb4719a,0x3ce6c8f5,0xbe879bb1,0x3e6fd1f4,0xbd919d85,0x3eb15232
.long 0x3eb504f3,0x80000000,0x3e9065c0,0xbe5a555c,0x3dc56621,0xbeae299f,0xbe0354e4,0xbea8b067
.long 0xbe9a1c9c,0xbe3debf8,0xbeb43386,0x3d098597,0xbe8560c8,0x3e74c58e,0xbd8259bb,0x3eb20fda
.long 0x3eb504f3,0x80000000,0x3e900fd7,0xbe5b37ea,0x3dc11ee4,0xbeae764c,0xbe066e62,0xbea813db
.long 0xbe9b43f5,0xbe3a2005,0xbeb3ea98,0x3d1f9e6a,0xbe831a4c,0x3e79a3ee,0xbd660d19,0x3eb2b87c
.long 0x3eb504f3,0x80000000,0x3e8fb994,0xbe5c19f1,0x3dbcd5ca,0xbeaec14c,0xbe0984f6,0xbea773a9
.long 0xbe9c6553,0xbe364ce5,0xbeb396d3,0x3d35ada0,0xbe80c872,0x3e7e6ca5,0xbd474b94,0x3eb34c05
.long 0x3eb504f3,0x80000000,0x3e8f62f9,0xbe5cfb70,0x3db88ade,0xbeaf0a9c,0xbe0c988f,0xbea6cfd6
.long 0xbe9d80a8,0xbe3272be,0xbeb3383d,0x3d4bb1e4,0xbe7cd6d6,0x3e818fa5,0xbd287287,0x3eb3ca63
.long 0x3eb504f3,0x80000000,0x3e8f0c05,0xbe5ddc67,0x3db43e2b,0xbeaf523c,0xbe0fa91b,0xbea62865
.long 0xbe9e95ec,0xbe2e91b5,0xbeb2cedb,0x3d61a9e3,0xbe7806db,0x3e83ddbb,0xbd098597,0x3eb43386
.long 0x3eb504f3,0x80000000,0x3e8eb4b9,0xbe5ebcd5,0x3dafefbb,0xbeaf982b,0xbe12b689,0xbea57d59
.long 0xbe9fa512,0xbe2aa9f2,0xbeb25ab4,0x3d77944a,0xbe73215c,0x3e862061,0xbcd510d4,0x3eb48763
.long 0x3eb504f3,0x80000000,0x3e8e5d15,0xbe5f9cba,0x3dab9f99,0xbeafdc6a,0xbe15c0c9,0xbea4ceb7
.long 0xbea0ae10,0xbe26bb9a,0xbeb1dbce,0x3d86b7e4,0xbe6e26c6,0x3e885764,0xbc96fd53,0x3eb4c5f0
.long 0x3eb504f3,0x80000000,0x3e8e0519,0xbe607c15,0x3da74dcf,0xbeb01ef6,0xbe18c7c9,0xbea41c82
.long 0xbea1b0dd,0xbe22c6d5,0xbeb15232,0x3d919d85,0xbe691788,0x3e8a8294,0xbc31affc,0x3eb4ef25
.long 0x3eb504f3,0x80000000,0x3e8dacc6,0xbe615ae5,0x3da2fa69,0xbeb05fd0,0xbe1bcb7a,0xbea366bd
.long 0xbea2ad6e,0xbe1ecbc9,0xbeb0bde7,0x3d9c7a61,0xbe63f411,0x3e8ca1c0,0xbb554160,0x3eb502fd
.long 0x3eb504f3,0x80000000,0x3e8d541b,0xbe62392a,0x3d9ea570,0xbeb09ef7,0xbe1ecbc9,0xbea2ad6e
.long 0xbea3a3b9,0xbe1aca9e,0xbeb01ef6,0x3da74dcf,0xbe5ebcd5,0x3e8eb4b9,0x3b8e2b2f,0x3eb50176
.long 0x3eb504f3,0x80000000,0x3e8cfb19,0xbe6316e4,0x3d9a4ef0,0xbeb0dc6a,0xbe21c8a7,0xbea1f097
.long 0xbea493b5,0xbe16c37c,0xbeaf756a,0x3db2172a,0xbe597247,0x3e90bb51,0x3c437322,0x3eb4ea90
.long 0x3eb504f3,0x80000000,0x3e8ca1c0,0xbe63f411,0x3d95f6f4,0xbeb11828,0xbe24c203,0xbea1303d
.long 0xbea57d59,0xbe12b689,0xbeaec14c,0x3dbcd5ca,0xbe5414dc,0x3e92b55b,0x3c9fdccd,0x3eb4be4f
.long 0x3eb504f3,0x80000000,0x3e8c4810,0xbe64d0b3,0x3d919d85,0xbeb15232,0xbe27b7cc,0xbea06c65
.long 0xbea6609c,0xbe0ea3ee,0xbeae02a7,0x3dc7890a,0xbe4ea50b,0x3e94a2ac,0x3cdded29,0x3eb47cb6
.long 0x3eb504f3,0x80000000,0x3e8bee0a,0xbe65acc6,0x3d8d42af,0xbeb18a86,0xbe2aa9f2,0xbe9fa512
.long 0xbea73d75,0xbe0a8bd4,0xbead3986,0x3dd23045,0xbe49234e,0x3e968317,0x3d0df1a9,0x3eb425ce
.long 0x3eb504f3,0x80000000,0x3e8b93ad,0xbe66884d,0x3d88e67c,0xbeb1c123,0xbe2d9864,0xbe9eda48
.long 0xbea813db,0xbe066e62,0xbeac65f6,0x3ddccad7,0xbe43901e,0x3e985675,0x3d2cdbfb,0x3eb3b9a2
.long 0x3eb504f3,0x80000000,0x3e8b38fb,0xbe676345,0x3d8488f8,0xbeb1f60b,0xbe308313,0xbe9e0c0d
.long 0xbea8e3c6,0xbe024bc1,0xbeab8804,0x3de7581c,0xbe3debf8,0x3e9a1c9c,0x3d4bb1e4,0x3eb3383d
.long 0x3eb504f3,0x80000000,0x3e8addf2,0xbe683dae,0x3d802a2d,0xbeb2293b,0xbe3369ee,0xbe9d3a64
.long 0xbea9ad2e,0xbdfc4836,0xbeaa9fbd,0x3df1d772,0xbe383758,0x3e9bd564,0x3d6a6fc1,0x3eb2a1af
.long 0x3eb504f3,0x80000000,0x3e8a8294,0xbe691788,0x3d77944a,0xbeb25ab4,0xbe364ce5,0xbe9c6553
.long 0xbeaa700c,0xbdf3ef2f,0xbea9ad2e,0x3dfc4836,0xbe3272be,0x3e9d80a8,0x3d8488f8,0x3eb1f60b
.long 0x3eb504f3,0x80000000,0x3e8a26e0,0xbe69f0d2,0x3d6ed1d8,0xbeb28a74,0xbe392be8,0xbe9b8cdd
.long 0xbeab2c57,0xbdeb8cc0,0xbea8b067,0x3e0354e4,0xbe2c9ea9,0x3e9f1e43,0x3d93ca6a,0x3eb13563
.long 0x3eb504f3,0x80000000,0x3e89cad7,0xbe6ac98c,0x3d660d19,0xbeb2b87c,0xbe3c06e6,0xbe9ab107
.long 0xbeabe20a,0xbde3213d,0xbea7a976,0x3e087dc3,0xbe26bb9a,0x3ea0ae10,0x3da2fa69,0x3eb05fd0
.long 0x3eb504f3,0x80000000,0x3e896e7a,0xbe6ba1b5,0x3d5d4622,0xbeb2e4cb,0xbe3eddd1,0xbe99d1d7
.long 0xbeac911c,0xbddaacf8,0xbea6986c,0x3e0d9e6a,0xbe20ca16,0x3ea22fed,0x3db2172a,0x3eaf756a
.long 0x3eb504f3,0x80000000,0x3e8911c7,0xbe6c794d,0x3d547d09,0xbeb30f61,0xbe41b099,0xbe98ef51
.long 0xbead3986,0xbdd23045,0xbea57d59,0x3e12b689,0xbe1aca9e,0x3ea3a3b9,0x3dc11ee4,0x3eae764c
.long 0x3eb504f3,0x80000000,0x3e88b4c0,0xbe6d5053,0x3d4bb1e4,0xbeb3383d,0xbe447f2d,0xbe98097a
.long 0xbeaddb43,0xbdc9ab78,0xbea4584e,0x3e17c5d1,0xbe14bdba,0x3ea50953,0x3dd00fd1,0x3ead6296
.long 0x3eb504f3,0x80000000,0x3e885764,0xbe6e26c6,0x3d42e4c8,0xbeb35f5f,0xbe47497e,0xbe972057
.long 0xbeae764c,0xbdc11ee4,0xbea3295d,0x3e1ccbf5,0xbe0ea3ee,0x3ea6609c,0x3ddee82e,0x3eac3a67
.long 0x3eb504f3,0x80000000,0x3e87f9b5,0xbe6efca7,0x3d3a15cc,0xbeb384c6,0xbe4a0f7c,0xbe9633ed
.long 0xbeaf0a9c,0xbdb88ade,0xbea1f097,0x3e21c8a7,0xbe087dc3,0x3ea7a976,0x3deda639,0x3eaafde3
.long 0x3eb504f3,0x80000000,0x3e879bb1,0xbe6fd1f4,0x3d314504,0xbeb3a872,0xbe4cd119,0xbe954440
.long 0xbeaf982b,0xbdafefbb,0xbea0ae10,0x3e26bb9a,0xbe024bc1,0x3ea8e3c6,0x3dfc4836,0x3ea9ad2e
.long 0x3eb504f3,0x80000000,0x3e873d5a,0xbe70a6ad,0x3d287287,0xbeb3ca63,0xbe4f8e45,0xbe945158
.long 0xbeb01ef6,0xbda74dcf,0xbe9f61dc,0x3e2ba482,0xbdf81ce5,0x3eaa0f6f,0x3e056635,0x3ea84871
.long 0x3eb504f3,0x80000000,0x3e86deb0,0xbe717ad2,0x3d1f9e6a,0xbeb3ea98,0xbe5246f1,0xbe935b38
.long 0xbeb09ef7,0xbd9ea570,0xbe9e0c0d,0x3e308313,0xbdeb8cc0,0x3eab2c57,0x3e0c988f,0x3ea6cfd6
.long 0x3eb504f3,0x80000000,0x3e867fb2,0xbe724e62,0x3d16c8c3,0xbeb40911,0xbe54fb0d,0xbe9261e5
.long 0xbeb11828,0xbd95f6f4,0xbe9cacb9,0x3e355702,0xbddee82e,0x3eac3a67,0x3e13ba4f,0x3ea54389
.long 0x3eb504f3,0x80000000,0x3e862061,0xbe73215c,0x3d0df1a9,0xbeb425ce,0xbe57aa8b,0xbe916566
.long 0xbeb18a86,0xbd8d42af,0xbe9b43f5,0x3e3a2005,0xbdd23045,0x3ead3986,0x3e1aca9e,0x3ea3a3b9
.long 0x3eb504f3,0x80000000,0x3e85c0be,0xbe73f3c1,0x3d051930,0xbeb440cf,0xbe5a555c,0xbe9065c0
.long 0xbeb1f60b,0xbd8488f8,0xbe99d1d7,0x3e3eddd1,0xbdc56621,0x3eae299f,0x3e21c8a7,0x3ea1f097
.long 0x3eb504f3,0x80000000,0x3e8560c8,0xbe74c58e,0x3cf87edd,0xbeb45a13,0xbe5cfb70,0xbe8f62f9
.long 0xbeb25ab4,0xbd77944a,0xbe985675,0x3e43901e,0xbdb88ade,0x3eaf0a9c,0x3e28b396,0x3ea02a57
.long 0x3eb504f3,0x80000000,0x3e85007f,0xbe7596c5,0x3ce6c8f5,0xbeb4719a,0xbe5f9cba,0xbe8e5d15
.long 0xbeb2b87c,0xbd660d19,0xbe96d1e6,0x3e4836a4,0xbdab9f99,0x3eafdc6a,0x3e2f8a9a,0x3e9e512d
.long 0x3eb504f3,0x80000000,0x3e849fe5,0xbe766765,0x3cd510d4,0xbeb48763,0xbe62392a,0xbe8d541b
.long 0xbeb30f61,0xbd547d09,0xbe954440,0x3e4cd119,0xbd9ea570,0x3eb09ef7,0x3e364ce5,0x3e9c6553
.long 0x3eb504f3,0x80000000,0x3e843ef9,0xbe77376c,0x3cc356a5,0xbeb49b6f,0xbe64d0b3,0xbe8c4810
.long 0xbeb35f5f,0xbd42e4c8,0xbe93ad9d,0x3e515f39,0xbd919d85,0x3eb15232,0x3e3cf9a9,0x3e9a6701
.long 0x3eb504f3,0x80000000,0x3e83ddbb,0xbe7806db,0x3cb19a94,0xbeb4adbe,0xbe676345,0xbe8b38fb
.long 0xbeb3a872,0xbd314504,0xbe920e15,0x3e55e0bb,0xbd8488f8,0x3eb1f60b,0x3e43901e,0x3e985675
.long 0x3eb504f3,0x80000000,0x3e837c2c,0xbe78d5b1,0x3c9fdccd,0xbeb4be4f,0xbe69f0d2,0xbe8a26e0
.long 0xbeb3ea98,0xbd1f9e6a,0xbe9065c0,0x3e5a555c,0xbd6ed1d8,0x3eb28a74,0x3e4a0f7c,0x3e9633ed
.long 0x3eb504f3,0x80000000,0x3e831a4c,0xbe79a3ee,0x3c8e1d7b,0xbeb4cd21,0xbe6c794d,0xbe8911c7
.long 0xbeb425ce,0xbd0df1a9,0xbe8eb4b9,0x3e5ebcd5,0xbd547d09,0x3eb30f61,0x3e5076ff,0x3e93ffa8
.long 0x3eb504f3,0x80000000,0x3e82b81b,0xbe7a7190,0x3c78b996,0xbeb4da36,0xbe6efca7,0xbe87f9b5
.long 0xbeb45a13,0xbcf87edd,0xbe8cfb19,0x3e6316e4,0xbd3a15cc,0x3eb384c6,0x3e56c5e5,0x3e91b9eb
.long 0x3eb504f3,0x80000000,0x3e82559a,0xbe7b3e98,0x3c5535d0,0xbeb4e58c,0xbe717ad2,0xbe86deb0
.long 0xbeb48763,0xbcd510d4,0xbe8b38fb,0x3e676345,0xbd1f9e6a,0x3eb3ea98,0x3e5cfb70,0x3e8f62f9
.long 0x3eb504f3,0x80000000,0x3e81f2c8,0xbe7c0b05,0x3c31affc,0xbeb4ef25,0xbe73f3c1,0xbe85c0be
.long 0xbeb4adbe,0xbcb19a94,0xbe896e7a,0x3e6ba1b5,0xbd051930,0x3eb440cf,0x3e6316e4,0x3e8cfb19
.long 0x3eb504f3,0x80000000,0x3e818fa5,0xbe7cd6d6,0x3c0e2871,0xbeb4f6fe,0xbe766765,0xbe849fe5
.long 0xbeb4cd21,0xbc8e1d7b,0xbe879bb1,0x3e6fd1f4,0xbcd510d4,0x3eb48763,0x3e691788,0x3e8a8294
.long 0x3eb504f3,0x80000000,0x3e812c33,0xbe7da20c,0x3bd53f10,0xbeb4fd19,0xbe78d5b1,0xbe837c2c
.long 0xbeb4e58c,0xbc5535d0,0xbe85c0be,0x3e73f3c1,0xbc9fdccd,0x3eb4be4f,0x3e6efca7,0x3e87f9b5
.long 0x3eb504f3,0x80000000,0x3e80c872,0xbe7e6ca5,0x3b8e2b2f,0xbeb50176,0xbe7b3e98,0xbe82559a
.long 0xbeb4f6fe,0xbc0e2871,0xbe83ddbb,0x3e7806db,0xbc5535d0,0x3eb4e58c,0x3e74c58e,0x3e8560c8
.long 0x3eb504f3,0x80000000,0x3e806460,0xbe7f36a1,0x3b0e2bde,0xbeb50414,0xbe7da20c,0xbe812c33
.long 0xbeb50176,0xbb8e2b2f,0xbe81f2c8,0x3e7c0b05,0xbbd53f10,0x3eb4fd19,0x3e7a7190,0x3e82b81b
.size const_tab, 48128
.section .rodata,"a"
.p2align 6
.amdhsa_kernel mega_kernel
  .amdhsa_next_free_vgpr 256
  .amdhsa_next_free_sgpr 102
  .amdhsa_accum_offset 256
  .amdhsa_group_segment_fixed_size 0
  .amdhsa_kernarg_size 88
  .amdhsa_user_sgpr_count 2
  .amdhsa_user_sgpr_kernarg_segment_ptr 1
  .amdhsa_system_sgpr_workgroup_id_x 1
  .amdhsa_float_denorm_mode_32 3
  .amdhsa_float_denorm_mode_16_64 3
.end_amdhsa_kernel
```
